```python
import torch

def _softmax(x, axis=-1):
    return torch.softmax(x, dim=axis)
def _gelu(x):
    return torch.nn.functional.gelu(x, approximate="tanh")
def _silu(x):
    return torch.nn.functional.silu(x)
def _sigmoid(x):
    return torch.sigmoid(x)
def _layernorm(x, axis=-1, eps=1e-5):
    m = x.mean(dim=axis, keepdim=True)
    v = x.var(dim=axis, keepdim=True, unbiased=False)
    return (x - m) / torch.sqrt(v + eps)
def _scatter_add(tgt, idx, src, axis=0):
    return tgt.clone().index_add_(axis, idx, src)
def _segment_sum(src, seg, n):
    out = torch.zeros((n,) + src.shape[1:], dtype=src.dtype)
    return out.index_add_(0, seg, src)
def _pad(x, pw):
    flat = tuple(v for pair in reversed(pw) for v in pair)
    return torch.nn.functional.pad(x, flat)

kernel_name = 'standalone__gqa_softmax__near_ridge'

def setup_inputs():

    _w = (lambda a: (lambda t: t.to(torch.bfloat16) if t.is_floating_point() else t)(torch.as_tensor(a)))
    B, Hq, Hkv, Sq, Sk, D = 16, 32, 4, 512, 512, 128
    return {
        "q": _w((lambda *s: torch.randn(*s, dtype=torch.bfloat16) * 0.8)(B, Hq, Sq, D)),
        "k": _w((lambda *s: torch.randn(*s, dtype=torch.bfloat16) * 0.8)(B, Hkv, Sk, D)),
        "v": _w((lambda *s: torch.randn(*s, dtype=torch.bfloat16) * 0.05)(B, Hkv, Sk, D)),
    }

def reference(q, k, v):
    B, Hq, Sq, D = q.shape
    Hkv = k.shape[1]
    rep = Hq // Hkv
    k = (lambda x, n, axis: torch.repeat_interleave(x, n, dim=axis))(k, rep, axis=1)
    v = (lambda x, n, axis: torch.repeat_interleave(x, n, dim=axis))(v, rep, axis=1)
    scale = D ** -0.5
    scores = torch.einsum("bhqd,bhkd->bhqk", q, k) * scale
    p = _softmax(scores, axis=-1)
    return torch.einsum("bhqk,bhkd->bhqd", p, v)
```

```asm
; @launch grid=(256,1,1) block=(256,1,1) lds=163840
.amdgcn_target "amdgcn-amd-amdhsa--gfx950"
.text
.globl standalone__gqa_softmax__near_ridge_kernel
.p2align 8
.type standalone__gqa_softmax__near_ridge_kernel,@function
standalone__gqa_softmax__near_ridge_kernel:
    s_cmp_ge_u32 s2, 256
    s_cbranch_scc1 L_end
    s_load_dwordx4 s[4:7], s[0:1], 0
    s_load_dwordx4 s[40:43], s[0:1], 16
    v_readfirstlane_b32 s3, v0
    v_and_b32 v0, 63, v0
    v_lshrrev_b32 v9, 4, v0
    s_getpc_b64 s[100:101]
L_pc:
    s_lshr_b32 s3, s3, 6
    s_lshr_b32 s47, s2, 3
    s_lshl2_add_u32 s47, s47, s3
    s_lshl_b32 s44, s47, 7
    s_add_u32 s100, s100, L_main-L_pc
    s_addc_u32 s101, s101, 0
    v_lshl_add_u32 v14, v9, 14, s44
    v_min_u32 v14, L_fin-L_main, v14
    v_add_co_u32 v14, vcc, s100, v14
    v_mov_b32 v15, s101
    s_and_b32 s44, s2, 7
    v_addc_co_u32 v15, vcc, 0, v15, vcc
    global_load_dword v14, v[14:15], off
    s_lshl_b32 s45, s44, 7
    s_add_u32 s45, s45, s47
    s_lshl_b32 s39, s45, 16
    s_lshr_b32 s45, s45, 4
    s_lshl_b32 s47, s45, 17
    s_lshr_b32 s44, s3, 1
    s_lshl_b32 s44, s44, 12
    s_and_b32 s45, s3, 1
    s_lshl_b32 s45, s45, 7
    s_add_u32 s44, s44, s45
    v_bfe_u32 v10, v0, 2, 2
    v_and_b32 v11, 3, v0
    v_lshlrev_b32 v2, 8, v10
    v_lshl_add_u32 v2, v9, 6, v2
    v_lshl_add_u32 v2, v11, 4, v2
    v_lshl_add_u32 v12, v10, 2, v9
    v_lshlrev_b32 v12, 8, v12
    v_lshl_add_u32 v11, v11, 4, v12
    s_mov_b32 s15, 0x20000
    s_mov_b32 s11, 0x20000
    s_mov_b32 s10, 0x10000
    s_sub_u32 s14, s15, s44
    s_add_u32 s44, s44, s47
    s_lshl_b32 s26, s3, 12
    s_lshl_b32 s38, 1, 12
    s_mov_b32 s33, 0
    s_waitcnt lgkmcnt(0)
    s_add_u32 s12, s6, s44
    s_addc_u32 s13, s7, 0
    s_add_u32 s8, s4, s39
    s_addc_u32 s9, s5, 0
    s_movk_i32 s36, 0x0
    buffer_load_dwordx4 v[128:131], v11, s[12:15], s36 offen offset:0
    buffer_load_dwordx4 v[132:135], v11, s[12:15], s36 offen offset:64
    s_movk_i32 s36, 0x2000
    buffer_load_dwordx4 v[136:139], v11, s[12:15], s36 offen offset:0
    buffer_load_dwordx4 v[140:143], v11, s[12:15], s36 offen offset:64
    s_movk_i32 s36, 0x4000
    buffer_load_dwordx4 v[144:147], v11, s[12:15], s36 offen offset:0
    buffer_load_dwordx4 v[148:151], v11, s[12:15], s36 offen offset:64
    s_movk_i32 s36, 0x6000
    buffer_load_dwordx4 v[152:155], v11, s[12:15], s36 offen offset:0
    buffer_load_dwordx4 v[156:159], v11, s[12:15], s36 offen offset:64
    s_barrier
    s_mov_b32 m0, s26
    s_nop 0
    buffer_load_dwordx4 v2, s[8:11], s33 offen offset:0 nt lds
    buffer_load_dwordx4 v2, s[8:11], s33 offen offset:1024 nt lds
    buffer_load_dwordx4 v2, s[8:11], s33 offen offset:2048 nt lds
    buffer_load_dwordx4 v2, s[8:11], s33 offen offset:3072 nt lds
    s_add_u32 s33, s33, s38
    s_branch L_main
L_fb:
    s_waitcnt vmcnt(0) lgkmcnt(0)
    s_barrier
    s_sub_u32 s40, 0x20000, s14
    s_sub_u32 s12, s12, s40
    s_subb_u32 s13, s13, 0
    s_mov_b32 s14, 0x20000
    s_lshl_b32 s40, s3, 11
    v_lshrrev_b32 v9, 8, v11
    v_and_b32 v14, 3, v0
    v_lshl_add_u32 v9, v14, 4, v9
    v_lshlrev_b32 v9, 4, v9
    s_mov_b32 s36, 0
L_fb_k:
    buffer_load_dwordx4 v[128:131], v11, s[12:15], s36 offen offset:0
    buffer_load_dwordx4 v[132:135], v11, s[12:15], s36 offen offset:64
    buffer_load_dwordx4 v[136:139], v11, s[12:15], s36 offen offset:128
    buffer_load_dwordx4 v[140:143], v11, s[12:15], s36 offen offset:192
    s_waitcnt vmcnt(0)
    v_lshlrev_b32 v16, 16, v128
    v_and_b32 v17, s27, v128
    v_pk_mul_f32 v[16:17], v[16:17], s[28:29]
    v_cvt_pk_bf16_f32 v128, v16, v17
    v_lshlrev_b32 v16, 16, v129
    v_and_b32 v17, s27, v129
    v_pk_mul_f32 v[16:17], v[16:17], s[28:29]
    v_cvt_pk_bf16_f32 v129, v16, v17
    v_lshlrev_b32 v16, 16, v130
    v_and_b32 v17, s27, v130
    v_pk_mul_f32 v[16:17], v[16:17], s[28:29]
    v_cvt_pk_bf16_f32 v130, v16, v17
    v_lshlrev_b32 v16, 16, v131
    v_and_b32 v17, s27, v131
    v_pk_mul_f32 v[16:17], v[16:17], s[28:29]
    v_cvt_pk_bf16_f32 v131, v16, v17
    v_lshlrev_b32 v16, 16, v132
    v_and_b32 v17, s27, v132
    v_pk_mul_f32 v[16:17], v[16:17], s[28:29]
    v_cvt_pk_bf16_f32 v132, v16, v17
    v_lshlrev_b32 v16, 16, v133
    v_and_b32 v17, s27, v133
    v_pk_mul_f32 v[16:17], v[16:17], s[28:29]
    v_cvt_pk_bf16_f32 v133, v16, v17
    v_lshlrev_b32 v16, 16, v134
    v_and_b32 v17, s27, v134
    v_pk_mul_f32 v[16:17], v[16:17], s[28:29]
    v_cvt_pk_bf16_f32 v134, v16, v17
    v_lshlrev_b32 v16, 16, v135
    v_and_b32 v17, s27, v135
    v_pk_mul_f32 v[16:17], v[16:17], s[28:29]
    v_cvt_pk_bf16_f32 v135, v16, v17
    v_lshlrev_b32 v16, 16, v136
    v_and_b32 v17, s27, v136
    v_pk_mul_f32 v[16:17], v[16:17], s[28:29]
    v_cvt_pk_bf16_f32 v136, v16, v17
    v_lshlrev_b32 v16, 16, v137
    v_and_b32 v17, s27, v137
    v_pk_mul_f32 v[16:17], v[16:17], s[28:29]
    v_cvt_pk_bf16_f32 v137, v16, v17
    v_lshlrev_b32 v16, 16, v138
    v_and_b32 v17, s27, v138
    v_pk_mul_f32 v[16:17], v[16:17], s[28:29]
    v_cvt_pk_bf16_f32 v138, v16, v17
    v_lshlrev_b32 v16, 16, v139
    v_and_b32 v17, s27, v139
    v_pk_mul_f32 v[16:17], v[16:17], s[28:29]
    v_cvt_pk_bf16_f32 v139, v16, v17
    v_lshlrev_b32 v16, 16, v140
    v_and_b32 v17, s27, v140
    v_pk_mul_f32 v[16:17], v[16:17], s[28:29]
    v_cvt_pk_bf16_f32 v140, v16, v17
    v_lshlrev_b32 v16, 16, v141
    v_and_b32 v17, s27, v141
    v_pk_mul_f32 v[16:17], v[16:17], s[28:29]
    v_cvt_pk_bf16_f32 v141, v16, v17
    v_lshlrev_b32 v16, 16, v142
    v_and_b32 v17, s27, v142
    v_pk_mul_f32 v[16:17], v[16:17], s[28:29]
    v_cvt_pk_bf16_f32 v142, v16, v17
    v_lshlrev_b32 v16, 16, v143
    v_and_b32 v17, s27, v143
    v_pk_mul_f32 v[16:17], v[16:17], s[28:29]
    v_cvt_pk_bf16_f32 v143, v16, v17
    ds_write_b128 v9, v[128:131] offset:0
    ds_write_b128 v9, v[132:135] offset:1024
    ds_write_b128 v9, v[136:139] offset:2048
    ds_write_b128 v9, v[140:143] offset:3072
    s_waitcnt lgkmcnt(0)
    v_add_u32 v9, 0x1000, v9
    s_add_u32 s36, s36, 0x1000
    s_cmp_lt_u32 s36, 0x20000
    s_cbranch_scc1 L_fb_k
    s_sub_u32 s16, s16, s40
    s_subb_u32 s17, s17, 0
    s_mov_b32 s18, 0x20000
    s_lshl_b32 s40, s3, 13
    v_add_u32 v10, s40, v5
    s_add_u32 s48, s40, 131072
L_fb_blk:
    s_ff1_i32_b32 s40, s32
    s_bitset0_b32 s32, s40
    s_sub_u32 s40, 15, s40
    s_mul_i32 s33, s40, s38
    buffer_load_dwordx4 a[0:3], v1, s[8:11], s33 offen offset:0
    buffer_load_dwordx4 a[4:7], v1, s[8:11], s33 offen offset:64
    buffer_load_dwordx4 a[8:11], v1, s[8:11], s33 offen offset:128
    buffer_load_dwordx4 a[12:15], v1, s[8:11], s33 offen offset:192
    v_mov_b32 v8, 0xff800000
    v_mov_b32 v9, v3
    v_mov_b64 v[96:97], 0
    v_mov_b64 v[98:99], 0
    v_mov_b64 v[100:101], 0
    v_mov_b64 v[102:103], 0
    v_mov_b64 v[104:105], 0
    v_mov_b64 v[106:107], 0
    v_mov_b64 v[108:109], 0
    v_mov_b64 v[110:111], 0
    v_mov_b64 v[112:113], 0
    v_mov_b64 v[114:115], 0
    v_mov_b64 v[116:117], 0
    v_mov_b64 v[118:119], 0
    v_mov_b64 v[120:121], 0
    v_mov_b64 v[122:123], 0
    v_mov_b64 v[124:125], 0
    v_mov_b64 v[126:127], 0
    v_mov_b64 v[36:37], 0
    v_mov_b64 v[38:39], 0
    s_mov_b32 s37, 16
    s_waitcnt vmcnt(0)
L_fb_max:
    ds_read_b128 a[80:83], v9 offset:0
    ds_read_b128 a[84:87], v9 offset:1024
    ds_read_b128 a[88:91], v9 offset:2048
    ds_read_b128 a[92:95], v9 offset:3072
    ds_read_b128 a[96:99], v9 offset:4096
    ds_read_b128 a[100:103], v9 offset:5120
    ds_read_b128 a[104:107], v9 offset:6144
    ds_read_b128 a[108:111], v9 offset:7168
    v_add_u32 v9, 0x2000, v9
    s_waitcnt lgkmcnt(0)
    v_mfma_f32_16x16x32_bf16 v[64:67], a[80:83], a[0:3], 0
    v_mfma_f32_16x16x32_bf16 v[64:67], a[84:87], a[4:7], v[64:67]
    v_mfma_f32_16x16x32_bf16 v[64:67], a[88:91], a[8:11], v[64:67]
    v_mfma_f32_16x16x32_bf16 v[64:67], a[92:95], a[12:15], v[64:67]
    v_mfma_f32_16x16x32_bf16 v[68:71], a[96:99], a[0:3], 0
    v_mfma_f32_16x16x32_bf16 v[68:71], a[100:103], a[4:7], v[68:71]
    v_mfma_f32_16x16x32_bf16 v[68:71], a[104:107], a[8:11], v[68:71]
    v_mfma_f32_16x16x32_bf16 v[68:71], a[108:111], a[12:15], v[68:71]
    s_nop 9
    v_max3_f32 v8, v8, v64, v65
    v_max3_f32 v8, v8, v66, v67
    v_max3_f32 v8, v8, v68, v69
    v_max3_f32 v8, v8, v70, v71
    s_sub_u32 s37, s37, 1
    s_cmp_lg_u32 s37, 0
    s_cbranch_scc1 L_fb_max
    v_mov_b32 v14, v8
    s_nop 1
    v_permlane32_swap_b32 v14, v8
    s_nop 1
    v_max_f32 v8, v8, v14
    v_mov_b32 v14, v8
    s_nop 1
    v_permlane16_swap_b32 v14, v8
    s_nop 1
    v_max_f32 v8, v8, v14
    v_mov_b32 v9, v3
    s_mov_b32 s35, 0
L_fb_pv:
    s_add_u32 m0, s48, 0
    s_nop 0
    buffer_load_dwordx4 v2, s[16:19], s35 offen offset:0 lds
    buffer_load_dwordx4 v2, s[16:19], s35 offen offset:1024 lds
    buffer_load_dwordx4 v2, s[16:19], s35 offen offset:2048 lds
    buffer_load_dwordx4 v2, s[16:19], s35 offen offset:3072 lds
    s_add_u32 s35, s35, 4096
    s_add_u32 m0, s48, 4096
    s_nop 0
    buffer_load_dwordx4 v2, s[16:19], s35 offen offset:0 lds
    buffer_load_dwordx4 v2, s[16:19], s35 offen offset:1024 lds
    buffer_load_dwordx4 v2, s[16:19], s35 offen offset:2048 lds
    buffer_load_dwordx4 v2, s[16:19], s35 offen offset:3072 lds
    s_add_u32 s35, s35, 4096
    ds_read_b128 a[80:83], v9 offset:0
    ds_read_b128 a[84:87], v9 offset:1024
    ds_read_b128 a[88:91], v9 offset:2048
    ds_read_b128 a[92:95], v9 offset:3072
    ds_read_b128 a[96:99], v9 offset:4096
    ds_read_b128 a[100:103], v9 offset:5120
    ds_read_b128 a[104:107], v9 offset:6144
    ds_read_b128 a[108:111], v9 offset:7168
    v_add_u32 v9, 0x2000, v9
    s_waitcnt lgkmcnt(0)
    v_mfma_f32_16x16x32_bf16 v[64:67], a[80:83], a[0:3], 0
    v_mfma_f32_16x16x32_bf16 v[64:67], a[84:87], a[4:7], v[64:67]
    v_mfma_f32_16x16x32_bf16 v[64:67], a[88:91], a[8:11], v[64:67]
    v_mfma_f32_16x16x32_bf16 v[64:67], a[92:95], a[12:15], v[64:67]
    v_mfma_f32_16x16x32_bf16 v[68:71], a[96:99], a[0:3], 0
    v_mfma_f32_16x16x32_bf16 v[68:71], a[100:103], a[4:7], v[68:71]
    v_mfma_f32_16x16x32_bf16 v[68:71], a[104:107], a[8:11], v[68:71]
    v_mfma_f32_16x16x32_bf16 v[68:71], a[108:111], a[12:15], v[68:71]
    s_nop 9
    v_sub_f32 v64, v64, v8
    v_sub_f32 v65, v65, v8
    v_sub_f32 v66, v66, v8
    v_sub_f32 v67, v67, v8
    v_sub_f32 v68, v68, v8
    v_sub_f32 v69, v69, v8
    v_sub_f32 v70, v70, v8
    v_sub_f32 v71, v71, v8
    v_exp_f32 v64, v64
    v_exp_f32 v65, v65
    v_exp_f32 v66, v66
    v_exp_f32 v67, v67
    v_exp_f32 v68, v68
    v_exp_f32 v69, v69
    v_exp_f32 v70, v70
    v_exp_f32 v71, v71
    s_nop 0
    v_cvt_pk_bf16_f32 v48, v64, v65
    v_cvt_pk_bf16_f32 v49, v66, v67
    v_cvt_pk_bf16_f32 v50, v68, v69
    v_cvt_pk_bf16_f32 v51, v70, v71
    s_waitcnt vmcnt(0)
    ds_read_b64_tr_b16 a[144:145], v10 offset:0
    ds_read_b64_tr_b16 a[146:147], v10 offset:4096
    ds_read_b64_tr_b16 a[148:149], v10 offset:8
    ds_read_b64_tr_b16 a[150:151], v10 offset:4104
    ds_read_b64_tr_b16 a[152:153], v10 offset:256
    ds_read_b64_tr_b16 a[154:155], v10 offset:4352
    ds_read_b64_tr_b16 a[156:157], v10 offset:264
    ds_read_b64_tr_b16 a[158:159], v10 offset:4360
    ds_read_b64_tr_b16 a[160:161], v10 offset:512
    ds_read_b64_tr_b16 a[162:163], v10 offset:4608
    ds_read_b64_tr_b16 a[164:165], v10 offset:520
    ds_read_b64_tr_b16 a[166:167], v10 offset:4616
    ds_read_b64_tr_b16 a[168:169], v10 offset:768
    ds_read_b64_tr_b16 a[170:171], v10 offset:4864
    ds_read_b64_tr_b16 a[172:173], v10 offset:776
    ds_read_b64_tr_b16 a[174:175], v10 offset:4872
    s_waitcnt lgkmcnt(0)
    v_mfma_f32_16x16x32_bf16 v[36:39], v[24:27], v[48:51], v[36:39]
    v_mfma_f32_16x16x32_bf16 v[96:99], a[144:147], v[48:51], v[96:99]
    v_mfma_f32_16x16x32_bf16 v[100:103], a[148:151], v[48:51], v[100:103]
    v_mfma_f32_16x16x32_bf16 v[104:107], a[152:155], v[48:51], v[104:107]
    v_mfma_f32_16x16x32_bf16 v[108:111], a[156:159], v[48:51], v[108:111]
    v_mfma_f32_16x16x32_bf16 v[112:115], a[160:163], v[48:51], v[112:115]
    v_mfma_f32_16x16x32_bf16 v[116:119], a[164:167], v[48:51], v[116:119]
    v_mfma_f32_16x16x32_bf16 v[120:123], a[168:171], v[48:51], v[120:123]
    v_mfma_f32_16x16x32_bf16 v[124:127], a[172:175], v[48:51], v[124:127]
    s_cmp_lt_u32 s35, 0x20000
    s_cbranch_scc1 L_fb_pv
    s_nop 9
    v_rcp_f32 v12, v36
    s_nop 0
    v_mul_f32 v96, v12, v96
    v_mul_f32 v97, v12, v97
    v_mul_f32 v98, v12, v98
    v_mul_f32 v99, v12, v99
    v_mul_f32 v100, v12, v100
    v_mul_f32 v101, v12, v101
    v_mul_f32 v102, v12, v102
    v_mul_f32 v103, v12, v103
    v_mul_f32 v104, v12, v104
    v_mul_f32 v105, v12, v105
    v_mul_f32 v106, v12, v106
    v_mul_f32 v107, v12, v107
    v_mul_f32 v108, v12, v108
    v_mul_f32 v109, v12, v109
    v_mul_f32 v110, v12, v110
    v_mul_f32 v111, v12, v111
    v_mul_f32 v112, v12, v112
    v_mul_f32 v113, v12, v113
    v_mul_f32 v114, v12, v114
    v_mul_f32 v115, v12, v115
    v_mul_f32 v116, v12, v116
    v_mul_f32 v117, v12, v117
    v_mul_f32 v118, v12, v118
    v_mul_f32 v119, v12, v119
    v_mul_f32 v120, v12, v120
    v_mul_f32 v121, v12, v121
    v_mul_f32 v122, v12, v122
    v_mul_f32 v123, v12, v123
    v_mul_f32 v124, v12, v124
    v_mul_f32 v125, v12, v125
    v_mul_f32 v126, v12, v126
    v_mul_f32 v127, v12, v127
    v_cvt_pk_bf16_f32 v96, v96, v97
    v_cvt_pk_bf16_f32 v97, v98, v99
    v_cvt_pk_bf16_f32 v98, v100, v101
    v_cvt_pk_bf16_f32 v99, v102, v103
    v_cvt_pk_bf16_f32 v104, v104, v105
    v_cvt_pk_bf16_f32 v105, v106, v107
    v_cvt_pk_bf16_f32 v106, v108, v109
    v_cvt_pk_bf16_f32 v107, v110, v111
    v_cvt_pk_bf16_f32 v112, v112, v113
    v_cvt_pk_bf16_f32 v113, v114, v115
    v_cvt_pk_bf16_f32 v114, v116, v117
    v_cvt_pk_bf16_f32 v115, v118, v119
    v_cvt_pk_bf16_f32 v120, v120, v121
    v_cvt_pk_bf16_f32 v121, v122, v123
    v_cvt_pk_bf16_f32 v122, v124, v125
    v_cvt_pk_bf16_f32 v123, v126, v127
    buffer_store_dwordx4 v[96:99], v1, s[20:23], s33 offen offset:0
    buffer_store_dwordx4 v[104:107], v1, s[20:23], s33 offen offset:64
    buffer_store_dwordx4 v[112:115], v1, s[20:23], s33 offen offset:128
    buffer_store_dwordx4 v[120:123], v1, s[20:23], s33 offen offset:192
    s_waitcnt vmcnt(0)
    s_cmp_lg_u32 s32, 0
    s_cbranch_scc1 L_fb_blk
L_end:
    s_endpgm
.p2align 12
L_main:
    s_lshl_b32 s45, s3, 11
    s_add_u32 s46, s45, s47
    s_add_u32 s16, s40, s46
    s_addc_u32 s17, s41, 0
    s_sub_u32 s18, 0x20000, s45
    s_mov_b32 s19, 0x20000
    s_add_u32 s20, s42, s39
    s_addc_u32 s21, s43, 0
    s_mov_b32 s22, 0x10000
    s_mov_b32 s23, 0x20000
    s_mov_b32 s34, 0
    s_mov_b32 s37, 0
    s_mov_b32 s32, 0
    s_add_u32 s48, s45, 131072
    s_add_u32 s49, s45, 139264
    s_add_u32 s50, s45, 147456
    s_add_u32 s51, s45, 155648
    s_mov_b32 s28, 0x3e0293ee
    s_mov_b32 s29, s28
    s_mov_b32 s27, 0xffff0000
    s_mov_b32 s30, 0x35800000
    s_mov_b32 s31, 0x18000000
    s_mov_b32 s46, 0x6c800000
    s_mov_b32 s40, 0xaaaaaaaa
    s_mov_b32 s42, 0x45000000
    s_brev_b32 s43, 1
    v_and_b32 v8, 15, v0
    v_lshlrev_b32 v1, 8, v8
    v_lshl_add_u32 v1, v9, 4, v1
    s_mov_b32 s24, s45
    s_add_u32 s25, s45, 59388
    v_cmp_eq_u32 vcc, v9, v10
    v_and_b32 v12, 3, v0
    v_mov_b32 v16, 0x3e03
    v_cndmask_b32 v13, 7, v12, vcc
    v_mov_b32 v17, 0xb9d8
    v_lshlrev_b32 v18, 16, v16
    v_lshlrev_b32 v19, 16, v17
    v_cmp_eq_u32 s[4:5], 0, v13
    v_cmp_eq_u32 s[6:7], 1, v13
    s_nop 0
    v_cndmask_b32 v240, 0, v16, s[4:5]
    v_cndmask_b32 v244, 0, v17, s[4:5]
    v_cndmask_b32 v248, 0, v18, s[4:5]
    v_cndmask_b32 v252, 0, v19, s[4:5]
    v_cndmask_b32 v241, 0, v16, s[6:7]
    v_cndmask_b32 v245, 0, v17, s[6:7]
    v_cndmask_b32 v249, 0, v18, s[6:7]
    v_cndmask_b32 v253, 0, v19, s[6:7]
    v_cmp_eq_u32 s[4:5], 2, v13
    v_cmp_eq_u32 s[6:7], 3, v13
    s_nop 0
    v_cndmask_b32 v242, 0, v16, s[4:5]
    v_cndmask_b32 v246, 0, v17, s[4:5]
    v_cndmask_b32 v250, 0, v18, s[4:5]
    v_cndmask_b32 v254, 0, v19, s[4:5]
    v_cndmask_b32 v243, 0, v16, s[6:7]
    v_cndmask_b32 v247, 0, v17, s[6:7]
    v_cndmask_b32 v251, 0, v18, s[6:7]
    v_cndmask_b32 v255, 0, v19, s[6:7]
    v_lshlrev_b32 v3, 4, v0
    v_add_u32 v4, 0x10000, v3
    v_lshlrev_b32 v5, 10, v9
    v_lshl_add_u32 v5, v8, 4, v5
    v_and_b32 v12, 3, v0
    v_cmp_gt_u32 vcc, 2, v12
    v_lshlrev_b32 v15, 10, v10
    v_lshl_add_u32 v15, v12, 6, v15
    v_lshl_add_u32 v15, v9, 4, v15
    v_add_u32 v15, s26, v15
    v_add_u32 v10, 49152, v5
    v_add_u32 v5, 131072, v5
    v_mov_b32 v12, 0x3f803f80
    v_cndmask_b32 v24, 0, v12, vcc
    v_cndmask_b32 v25, 0, v12, vcc
    v_cndmask_b32 v26, 0, v12, vcc
    v_cndmask_b32 v27, 0, v12, vcc
    v_and_b32 v12, 7, v0
    v_bfe_u32 v13, v0, 3, 1
    v_lshlrev_b32 v12, 8, v12
    v_lshl_add_u32 v12, v13, 6, v12
    v_lshl_add_u32 v8, v9, 4, v12
    v_and_b32 v12, 1, v0
    v_mul_lo_u32 v12, v12, s40
    v_add_u32 v9, 0x44444444, v12
    v_mov_b64 v[36:37], 0
    v_mov_b64 v[38:39], 0
    v_mov_b64 v[40:41], 0
    v_mov_b64 v[42:43], 0
    v_mov_b64 v[44:45], 0
    v_mov_b64 v[46:47], 0
    s_waitcnt vmcnt(11)
    v_mfma_f32_16x16x32_bf16 v[16:19], v[128:131], v[240:243], 0
    v_mfma_f32_16x16x32_bf16 v[16:19], v[128:131], v[244:247], v[16:19]
    v_mfma_f32_16x16x32_bf16 v[20:23], v[128:131], v[248:251], 0
    v_mfma_f32_16x16x32_bf16 v[20:23], v[128:131], v[252:255], v[20:23]
    s_waitcnt vmcnt(10)
    v_mfma_f32_16x16x32_bf16 v[64:67], v[132:135], v[240:243], 0
    v_mfma_f32_16x16x32_bf16 v[64:67], v[132:135], v[244:247], v[64:67]
    v_mfma_f32_16x16x32_bf16 v[68:71], v[132:135], v[248:251], 0
    v_mfma_f32_16x16x32_bf16 v[68:71], v[132:135], v[252:255], v[68:71]
    v_cvt_pk_bf16_f32 v128, v16, v20
    v_cvt_pk_bf16_f32 v129, v17, v21
    v_cvt_pk_bf16_f32 v130, v18, v22
    v_cvt_pk_bf16_f32 v131, v19, v23
    s_mov_b32 m0, s25
    s_nop 0
    ds_write_addtid_b32 v128 offset:55300
    ds_write_addtid_b32 v129 offset:55556
    ds_write_addtid_b32 v130 offset:55812
    ds_write_addtid_b32 v131 offset:56068
    s_mov_b32 m0, s48
    s_movk_i32 s35, 0x0
    buffer_load_dwordx4 v2, s[16:19], s35 offen offset:0 lds
    buffer_load_dwordx4 v2, s[16:19], s35 offen offset:1024 lds
    s_waitcnt vmcnt(11)
    v_mfma_f32_16x16x32_bf16 v[16:19], v[136:139], v[240:243], 0
    v_mfma_f32_16x16x32_bf16 v[16:19], v[136:139], v[244:247], v[16:19]
    v_mfma_f32_16x16x32_bf16 v[20:23], v[136:139], v[248:251], 0
    v_mfma_f32_16x16x32_bf16 v[20:23], v[136:139], v[252:255], v[20:23]
    v_cvt_pk_bf16_f32 v132, v64, v68
    v_cvt_pk_bf16_f32 v133, v65, v69
    v_cvt_pk_bf16_f32 v134, v66, v70
    v_cvt_pk_bf16_f32 v135, v67, v71
    s_mov_b32 m0, s25
    s_nop 0
    ds_write_addtid_b32 v132 offset:56324
    ds_write_addtid_b32 v133 offset:56580
    ds_write_addtid_b32 v134 offset:56836
    ds_write_addtid_b32 v135 offset:57092
    s_waitcnt vmcnt(10)
    v_mfma_f32_16x16x32_bf16 v[64:67], v[140:143], v[240:243], 0
    v_mfma_f32_16x16x32_bf16 v[64:67], v[140:143], v[244:247], v[64:67]
    v_mfma_f32_16x16x32_bf16 v[68:71], v[140:143], v[248:251], 0
    v_mfma_f32_16x16x32_bf16 v[68:71], v[140:143], v[252:255], v[68:71]
    v_cvt_pk_bf16_f32 v136, v16, v20
    v_cvt_pk_bf16_f32 v137, v17, v21
    v_cvt_pk_bf16_f32 v138, v18, v22
    v_cvt_pk_bf16_f32 v139, v19, v23
    ds_write_addtid_b32 v136 offset:63492
    ds_write_addtid_b32 v137 offset:63748
    ds_write_addtid_b32 v138 offset:64004
    ds_write_addtid_b32 v139 offset:64260
    s_mov_b32 m0, s49
    s_movk_i32 s35, 0x2000
    buffer_load_dwordx4 v2, s[16:19], s35 offen offset:0 lds
    buffer_load_dwordx4 v2, s[16:19], s35 offen offset:1024 lds
    s_waitcnt vmcnt(11)
    v_mfma_f32_16x16x32_bf16 v[16:19], v[144:147], v[240:243], 0
    v_mfma_f32_16x16x32_bf16 v[16:19], v[144:147], v[244:247], v[16:19]
    v_mfma_f32_16x16x32_bf16 v[20:23], v[144:147], v[248:251], 0
    v_mfma_f32_16x16x32_bf16 v[20:23], v[144:147], v[252:255], v[20:23]
    v_cvt_pk_bf16_f32 v140, v64, v68
    v_cvt_pk_bf16_f32 v141, v65, v69
    v_cvt_pk_bf16_f32 v142, v66, v70
    v_cvt_pk_bf16_f32 v143, v67, v71
    s_mov_b32 m0, s25
    s_nop 0
    ds_write_addtid_b32 v140 offset:64516
    ds_write_addtid_b32 v141 offset:64772
    ds_write_addtid_b32 v142 offset:65028
    ds_write_addtid_b32 v143 offset:65284
    s_waitcnt vmcnt(10)
    v_mfma_f32_16x16x32_bf16 v[64:67], v[148:151], v[240:243], 0
    v_mfma_f32_16x16x32_bf16 v[64:67], v[148:151], v[244:247], v[64:67]
    v_mfma_f32_16x16x32_bf16 v[68:71], v[148:151], v[248:251], 0
    v_mfma_f32_16x16x32_bf16 v[68:71], v[148:151], v[252:255], v[68:71]
    v_cvt_pk_bf16_f32 v144, v16, v20
    v_cvt_pk_bf16_f32 v145, v17, v21
    v_cvt_pk_bf16_f32 v146, v18, v22
    v_cvt_pk_bf16_f32 v147, v19, v23
    s_mov_b32 m0, s24
    s_nop 0
    ds_write_addtid_b32 v144 offset:16384
    ds_write_addtid_b32 v145 offset:16640
    ds_write_addtid_b32 v146 offset:16896
    ds_write_addtid_b32 v147 offset:17152
    s_waitcnt vmcnt(9)
    v_mfma_f32_16x16x32_bf16 v[16:19], v[152:155], v[240:243], 0
    v_mfma_f32_16x16x32_bf16 v[16:19], v[152:155], v[244:247], v[16:19]
    v_mfma_f32_16x16x32_bf16 v[20:23], v[152:155], v[248:251], 0
    v_mfma_f32_16x16x32_bf16 v[20:23], v[152:155], v[252:255], v[20:23]
    v_cvt_pk_bf16_f32 v148, v64, v68
    v_cvt_pk_bf16_f32 v149, v65, v69
    v_cvt_pk_bf16_f32 v150, v66, v70
    v_cvt_pk_bf16_f32 v151, v67, v71
    ds_write_addtid_b32 v148 offset:17408
    ds_write_addtid_b32 v149 offset:17664
    ds_write_addtid_b32 v150 offset:17920
    ds_write_addtid_b32 v151 offset:18176
    s_waitcnt vmcnt(8)
    v_mfma_f32_16x16x32_bf16 v[64:67], v[156:159], v[240:243], 0
    v_mfma_f32_16x16x32_bf16 v[64:67], v[156:159], v[244:247], v[64:67]
    v_mfma_f32_16x16x32_bf16 v[68:71], v[156:159], v[248:251], 0
    v_mfma_f32_16x16x32_bf16 v[68:71], v[156:159], v[252:255], v[68:71]
    v_cvt_pk_bf16_f32 v152, v16, v20
    v_cvt_pk_bf16_f32 v153, v17, v21
    v_cvt_pk_bf16_f32 v154, v18, v22
    v_cvt_pk_bf16_f32 v155, v19, v23
    ds_write_addtid_b32 v152 offset:24576
    ds_write_addtid_b32 v153 offset:24832
    ds_write_addtid_b32 v154 offset:25088
    ds_write_addtid_b32 v155 offset:25344
    s_add_u32 m0, s26, 0xc000
    s_nop 0
    buffer_load_dwordx4 v2, s[8:11], s33 offen offset:0 nt lds
    buffer_load_dwordx4 v2, s[8:11], s33 offen offset:1024 nt lds
    buffer_load_dwordx4 v2, s[8:11], s33 offen offset:2048 nt lds
    buffer_load_dwordx4 v2, s[8:11], s33 offen offset:3072 nt lds
    s_add_u32 s33, s33, s38
    v_cvt_pk_bf16_f32 v156, v64, v68
    v_cvt_pk_bf16_f32 v157, v65, v69
    v_cvt_pk_bf16_f32 v158, v66, v70
    v_cvt_pk_bf16_f32 v159, v67, v71
    s_mov_b32 m0, s24
    s_nop 0
    ds_write_addtid_b32 v156 offset:25600
    ds_write_addtid_b32 v157 offset:25856
    ds_write_addtid_b32 v158 offset:26112
    ds_write_addtid_b32 v159 offset:26368
    s_waitcnt lgkmcnt(0)
    s_barrier
    ds_read_b128 a[208:211], v4 offset:49152
    ds_read_b128 a[212:215], v4 offset:50176
    ds_read_b128 a[216:219], v4 offset:51200
    ds_read_b128 a[220:223], v4 offset:52224
    ds_read_b128 a[236:239], v4 offset:56320
    ds_read_b128 a[232:235], v4 offset:55296
    ds_read_b128 a[228:231], v4 offset:54272
    ds_read_b128 a[224:227], v4 offset:53248
    ds_read_b128 a[240:243], v4 offset:57344
    ds_read_b128 a[244:247], v4 offset:58368
    ds_read_b128 a[248:251], v4 offset:59392
    ds_read_b128 a[252:255], v4 offset:60416
    ds_read_b128 v[92:95], v4 offset:64512
    ds_read_b128 v[88:91], v4 offset:63488
    ds_read_b128 v[84:87], v4 offset:62464
    ds_read_b128 v[80:83], v4 offset:61440
    s_mov_b64 exec, 0
    s_cmp_eq_u32 s3, 0
    s_cbranch_scc1 L_st0
    s_cmp_eq_u32 s3, 1
    s_cbranch_scc1 L_st3
    s_cmp_eq_u32 s3, 2
    s_cbranch_scc1 L_st6
    s_branch L_st9
L_wret:
    s_mov_b64 exec, -1
    s_waitcnt vmcnt(8)
    ds_read_b128 a[0:3], v15 offset:0
    ds_read_b128 a[4:7], v15 offset:256
    ds_read_b128 a[8:11], v15 offset:512
    ds_read_b128 a[12:15], v15 offset:768
    s_mov_b32 m0, s50
    s_movk_i32 s35, 0x4000
    buffer_load_dwordx4 v2, s[16:19], s35 offen offset:0 lds
    buffer_load_dwordx4 v2, s[16:19], s35 offen offset:1024 lds
    s_mov_b32 m0, s51
    s_movk_i32 s35, 0x6000
    buffer_load_dwordx4 v2, s[16:19], s35 offen offset:0 lds
    buffer_load_dwordx4 v2, s[16:19], s35 offen offset:1024 lds
    s_waitcnt lgkmcnt(3)
    v_mfma_f32_16x16x32_bf16 v[64:67], a[208:211], a[0:3], -4.0
    s_waitcnt lgkmcnt(2)
    s_mov_b32 s36, 0x8000
    ds_read_b128 a[80:83], v3 offset:16384
    ds_read_b128 a[84:87], v3 offset:17408
    v_mfma_f32_16x16x32_bf16 v[64:67], a[212:215], a[4:7], v[64:67]
    s_waitcnt lgkmcnt(3)
    buffer_load_dwordx4 v[160:163], v11, s[12:15], s36 offen offset:0
    v_mfma_f32_16x16x32_bf16 v[64:67], a[216:219], a[8:11], v[64:67]
    s_waitcnt lgkmcnt(2)
    ds_read_b128 a[112:115], v3 offset:24576
    ds_read_b128 a[88:91], v3 offset:18432
    v_mfma_f32_16x16x32_bf16 v[64:67], a[220:223], a[12:15], v[64:67]
    buffer_load_dwordx4 v[164:167], v11, s[12:15], s36 offen offset:64
    v_mfma_f32_16x16x32_bf16 v[68:71], a[236:239], a[12:15], -4.0
    ds_read_b128 a[92:95], v3 offset:19456
    ds_read_b128 a[116:119], v3 offset:25600
    v_mfma_f32_16x16x32_bf16 v[68:71], a[232:235], a[8:11], v[68:71]
    ds_read_b128 a[108:111], v3 offset:23552
    ds_read_b128 a[120:123], v3 offset:26624
    v_mfma_f32_16x16x32_bf16 v[68:71], a[228:231], a[4:7], v[68:71]
    v_exp_f32 v64, v64
    v_mfma_f32_16x16x32_bf16 v[68:71], a[224:227], a[0:3], v[68:71]
    ds_read_b128 a[104:107], v3 offset:22528
    ds_read_b128 a[100:103], v3 offset:21504
    v_mfma_f32_16x16x32_bf16 v[72:75], a[240:243], a[0:3], -4.0
    v_exp_f32 v65, v65
    v_mfma_f32_16x16x32_bf16 v[72:75], a[244:247], a[4:7], v[72:75]
    s_waitcnt vmcnt(10)
    ds_read_b128 a[124:127], v3 offset:27648
    ds_read_b128 a[96:99], v3 offset:20480
    v_mfma_f32_16x16x32_bf16 v[72:75], a[248:251], a[8:11], v[72:75]
    s_mov_b32 s36, 0xa000
    v_exp_f32 v66, v66
    v_mfma_f32_16x16x32_bf16 v[72:75], a[252:255], a[12:15], v[72:75]
    s_barrier
    v_mfma_f32_16x16x32_bf16 v[76:79], v[92:95], a[12:15], -4.0
    ds_read_b128 v[192:195], v5 offset:512
    ds_read_b128 v[196:199], v5 offset:4608
    ds_read_b64_tr_b16 a[176:177], v5 offset:8192
    v_mfma_f32_16x16x32_bf16 v[76:79], v[88:91], a[8:11], v[76:79]
    ds_read_b64_tr_b16 a[178:179], v5 offset:12288
    ds_read_b64_tr_b16 a[144:145], v5 offset:0
    ds_read_b128 a[140:143], v3 offset:31744
    ds_read_b64_tr_b16 a[192:193], v5 offset:8704
    v_mfma_f32_16x16x32_bf16 v[76:79], v[84:87], a[4:7], v[76:79]
    ds_read_b64_tr_b16 a[146:147], v5 offset:4096
    v_exp_f32 v67, v67
    v_exp_f32 v72, v72
    v_mfma_f32_16x16x32_bf16 v[76:79], v[80:83], a[0:3], v[76:79]
    s_waitcnt lgkmcnt(10)
    ds_read_b64_tr_b16 a[148:149], v5 offset:8
    ds_read_b64_tr_b16 a[150:151], v5 offset:4104
    ds_read_b64_tr_b16 a[194:195], v5 offset:12800
    v_cvt_pk_bf16_f32 v48, v64, v65
    v_cvt_pk_bf16_f32 v49, v66, v67
    v_exp_f32 v73, v73
    v_mfma_f32_16x16x32_bf16 v[64:67], a[80:83], a[0:3], -4.0
    ds_read_b64_tr_b16 a[180:181], v5 offset:8200
    ds_read_b128 a[136:139], v3 offset:30720
    ds_read_b64_tr_b16 a[160:161], v5 offset:512
    v_cvt_pk_bf16_f32 v52, v72, v73
    v_exp_f32 v74, v74
    v_mfma_f32_16x16x32_bf16 v[64:67], a[84:87], a[4:7], v[64:67]
    buffer_load_dwordx4 v[168:171], v11, s[12:15], s36 offen offset:0
    ds_read_b64_tr_b16 a[182:183], v5 offset:12296
    ds_read_b64_tr_b16 a[184:185], v5 offset:8448
    v_exp_f32 v75, v75
    v_mfma_f32_16x16x32_bf16 v[64:67], a[88:91], a[8:11], v[64:67]
    ds_read_b64_tr_b16 a[186:187], v5 offset:12544
    ds_read_b64_tr_b16 a[152:153], v5 offset:256
    ds_read_b128 a[132:135], v3 offset:29696
    ds_read_b64_tr_b16 a[162:163], v5 offset:4608
    v_exp_f32 v68, v68
    v_exp_f32 v69, v69
    v_exp_f32 v70, v70
    v_exp_f32 v71, v71
    v_cvt_pk_bf16_f32 v53, v74, v75
    v_exp_f32 v76, v76
    v_mfma_f32_16x16x32_bf16 v[64:67], a[92:95], a[12:15], v[64:67]
    s_waitcnt lgkmcnt(15)
    buffer_load_dwordx4 v[172:175], v11, s[12:15], s36 offen offset:64
    ds_read_b64_tr_b16 a[154:155], v5 offset:4352
    ds_read_b64_tr_b16 a[164:165], v5 offset:520
    v_cvt_pk_bf16_f32 v50, v68, v69
    v_cvt_pk_bf16_f32 v51, v70, v71
    v_max3_f32 v192, abs(v192), abs(v193), abs(v194)
    v_exp_f32 v77, v77
    v_mfma_f32_16x16x32_bf16 v[68:71], a[108:111], a[12:15], -4.0
    ds_read_b64_tr_b16 a[156:157], v5 offset:264
    ds_read_b64_tr_b16 a[158:159], v5 offset:4360
    v_max3_f32 v195, abs(v195), abs(v196), abs(v197)
    v_max3_f32 v192, v192, abs(v198), abs(v199)
    v_cvt_pk_bf16_f32 v54, v76, v77
    v_exp_f32 v78, v78
    v_mfma_f32_16x16x32_bf16 v[68:71], a[104:107], a[8:11], v[68:71]
    ds_read_b64_tr_b16 a[188:189], v5 offset:8456
    ds_read_b128 a[128:131], v3 offset:28672
    ds_read_b64_tr_b16 a[166:167], v5 offset:4616
    v_max_f32 v192, v192, v195
    v_exp_f32 v79, v79
    v_mfma_f32_16x16x32_bf16 v[68:71], a[100:103], a[4:7], v[68:71]
    ds_read_b64_tr_b16 a[190:191], v5 offset:12552
    ds_read_b64_tr_b16 a[196:197], v5 offset:8712
    v_cmp_gt_f32 vcc, s46, v192
    v_mul_f32 v192, 4.0, v192
    v_cvt_pk_bf16_f32 v55, v78, v79
    v_mfma_f32_16x16x32_bf16 v[68:71], a[96:99], a[0:3], v[68:71]
    v_cndmask_b32 v32, 0, v192, vcc
    v_cndmask_b32 v33, 0, v192, vcc
    v_cndmask_b32 v34, 0, v192, vcc
    v_cndmask_b32 v35, 0, v192, vcc
    v_smfmac_f32_16x16x64_bf16 v[36:39], v[24:27], v[48:55], v9
    ds_read_b64_tr_b16 a[198:199], v5 offset:12808
    ds_read_b64_tr_b16 a[200:201], v5 offset:8960
    v_mfma_f32_16x16x32_bf16 v[96:99], a[176:179], v[52:55], v[32:35]
    s_waitcnt lgkmcnt(15)
    v_exp_f32 v64, v64
    v_mfma_f32_16x16x32_bf16 v[96:99], a[144:147], v[48:51], v[96:99]
    ds_read_b64_tr_b16 a[202:203], v5 offset:13056
    ds_read_b64_tr_b16 a[168:169], v5 offset:768
    v_mfma_f32_16x16x32_bf16 v[100:103], a[148:151], v[48:51], v[32:35]
    v_exp_f32 v65, v65
    v_mfma_f32_16x16x32_bf16 v[100:103], a[180:183], v[52:55], v[100:103]
    s_waitcnt lgkmcnt(9)
    ds_read_b64_tr_b16 a[170:171], v5 offset:4864
    ds_read_b64_tr_b16 a[172:173], v5 offset:776
    v_mfma_f32_16x16x32_bf16 v[104:107], a[184:187], v[52:55], v[32:35]
    v_exp_f32 v66, v66
    v_mfma_f32_16x16x32_bf16 v[104:107], a[152:155], v[48:51], v[104:107]
    ds_read_b64_tr_b16 a[174:175], v5 offset:4872
    ds_read_b64_tr_b16 a[204:205], v5 offset:8968
    v_mfma_f32_16x16x32_bf16 v[108:111], a[156:159], v[48:51], v[32:35]
    s_waitcnt lgkmcnt(8)
    v_exp_f32 v67, v67
    v_mfma_f32_16x16x32_bf16 v[108:111], a[188:191], v[52:55], v[108:111]
    ds_read_b64_tr_b16 a[206:207], v5 offset:13064
    v_cvt_pk_bf16_f32 v56, v64, v65
    v_mfma_f32_16x16x32_bf16 v[72:75], a[112:115], a[0:3], -4.0
    v_exp_f32 v68, v68
    v_mfma_f32_16x16x32_bf16 v[72:75], a[116:119], a[4:7], v[72:75]
    s_mov_b32 s36, 0xc000
    v_exp_f32 v69, v69
    v_mfma_f32_16x16x32_bf16 v[72:75], a[120:123], a[8:11], v[72:75]
    v_cvt_pk_bf16_f32 v57, v66, v67
    v_cvt_pk_bf16_f32 v58, v68, v69
    v_mfma_f32_16x16x32_bf16 v[72:75], a[124:127], a[12:15], v[72:75]
    v_exp_f32 v70, v70
    v_mfma_f32_16x16x32_bf16 v[76:79], a[140:143], a[12:15], -4.0
    v_exp_f32 v71, v71
    v_mfma_f32_16x16x32_bf16 v[76:79], a[136:139], a[8:11], v[76:79]
    s_mov_b32 s35, 0x8000
    v_cvt_pk_bf16_f32 v59, v70, v71
    v_mfma_f32_16x16x32_bf16 v[76:79], a[132:135], a[4:7], v[76:79]
    s_waitcnt vmcnt(3)
    v_exp_f32 v72, v72
    v_mfma_f32_16x16x32_bf16 v[76:79], a[128:131], a[0:3], v[76:79]
    s_sub_u32 m0, s48, 0xc000
    v_exp_f32 v73, v73
    v_mfma_f32_16x16x32_bf16 v[16:19], v[160:163], v[240:243], 0
    buffer_load_dwordx4 v[176:179], v11, s[12:15], s36 offen offset:0
    v_cvt_pk_bf16_f32 v60, v72, v73
    v_mfma_f32_16x16x32_bf16 v[16:19], v[160:163], v[244:247], v[16:19]
    v_exp_f32 v74, v74
    v_mfma_f32_16x16x32_bf16 v[20:23], v[160:163], v[248:251], 0
    buffer_load_dwordx4 v[180:183], v11, s[12:15], s36 offen offset:64
    ds_read_b128 a[16:19], v15 offset:49152
    buffer_load_dwordx4 v2, s[16:19], s35 offen offset:0 lds
    v_mfma_f32_16x16x32_bf16 v[20:23], v[160:163], v[252:255], v[20:23]
    s_barrier
    v_mfma_f32_16x16x32_bf16 v[112:115], a[192:195], v[52:55], v[32:35]
    v_exp_f32 v75, v75
    v_mfma_f32_16x16x32_bf16 v[112:115], a[160:163], v[48:51], v[112:115]
    s_waitcnt lgkmcnt(1)
    buffer_load_dwordx4 v2, s[16:19], s35 offen offset:1024 lds
    ds_read_b64_tr_b16 a[176:177], v5 offset:24576
    v_mfma_f32_16x16x32_bf16 v[116:119], a[164:167], v[48:51], v[32:35]
    s_mov_b32 m0, s24
    ds_read_b128 a[20:23], v15 offset:49408
    ds_read_b64_tr_b16 a[178:179], v5 offset:28672
    v_mfma_f32_16x16x32_bf16 v[116:119], a[196:199], v[52:55], v[116:119]
    v_exp_f32 v76, v76
    v_mfma_f32_16x16x32_bf16 v[120:123], a[200:203], v[52:55], v[32:35]
    ds_read_b64_tr_b16 a[144:145], v5 offset:16384
    v_cvt_pk_bf16_f32 v160, v16, v20
    v_cvt_pk_bf16_f32 v161, v17, v21
    v_mfma_f32_16x16x32_bf16 v[120:123], a[168:171], v[48:51], v[120:123]
    s_mov_b32 s35, 0xa000
    ds_read_b128 a[24:27], v15 offset:49664
    ds_write_addtid_b32 v160 offset:32768
    ds_read_b64_tr_b16 a[146:147], v5 offset:20480
    v_cvt_pk_bf16_f32 v162, v18, v22
    v_cvt_pk_bf16_f32 v163, v19, v23
    v_mfma_f32_16x16x32_bf16 v[124:127], a[172:175], v[48:51], v[32:35]
    s_waitcnt vmcnt(6)
    ds_read_b128 a[28:31], v15 offset:49920
    ds_write_addtid_b32 v161 offset:33024
    ds_write_addtid_b32 v162 offset:33280
    ds_read_b64_tr_b16 a[148:149], v5 offset:16392
    v_mfma_f32_16x16x32_bf16 v[124:127], a[204:207], v[52:55], v[124:127]
    s_barrier
    v_mfma_f32_16x16x32_bf16 v[16:19], v[164:167], v[240:243], 0
    ds_write_addtid_b32 v163 offset:33536
    ds_read_b64_tr_b16 a[150:151], v5 offset:20488
    v_mfma_f32_16x16x32_bf16 v[16:19], v[164:167], v[244:247], v[16:19]
    s_sub_u32 m0, s48, 0xa000
    ds_read_b64_tr_b16 a[180:181], v5 offset:24584
    ds_read_b64_tr_b16 a[182:183], v5 offset:28680
    v_mfma_f32_16x16x32_bf16 v[20:23], v[164:167], v[248:251], 0
    s_mov_b32 s36, 0xe000
    v_exp_f32 v77, v77
    v_mfma_f32_16x16x32_bf16 v[20:23], v[164:167], v[252:255], v[20:23]
    s_waitcnt lgkmcnt(12)
    buffer_load_dwordx4 v2, s[16:19], s35 offen offset:0 lds
    v_cvt_pk_bf16_f32 v61, v74, v75
    v_mfma_f32_16x16x32_bf16 v[64:67], a[80:83], a[16:19], -4.0
    ds_read_b64_tr_b16 a[184:185], v5 offset:24832
    ds_read_b64_tr_b16 a[186:187], v5 offset:28928
    v_mfma_f32_16x16x32_bf16 v[64:67], a[84:87], a[20:23], v[64:67]
    s_waitcnt lgkmcnt(9)
    buffer_load_dwordx4 v2, s[16:19], s35 offen offset:1024 lds
    ds_read_b64_tr_b16 a[192:193], v5 offset:25088
    v_mfma_f32_16x16x32_bf16 v[64:67], a[88:91], a[24:27], v[64:67]
    s_mov_b32 m0, s24
    v_exp_f32 v78, v78
    v_mfma_f32_16x16x32_bf16 v[64:67], a[92:95], a[28:31], v[64:67]
    s_mov_b32 vcc_lo, 0xff00ff
    ds_read_b64_tr_b16 a[152:153], v5 offset:16640
    ds_read_b64_tr_b16 a[194:195], v5 offset:29184
    v_mfma_f32_16x16x32_bf16 v[68:71], a[108:111], a[28:31], -4.0
    s_mov_b32 vcc_hi, 0xff00ff
    buffer_load_dwordx4 v[184:187], v11, s[12:15], s36 offen offset:0
    ds_read_b64_tr_b16 a[154:155], v5 offset:20736
    ds_read_b64_tr_b16 a[160:161], v5 offset:16896
    v_cvt_pk_bf16_f32 v164, v16, v20
    v_cvt_pk_bf16_f32 v165, v17, v21
    v_mfma_f32_16x16x32_bf16 v[68:71], a[104:107], a[24:27], v[68:71]
    ds_write_addtid_b32 v164 offset:33792
    ds_read_b64_tr_b16 a[156:157], v5 offset:16648
    v_cvt_pk_bf16_f32 v62, v76, v77
    v_cvt_pk_bf16_f32 v166, v18, v22
    v_cvt_pk_bf16_f32 v167, v19, v23
    v_mfma_f32_16x16x32_bf16 v[68:71], a[100:103], a[20:23], v[68:71]
    buffer_load_dwordx4 v[188:191], v11, s[12:15], s36 offen offset:64
    ds_write_addtid_b32 v165 offset:34048
    ds_read_b64_tr_b16 a[162:163], v5 offset:20992
    v_exp_f32 v79, v79
    v_mfma_f32_16x16x32_bf16 v[68:71], a[96:99], a[16:19], v[68:71]
    s_waitcnt vmcnt(9)
    ds_write_addtid_b32 v166 offset:34304
    ds_read_b64_tr_b16 a[158:159], v5 offset:20744
    ds_read_b64_tr_b16 a[164:165], v5 offset:16904
    v_cvt_pk_bf16_f32 v63, v78, v79
    v_mfma_f32_16x16x32_bf16 v[16:19], v[168:171], v[240:243], 0
    ds_write_addtid_b32 v167 offset:34560
    ds_read_b64_tr_b16 a[188:189], v5 offset:24840
    v_mfma_f32_16x16x32_bf16 v[16:19], v[168:171], v[244:247], v[16:19]
    s_mov_b32 m0, s26
    ds_read_b64_tr_b16 a[166:167], v5 offset:21000
    ds_read_b64_tr_b16 a[190:191], v5 offset:28936
    v_mfma_f32_16x16x32_bf16 v[20:23], v[168:171], v[248:251], 0
    ds_read_b64_tr_b16 a[196:197], v5 offset:25096
    ds_read_b64_tr_b16 a[198:199], v5 offset:29192
    v_mfma_f32_16x16x32_bf16 v[20:23], v[168:171], v[252:255], v[20:23]
    v_exp_f32 v64, v64
    v_smfmac_f32_16x16x64_bf16 v[36:39], v[24:27], v[56:63], v9
    buffer_load_dwordx4 v2, s[8:11], s33 offen offset:0 nt lds
    v_mfma_f32_16x16x32_bf16 v[96:99], a[176:179], v[60:63], v[96:99]
    ds_read_b64_tr_b16 a[200:201], v5 offset:25344
    ds_read_b64_tr_b16 a[202:203], v5 offset:29440
    v_mfma_f32_16x16x32_bf16 v[96:99], a[144:147], v[56:59], v[96:99]
    s_waitcnt lgkmcnt(11)
    buffer_load_dwordx4 v2, s[8:11], s33 offen offset:1024 nt lds
    v_cvt_pk_bf16_f32 v168, v16, v20
    v_mfma_f32_16x16x32_bf16 v[100:103], a[148:151], v[56:59], v[100:103]
    s_mov_b32 m0, s24
    v_exp_f32 v65, v65
    v_mfma_f32_16x16x32_bf16 v[100:103], a[180:183], v[60:63], v[100:103]
    ds_read_b64_tr_b16 a[168:169], v5 offset:17152
    v_cvt_pk_bf16_f32 v169, v17, v21
    v_mfma_f32_16x16x32_bf16 v[104:107], a[184:187], v[60:63], v[104:107]
    ds_write_addtid_b32 v168 offset:40960
    v_cvt_pk_bf16_f32 v170, v18, v22
    v_cvt_pk_bf16_f32 v171, v19, v23
    v_mfma_f32_16x16x32_bf16 v[104:107], a[152:155], v[56:59], v[104:107]
    s_waitcnt lgkmcnt(4)
    ds_write_addtid_b32 v169 offset:41216
    ds_read_b64_tr_b16 a[170:171], v5 offset:21248
    v_mfma_f32_16x16x32_bf16 v[108:111], a[156:159], v[56:59], v[108:111]
    ds_write_addtid_b32 v170 offset:41472
    ds_read_b64_tr_b16 a[172:173], v5 offset:17160
    v_mfma_f32_16x16x32_bf16 v[108:111], a[188:191], v[60:63], v[108:111]
    s_waitcnt vmcnt(10)
    ds_write_addtid_b32 v171 offset:41728
    ds_read_b64_tr_b16 a[174:175], v5 offset:21256
    v_mfma_f32_16x16x32_bf16 v[16:19], v[172:175], v[240:243], 0
    v_exp_f32 v66, v66
    v_mfma_f32_16x16x32_bf16 v[16:19], v[172:175], v[244:247], v[16:19]
    ds_read_b64_tr_b16 a[204:205], v5 offset:25352
    ds_read_b64_tr_b16 a[206:207], v5 offset:29448
    v_mfma_f32_16x16x32_bf16 v[20:23], v[172:175], v[248:251], 0
    v_exp_f32 v67, v67
    v_mfma_f32_16x16x32_bf16 v[20:23], v[172:175], v[252:255], v[20:23]
    v_cvt_pk_bf16_f32 v48, v64, v65
    v_cvt_pk_bf16_f32 v49, v66, v67
    v_mfma_f32_16x16x32_bf16 v[72:75], a[112:115], a[16:19], -4.0
    v_exp_f32 v68, v68
    v_mfma_f32_16x16x32_bf16 v[72:75], a[116:119], a[20:23], v[72:75]
    v_exp_f32 v69, v69
    v_mfma_f32_16x16x32_bf16 v[72:75], a[120:123], a[24:27], v[72:75]
    v_cvt_pk_bf16_f32 v50, v68, v69
    v_cvt_pk_bf16_f32 v172, v16, v20
    v_mfma_f32_16x16x32_bf16 v[72:75], a[124:127], a[28:31], v[72:75]
    v_exp_f32 v70, v70
    v_cvt_pk_bf16_f32 v173, v17, v21
    v_mfma_f32_16x16x32_bf16 v[76:79], a[140:143], a[28:31], -4.0
    s_barrier
    v_mfma_f32_16x16x32_bf16 v[76:79], a[136:139], a[24:27], v[76:79]
    s_mov_b32 s35, 0xc000
    ds_write_addtid_b32 v172 offset:41984
    v_exp_f32 v71, v71
    v_cvt_pk_bf16_f32 v174, v18, v22
    v_cvt_pk_bf16_f32 v175, v19, v23
    v_mfma_f32_16x16x32_bf16 v[76:79], a[132:135], a[20:23], v[76:79]
    ds_write_addtid_b32 v173 offset:42240
    ds_read_b128 a[80:83], v3 offset:32768
    v_cvt_pk_bf16_f32 v51, v70, v71
    v_mfma_f32_16x16x32_bf16 v[76:79], a[128:131], a[16:19], v[76:79]
L_st0:
    s_cbranch_execz L_st1
    ds_write_addtid_b32 v174 offset:42496
    ds_write_addtid_b32 v175 offset:42752
    v_mfma_f32_16x16x32_bf16 v[112:115], a[192:195], v[60:63], v[112:115]
    s_sub_u32 m0, s48, 0x8000
    ds_read_b128 a[84:87], v3 offset:33792
    ds_read_b128 a[88:91], v3 offset:34816
    v_mfma_f32_16x16x32_bf16 v[112:115], a[160:163], v[56:59], v[112:115]
    v_exp_f32 v72, v72
    v_mfma_f32_16x16x32_bf16 v[116:119], a[164:167], v[56:59], v[116:119]
    v_exp_f32 v73, v73
    v_mfma_f32_16x16x32_bf16 v[116:119], a[196:199], v[60:63], v[116:119]
    s_waitcnt lgkmcnt(7)
    buffer_load_dwordx4 v2, s[16:19], s35 offen offset:0 lds
    ds_read_b128 a[92:95], v3 offset:35840
    v_mfma_f32_16x16x32_bf16 v[120:123], a[200:203], v[60:63], v[120:123]
    ds_read_b128 a[108:111], v3 offset:39936
    ds_read_b128 a[104:107], v3 offset:38912
    v_mfma_f32_16x16x32_bf16 v[120:123], a[168:171], v[56:59], v[120:123]
    s_waitcnt vmcnt(10) lgkmcnt(5)
    buffer_load_dwordx4 v2, s[16:19], s35 offen offset:1024 lds
    v_cvt_pk_bf16_f32 v52, v72, v73
    v_mfma_f32_16x16x32_bf16 v[124:127], a[172:175], v[56:59], v[124:127]
    s_sub_u32 m0, s48, 0x6000
    ds_read_b128 a[100:103], v3 offset:37888
    ds_read_b128 a[96:99], v3 offset:36864
    v_mfma_f32_16x16x32_bf16 v[124:127], a[204:207], v[60:63], v[124:127]
    s_barrier
    v_mfma_f32_16x16x32_bf16 v[16:19], v[176:179], v[240:243], 0
    s_mov_b32 s35, 0xe000
    v_exp_f32 v74, v74
    v_mfma_f32_16x16x32_bf16 v[16:19], v[176:179], v[244:247], v[16:19]
    v_exp_f32 v75, v75
    v_mfma_f32_16x16x32_bf16 v[20:23], v[176:179], v[248:251], 0
    buffer_load_dwordx4 v2, s[16:19], s35 offen offset:0 lds
    ds_read_b128 a[112:115], v3 offset:40960
    v_mfma_f32_16x16x32_bf16 v[20:23], v[176:179], v[252:255], v[20:23]
    v_exp_f32 v76, v76
    v_mfma_f32_16x16x32_bf16 v[64:67], a[80:83], a[0:3], -4.0
    s_waitcnt lgkmcnt(3)
    buffer_load_dwordx4 v2, s[16:19], s35 offen offset:1024 lds
    v_cvt_pk_bf16_f32 v53, v74, v75
    v_mfma_f32_16x16x32_bf16 v[64:67], a[84:87], a[4:7], v[64:67]
    s_mov_b32 m0, s24
    ds_read_b128 a[116:119], v3 offset:41984
    ds_read_b128 a[120:123], v3 offset:43008
    v_mfma_f32_16x16x32_bf16 v[64:67], a[88:91], a[8:11], v[64:67]
    v_exp_f32 v77, v77
    v_mfma_f32_16x16x32_bf16 v[64:67], a[92:95], a[12:15], v[64:67]
    s_mov_b32 s36, 0x10000
    v_cvt_pk_bf16_f32 v176, v16, v20
    v_cvt_pk_bf16_f32 v177, v17, v21
    v_mfma_f32_16x16x32_bf16 v[68:71], a[108:111], a[12:15], -4.0
    v_exp_f32 v78, v78
    v_mfma_f32_16x16x32_bf16 v[68:71], a[104:107], a[8:11], v[68:71]
    s_waitcnt lgkmcnt(3)
    ds_write_addtid_b32 v176 offset:49152
    v_cvt_pk_bf16_f32 v178, v18, v22
    v_cvt_pk_bf16_f32 v179, v19, v23
    v_mfma_f32_16x16x32_bf16 v[68:71], a[100:103], a[4:7], v[68:71]
    ds_write_addtid_b32 v177 offset:49408
    ds_read_b128 a[124:127], v3 offset:44032
    v_mfma_f32_16x16x32_bf16 v[68:71], a[96:99], a[0:3], v[68:71]
    s_waitcnt vmcnt(12)
    ds_write_addtid_b32 v178 offset:49664
    v_cvt_pk_bf16_f32 v54, v76, v77
    v_mfma_f32_16x16x32_bf16 v[16:19], v[180:183], v[240:243], 0
    ds_write_addtid_b32 v179 offset:49920
    ds_read_b128 a[140:143], v3 offset:48128
    v_mfma_f32_16x16x32_bf16 v[16:19], v[180:183], v[244:247], v[16:19]
    v_exp_f32 v79, v79
    v_mfma_f32_16x16x32_bf16 v[20:23], v[180:183], v[248:251], 0
    buffer_load_dwordx4 v[192:195], v11, s[12:15], s36 offen offset:0
    v_cvt_pk_bf16_f32 v55, v78, v79
    v_mfma_f32_16x16x32_bf16 v[20:23], v[180:183], v[252:255], v[20:23]
    ds_read_b128 a[136:139], v3 offset:47104
    ds_read_b128 a[132:135], v3 offset:46080
    v_smfmac_f32_16x16x64_bf16 v[38:41], v[24:27], v[48:55], v9
    buffer_load_dwordx4 v[196:199], v11, s[12:15], s36 offen offset:64
    v_mfma_f32_16x16x32_bf16 v[128:131], a[176:179], v[52:55], v[32:35]
    v_exp_f32 v64, v64
    v_mfma_f32_16x16x32_bf16 v[128:131], a[144:147], v[48:51], v[128:131]
    v_cvt_pk_bf16_f32 v180, v16, v20
    v_cvt_pk_bf16_f32 v181, v17, v21
    v_mfma_f32_16x16x32_bf16 v[132:135], a[148:151], v[48:51], v[32:35]
    v_exp_f32 v65, v65
    v_mfma_f32_16x16x32_bf16 v[132:135], a[180:183], v[52:55], v[132:135]
    ds_read_b128 a[128:131], v3 offset:45056
    v_cvt_pk_bf16_f32 v182, v18, v22
    v_mfma_f32_16x16x32_bf16 v[136:139], a[184:187], v[52:55], v[32:35]
    ds_write_addtid_b32 v180 offset:50176
    v_cvt_pk_bf16_f32 v183, v19, v23
    v_mfma_f32_16x16x32_bf16 v[136:139], a[152:155], v[48:51], v[136:139]
    ds_write_addtid_b32 v181 offset:50432
    ds_write_addtid_b32 v182 offset:50688
    v_mfma_f32_16x16x32_bf16 v[140:143], a[156:159], v[48:51], v[32:35]
    v_exp_f32 v66, v66
    v_mfma_f32_16x16x32_bf16 v[140:143], a[188:191], v[52:55], v[140:143]
    s_waitcnt lgkmcnt(4)
    ds_write_addtid_b32 v183 offset:50944
    v_cvt_pk_bf16_f32 v56, v64, v65
    v_mfma_f32_16x16x32_bf16 v[72:75], a[112:115], a[0:3], -4.0
    s_mov_b32 m0, s26
    v_exp_f32 v67, v67
    v_mfma_f32_16x16x32_bf16 v[72:75], a[116:119], a[4:7], v[72:75]
    s_mov_b32 s36, 0x12000
    buffer_load_dwordx4 v2, s[8:11], s33 offen offset:2048 nt lds
    v_cvt_pk_bf16_f32 v57, v66, v67
    v_mfma_f32_16x16x32_bf16 v[72:75], a[120:123], a[8:11], v[72:75]
    v_exp_f32 v68, v68
    v_mfma_f32_16x16x32_bf16 v[72:75], a[124:127], a[12:15], v[72:75]
    v_exp_f32 v69, v69
    v_mfma_f32_16x16x32_bf16 v[76:79], a[140:143], a[12:15], -4.0
    v_exp_f32 v70, v70
    v_mfma_f32_16x16x32_bf16 v[76:79], a[136:139], a[8:11], v[76:79]
    v_exp_f32 v71, v71
    v_mfma_f32_16x16x32_bf16 v[76:79], a[132:135], a[4:7], v[76:79]
    s_waitcnt lgkmcnt(1)
    buffer_load_dwordx4 v[200:203], v11, s[12:15], s36 offen offset:0
    v_cvt_pk_bf16_f32 v58, v68, v69
    v_mfma_f32_16x16x32_bf16 v[76:79], a[128:131], a[0:3], v[76:79]
    v_exp_f32 v72, v72
    v_mfma_f32_16x16x32_bf16 v[144:147], a[192:195], v[52:55], v[32:35]
    buffer_load_dwordx4 v[204:207], v11, s[12:15], s36 offen offset:64
    v_cvt_pk_bf16_f32 v59, v70, v71
    v_mfma_f32_16x16x32_bf16 v[144:147], a[160:163], v[48:51], v[144:147]
    v_exp_f32 v73, v73
    v_mfma_f32_16x16x32_bf16 v[148:151], a[164:167], v[48:51], v[32:35]
    s_waitcnt vmcnt(13) lgkmcnt(0)
    v_exp_f32 v74, v74
    v_mfma_f32_16x16x32_bf16 v[148:151], a[196:199], v[52:55], v[148:151]
    s_barrier
    v_mfma_f32_16x16x32_bf16 v[152:155], a[200:203], v[52:55], v[32:35]
    ds_read_b64_tr_b16 a[176:177], v10 offset:40960
    ds_read_b64_tr_b16 a[178:179], v10 offset:45056
    v_mfma_f32_16x16x32_bf16 v[152:155], a[168:171], v[48:51], v[152:155]
    v_exp_f32 v75, v75
    v_mfma_f32_16x16x32_bf16 v[156:159], a[172:175], v[48:51], v[32:35]
    ds_read_b64_tr_b16 a[144:145], v10 offset:32768
    ds_read_b64_tr_b16 a[146:147], v10 offset:36864
    v_mfma_f32_16x16x32_bf16 v[156:159], a[204:207], v[52:55], v[156:159]
    v_exp_f32 v76, v76
    v_mfma_f32_16x16x32_bf16 v[64:67], a[80:83], a[16:19], -4.0
    ds_read_b64_tr_b16 a[148:149], v10 offset:32776
    ds_read_b64_tr_b16 a[150:151], v10 offset:36872
    v_mfma_f32_16x16x32_bf16 v[64:67], a[84:87], a[20:23], v[64:67]
    ds_read_b64_tr_b16 a[192:193], v10 offset:41472
    ds_read_b64_tr_b16 a[180:181], v10 offset:40968
    v_mfma_f32_16x16x32_bf16 v[64:67], a[88:91], a[24:27], v[64:67]
    v_exp_f32 v77, v77
    v_mfma_f32_16x16x32_bf16 v[64:67], a[92:95], a[28:31], v[64:67]
    ds_read_b64_tr_b16 a[182:183], v10 offset:45064
    ds_read_b64_tr_b16 a[184:185], v10 offset:41216
    ds_read_b64_tr_b16 a[194:195], v10 offset:45568
    v_mfma_f32_16x16x32_bf16 v[68:71], a[108:111], a[28:31], -4.0
    ds_read_b64_tr_b16 a[186:187], v10 offset:45312
    ds_read_b64_tr_b16 a[160:161], v10 offset:33280
    v_cvt_pk_bf16_f32 v60, v72, v73
    v_mfma_f32_16x16x32_bf16 v[68:71], a[104:107], a[24:27], v[68:71]
    ds_read_b64_tr_b16 a[152:153], v10 offset:33024
    v_cvt_pk_bf16_f32 v61, v74, v75
    v_mfma_f32_16x16x32_bf16 v[68:71], a[100:103], a[20:23], v[68:71]
    ds_read_b64_tr_b16 a[154:155], v10 offset:37120
    ds_read_b64_tr_b16 a[162:163], v10 offset:37376
    v_mfma_f32_16x16x32_bf16 v[68:71], a[96:99], a[16:19], v[68:71]
    s_waitcnt vmcnt(12)
    ds_read_b64_tr_b16 a[156:157], v10 offset:33032
    ds_read_b64_tr_b16 a[164:165], v10 offset:33288
    v_mfma_f32_16x16x32_bf16 v[16:19], v[184:187], v[240:243], 0
    ds_read_b64_tr_b16 a[158:159], v10 offset:37128
    v_cvt_pk_bf16_f32 v62, v76, v77
    v_exp_f32 v78, v78
    v_mfma_f32_16x16x32_bf16 v[16:19], v[184:187], v[244:247], v[16:19]
    ds_read_b64_tr_b16 a[188:189], v10 offset:41224
    ds_read_b64_tr_b16 a[166:167], v10 offset:37384
    v_exp_f32 v79, v79
    v_mfma_f32_16x16x32_bf16 v[20:23], v[184:187], v[248:251], 0
    ds_read_b64_tr_b16 a[190:191], v10 offset:45320
    ds_read_b64_tr_b16 a[196:197], v10 offset:41480
    v_cvt_pk_bf16_f32 v63, v78, v79
    v_mfma_f32_16x16x32_bf16 v[20:23], v[184:187], v[252:255], v[20:23]
    ds_read_b128 a[80:83], v3 offset:49152
    ds_read_b64_tr_b16 a[198:199], v10 offset:45576
    v_smfmac_f32_16x16x64_bf16 v[36:39], v[24:27], v[56:63], v9
    s_waitcnt lgkmcnt(12)
    ds_read_b64_tr_b16 a[200:201], v10 offset:41728
    ds_read_b128 a[84:87], v3 offset:50176
    v_mfma_f32_16x16x32_bf16 v[96:99], a[176:179], v[60:63], v[96:99]
    s_mov_b32 m0, s24
    v_exp_f32 v64, v64
    v_mfma_f32_16x16x32_bf16 v[96:99], a[144:147], v[56:59], v[96:99]
    ds_read_b64_tr_b16 a[202:203], v10 offset:45824
    v_cvt_pk_bf16_f32 v184, v16, v20
    v_mfma_f32_16x16x32_bf16 v[100:103], a[148:151], v[56:59], v[100:103]
    v_exp_f32 v65, v65
    v_mfma_f32_16x16x32_bf16 v[100:103], a[180:183], v[60:63], v[100:103]
    ds_read_b64_tr_b16 a[168:169], v10 offset:33536
    ds_read_b128 a[88:91], v3 offset:51200
    v_cvt_pk_bf16_f32 v185, v17, v21
    v_mfma_f32_16x16x32_bf16 v[104:107], a[184:187], v[60:63], v[104:107]
    s_waitcnt lgkmcnt(9)
    ds_write_addtid_b32 v184 offset:57344
    v_cvt_pk_bf16_f32 v186, v18, v22
    v_cvt_pk_bf16_f32 v187, v19, v23
    v_mfma_f32_16x16x32_bf16 v[104:107], a[152:155], v[56:59], v[104:107]
    ds_write_addtid_b32 v185 offset:57600
    ds_read_b64_tr_b16 a[170:171], v10 offset:37632
    v_mfma_f32_16x16x32_bf16 v[108:111], a[156:159], v[56:59], v[108:111]
    s_waitcnt lgkmcnt(8)
    ds_write_addtid_b32 v186 offset:57856
    ds_read_b64_tr_b16 a[172:173], v10 offset:33544
    ds_read_b128 a[92:95], v3 offset:52224
    v_mfma_f32_16x16x32_bf16 v[108:111], a[188:191], v[60:63], v[108:111]
    s_waitcnt vmcnt(11)
    ds_write_addtid_b32 v187 offset:58112
    ds_read_b64_tr_b16 a[174:175], v10 offset:37640
    v_mfma_f32_16x16x32_bf16 v[16:19], v[188:191], v[240:243], 0
    s_mov_b32 m0, s26
    ds_read_b128 a[108:111], v3 offset:56320
    ds_read_b64_tr_b16 a[204:205], v10 offset:41736
    v_mfma_f32_16x16x32_bf16 v[16:19], v[188:191], v[244:247], v[16:19]
    s_mov_b32 s36, 0x14000
    v_exp_f32 v66, v66
    v_mfma_f32_16x16x32_bf16 v[20:23], v[188:191], v[248:251], 0
    buffer_load_dwordx4 v2, s[8:11], s33 offen offset:3072 nt lds
    v_cvt_pk_bf16_f32 v48, v64, v65
    v_mfma_f32_16x16x32_bf16 v[20:23], v[188:191], v[252:255], v[20:23]
    s_add_u32 s33, s33, s38
    ds_read_b64_tr_b16 a[206:207], v10 offset:45832
    ds_read_b128 a[104:107], v3 offset:55296
    v_mfma_f32_16x16x32_bf16 v[72:75], a[112:115], a[16:19], -4.0
    v_exp_f32 v67, v67
    v_mfma_f32_16x16x32_bf16 v[72:75], a[116:119], a[20:23], v[72:75]
    s_mov_b32 m0, s24
    ds_read_b128 a[100:103], v3 offset:54272
    v_cvt_pk_bf16_f32 v49, v66, v67
    v_mfma_f32_16x16x32_bf16 v[72:75], a[120:123], a[24:27], v[72:75]
    v_exp_f32 v68, v68
    v_mfma_f32_16x16x32_bf16 v[72:75], a[124:127], a[28:31], v[72:75]
    buffer_load_dwordx4 v[208:211], v11, s[12:15], s36 offen offset:0
    v_exp_f32 v69, v69
    v_mfma_f32_16x16x32_bf16 v[76:79], a[140:143], a[28:31], -4.0
    ds_read_b128 a[96:99], v3 offset:53248
    v_cvt_pk_bf16_f32 v50, v68, v69
    v_exp_f32 v70, v70
    v_cvt_pk_bf16_f32 v188, v16, v20
    v_cvt_pk_bf16_f32 v189, v17, v21
    v_mfma_f32_16x16x32_bf16 v[76:79], a[136:139], a[24:27], v[76:79]
    s_mov_b32 s35, 0x10000
    buffer_load_dwordx4 v[212:215], v11, s[12:15], s36 offen offset:64
    ds_write_addtid_b32 v188 offset:58368
    v_exp_f32 v71, v71
    v_cvt_pk_bf16_f32 v190, v18, v22
    v_cvt_pk_bf16_f32 v191, v19, v23
    v_mfma_f32_16x16x32_bf16 v[76:79], a[132:135], a[20:23], v[76:79]
    ds_write_addtid_b32 v189 offset:58624
    v_cvt_pk_bf16_f32 v51, v70, v71
    v_mfma_f32_16x16x32_bf16 v[76:79], a[128:131], a[16:19], v[76:79]
    ds_write_addtid_b32 v190 offset:58880
    ds_write_addtid_b32 v191 offset:59136
    v_mfma_f32_16x16x32_bf16 v[112:115], a[192:195], v[60:63], v[112:115]
    s_mov_b32 m0, s48
    v_exp_f32 v72, v72
    v_mfma_f32_16x16x32_bf16 v[112:115], a[160:163], v[56:59], v[112:115]
    v_exp_f32 v73, v73
    v_mfma_f32_16x16x32_bf16 v[116:119], a[164:167], v[56:59], v[116:119]
    buffer_load_dwordx4 v2, s[16:19], s35 offen offset:0 lds
    v_cvt_pk_bf16_f32 v52, v72, v73
    v_mfma_f32_16x16x32_bf16 v[116:119], a[196:199], v[60:63], v[116:119]
    s_waitcnt lgkmcnt(5)
    v_exp_f32 v74, v74
    v_mfma_f32_16x16x32_bf16 v[120:123], a[200:203], v[60:63], v[120:123]
    v_exp_f32 v75, v75
    v_mfma_f32_16x16x32_bf16 v[120:123], a[168:171], v[56:59], v[120:123]
    s_waitcnt lgkmcnt(0)
    buffer_load_dwordx4 v2, s[16:19], s35 offen offset:1024 lds
    v_cvt_pk_bf16_f32 v53, v74, v75
    v_mfma_f32_16x16x32_bf16 v[124:127], a[172:175], v[56:59], v[124:127]
    s_mov_b32 m0, s49
    v_exp_f32 v76, v76
    v_mfma_f32_16x16x32_bf16 v[124:127], a[204:207], v[60:63], v[124:127]
    s_barrier
    v_mfma_f32_16x16x32_bf16 v[64:67], a[80:83], a[0:3], -4.0
    s_mov_b32 s35, 0x12000
    v_exp_f32 v77, v77
    v_mfma_f32_16x16x32_bf16 v[64:67], a[84:87], a[4:7], v[64:67]
    buffer_load_dwordx4 v2, s[16:19], s35 offen offset:0 lds
    ds_read_b128 a[112:115], v3 offset:57344
    v_mfma_f32_16x16x32_bf16 v[64:67], a[88:91], a[8:11], v[64:67]
    v_exp_f32 v78, v78
    v_mfma_f32_16x16x32_bf16 v[64:67], a[92:95], a[12:15], v[64:67]
    buffer_load_dwordx4 v2, s[16:19], s35 offen offset:1024 lds
    ds_read_b128 a[116:119], v3 offset:58368
    v_mfma_f32_16x16x32_bf16 v[68:71], a[108:111], a[12:15], -4.0
    ds_read_b128 a[120:123], v3 offset:59392
    v_cvt_pk_bf16_f32 v54, v76, v77
    v_mfma_f32_16x16x32_bf16 v[68:71], a[104:107], a[8:11], v[68:71]
    v_exp_f32 v79, v79
    v_mfma_f32_16x16x32_bf16 v[68:71], a[100:103], a[4:7], v[68:71]
    ds_read_b128 a[124:127], v3 offset:60416
    v_cvt_pk_bf16_f32 v55, v78, v79
    v_mfma_f32_16x16x32_bf16 v[68:71], a[96:99], a[0:3], v[68:71]
    s_waitcnt vmcnt(12)
    ds_read_b128 a[140:143], v3 offset:64512
    ds_read_b128 a[136:139], v3 offset:63488
    v_smfmac_f32_16x16x64_bf16 v[38:41], v[24:27], v[48:55], v9
    s_barrier
    v_mfma_f32_16x16x32_bf16 v[128:131], a[176:179], v[52:55], v[128:131]
    v_exp_f32 v64, v64
    v_mfma_f32_16x16x32_bf16 v[128:131], a[144:147], v[48:51], v[128:131]
    ds_read_b128 a[132:135], v3 offset:62464
    ds_read_b128 a[128:131], v3 offset:61440
    v_mfma_f32_16x16x32_bf16 v[132:135], a[148:151], v[48:51], v[132:135]
    v_exp_f32 v65, v65
    v_mfma_f32_16x16x32_bf16 v[132:135], a[180:183], v[52:55], v[132:135]
    ds_read_b64_tr_b16 a[176:177], v10 offset:57344
    ds_read_b64_tr_b16 a[178:179], v10 offset:61440
    v_mfma_f32_16x16x32_bf16 v[136:139], a[184:187], v[52:55], v[136:139]
    v_exp_f32 v66, v66
    v_mfma_f32_16x16x32_bf16 v[136:139], a[152:155], v[48:51], v[136:139]
    ds_read_b64_tr_b16 a[144:145], v10 offset:49152
    v_cvt_pk_bf16_f32 v56, v64, v65
    v_mfma_f32_16x16x32_bf16 v[140:143], a[156:159], v[48:51], v[140:143]
    v_exp_f32 v67, v67
    v_mfma_f32_16x16x32_bf16 v[140:143], a[188:191], v[52:55], v[140:143]
    s_waitcnt lgkmcnt(5)
    ds_read_b64_tr_b16 a[146:147], v10 offset:53248
    v_cvt_pk_bf16_f32 v57, v66, v67
    v_mfma_f32_16x16x32_bf16 v[72:75], a[112:115], a[0:3], -4.0
    v_exp_f32 v68, v68
    v_mfma_f32_16x16x32_bf16 v[72:75], a[116:119], a[4:7], v[72:75]
    ds_read_b64_tr_b16 a[148:149], v10 offset:49160
    ds_read_b64_tr_b16 a[150:151], v10 offset:53256
    v_mfma_f32_16x16x32_bf16 v[72:75], a[120:123], a[8:11], v[72:75]
    v_exp_f32 v69, v69
    v_mfma_f32_16x16x32_bf16 v[72:75], a[124:127], a[12:15], v[72:75]
    ds_read_b64_tr_b16 a[180:181], v10 offset:57352
    v_cvt_pk_bf16_f32 v58, v68, v69
    v_mfma_f32_16x16x32_bf16 v[76:79], a[140:143], a[12:15], -4.0
    v_exp_f32 v70, v70
    v_mfma_f32_16x16x32_bf16 v[76:79], a[136:139], a[8:11], v[76:79]
    s_waitcnt lgkmcnt(4)
    ds_read_b64_tr_b16 a[182:183], v10 offset:61448
    ds_read_b64_tr_b16 a[184:185], v10 offset:57600
    v_mfma_f32_16x16x32_bf16 v[76:79], a[132:135], a[4:7], v[76:79]
    v_exp_f32 v71, v71
    v_mfma_f32_16x16x32_bf16 v[76:79], a[128:131], a[0:3], v[76:79]
    s_waitcnt vmcnt(11)
    ds_read_b64_tr_b16 a[186:187], v10 offset:61696
    v_cvt_pk_bf16_f32 v59, v70, v71
    v_mfma_f32_16x16x32_bf16 v[16:19], v[192:195], v[240:243], 0
    v_exp_f32 v72, v72
    v_mfma_f32_16x16x32_bf16 v[16:19], v[192:195], v[244:247], v[16:19]
    ds_read_b64_tr_b16 a[152:153], v10 offset:49408
    ds_read_b64_tr_b16 a[154:155], v10 offset:53504
    v_mfma_f32_16x16x32_bf16 v[20:23], v[192:195], v[248:251], 0
    v_exp_f32 v73, v73
    v_mfma_f32_16x16x32_bf16 v[20:23], v[192:195], v[252:255], v[20:23]
    ds_read_b64_tr_b16 a[156:157], v10 offset:49416
    v_cvt_pk_bf16_f32 v60, v72, v73
    v_mfma_f32_16x16x32_bf16 v[144:147], a[192:195], v[52:55], v[144:147]
    v_exp_f32 v74, v74
    v_mfma_f32_16x16x32_bf16 v[144:147], a[160:163], v[48:51], v[144:147]
    s_mov_b32 m0, s25
    ds_read_b64_tr_b16 a[158:159], v10 offset:53512
    ds_read_b64_tr_b16 a[192:193], v10 offset:57856
    v_mfma_f32_16x16x32_bf16 v[148:151], a[164:167], v[48:51], v[148:151]
    v_exp_f32 v75, v75
    v_mfma_f32_16x16x32_bf16 v[148:151], a[196:199], v[52:55], v[148:151]
    v_cvt_pk_bf16_f32 v192, v16, v20
    v_cvt_pk_bf16_f32 v193, v17, v21
    v_mfma_f32_16x16x32_bf16 v[152:155], a[200:203], v[52:55], v[152:155]
    v_exp_f32 v76, v76
    v_mfma_f32_16x16x32_bf16 v[152:155], a[168:171], v[48:51], v[152:155]
    ds_write_addtid_b32 v192 offset:6148
    v_cvt_pk_bf16_f32 v194, v18, v22
    v_cvt_pk_bf16_f32 v195, v19, v23
    v_mfma_f32_16x16x32_bf16 v[156:159], a[172:175], v[48:51], v[156:159]
    ds_write_addtid_b32 v193 offset:6404
    ds_write_addtid_b32 v194 offset:6660
    v_mfma_f32_16x16x32_bf16 v[156:159], a[204:207], v[52:55], v[156:159]
    s_waitcnt vmcnt(10)
    v_exp_f32 v77, v77
    v_mfma_f32_16x16x32_bf16 v[16:19], v[196:199], v[240:243], 0
    ds_write_addtid_b32 v195 offset:6916
    ds_read_b64_tr_b16 a[188:189], v10 offset:57608
    v_mfma_f32_16x16x32_bf16 v[16:19], v[196:199], v[244:247], v[16:19]
    v_exp_f32 v78, v78
    v_mfma_f32_16x16x32_bf16 v[20:23], v[196:199], v[248:251], 0
    ds_read_b64_tr_b16 a[194:195], v10 offset:61952
    v_cvt_pk_bf16_f32 v61, v74, v75
    v_mfma_f32_16x16x32_bf16 v[20:23], v[196:199], v[252:255], v[20:23]
    s_mov_b32 s36, 0x16000
    v_exp_f32 v79, v79
    v_mfma_f32_16x16x32_bf16 v[64:67], a[80:83], a[16:19], -4.0
    ds_read_b64_tr_b16 a[190:191], v10 offset:61704
    ds_read_b64_tr_b16 a[160:161], v10 offset:49664
    v_mfma_f32_16x16x32_bf16 v[64:67], a[84:87], a[20:23], v[64:67]
    ds_read_b64_tr_b16 a[162:163], v10 offset:53760
    v_cvt_pk_bf16_f32 v62, v76, v77
    v_mfma_f32_16x16x32_bf16 v[64:67], a[88:91], a[24:27], v[64:67]
    v_cvt_pk_bf16_f32 v196, v16, v20
    v_cvt_pk_bf16_f32 v197, v17, v21
    v_mfma_f32_16x16x32_bf16 v[64:67], a[92:95], a[28:31], v[64:67]
    v_cvt_pk_bf16_f32 v198, v18, v22
    v_cvt_pk_bf16_f32 v199, v19, v23
    v_mfma_f32_16x16x32_bf16 v[68:71], a[108:111], a[28:31], -4.0
    ds_write_addtid_b32 v196 offset:7172
    ds_write_addtid_b32 v197 offset:7428
    v_mfma_f32_16x16x32_bf16 v[68:71], a[104:107], a[24:27], v[68:71]
    buffer_load_dwordx4 v[216:219], v11, s[12:15], s36 offen offset:0
    v_cvt_pk_bf16_f32 v63, v78, v79
    v_mfma_f32_16x16x32_bf16 v[68:71], a[100:103], a[20:23], v[68:71]
    v_exp_f32 v64, v64
    v_mfma_f32_16x16x32_bf16 v[68:71], a[96:99], a[16:19], v[68:71]
    s_waitcnt vmcnt(9)
    ds_write_addtid_b32 v198 offset:7684
    ds_read_b64_tr_b16 a[164:165], v10 offset:49672
    v_mfma_f32_16x16x32_bf16 v[16:19], v[200:203], v[240:243], 0
    ds_write_addtid_b32 v199 offset:7940
    buffer_load_dwordx4 v[220:223], v11, s[12:15], s36 offen offset:64
    v_mfma_f32_16x16x32_bf16 v[16:19], v[200:203], v[244:247], v[16:19]
    s_mov_b32 s36, 0x18000
    ds_read_b64_tr_b16 a[166:167], v10 offset:53768
    ds_read_b64_tr_b16 a[196:197], v10 offset:57864
    v_mfma_f32_16x16x32_bf16 v[20:23], v[200:203], v[248:251], 0
    buffer_load_dwordx4 v[224:227], v11, s[12:15], s36 offen offset:0
    v_mfma_f32_16x16x32_bf16 v[20:23], v[200:203], v[252:255], v[20:23]
    v_exp_f32 v65, v65
    v_smfmac_f32_16x16x64_bf16 v[36:39], v[24:27], v[56:63], v9
    buffer_load_dwordx4 v[228:231], v11, s[12:15], s36 offen offset:64
    ds_read_b64_tr_b16 a[198:199], v10 offset:61960
    v_mfma_f32_16x16x32_bf16 v[96:99], a[176:179], v[60:63], v[96:99]
    s_waitcnt lgkmcnt(6)
    ds_read_b64_tr_b16 a[200:201], v10 offset:58112
    ds_read_b64_tr_b16 a[202:203], v10 offset:62208
    v_mfma_f32_16x16x32_bf16 v[96:99], a[144:147], v[56:59], v[96:99]
    v_exp_f32 v66, v66
    v_mfma_f32_16x16x32_bf16 v[100:103], a[148:151], v[56:59], v[100:103]
    v_cvt_pk_bf16_f32 v200, v16, v20
    v_cvt_pk_bf16_f32 v201, v17, v21
    v_mfma_f32_16x16x32_bf16 v[100:103], a[180:183], v[60:63], v[100:103]
    ds_read_b64_tr_b16 a[168:169], v10 offset:49920
    v_cvt_pk_bf16_f32 v202, v18, v22
    v_mfma_f32_16x16x32_bf16 v[104:107], a[184:187], v[60:63], v[104:107]
    s_mov_b32 s35, 0x14000
    ds_write_addtid_b32 v200 offset:14340
    v_cvt_pk_bf16_f32 v203, v19, v23
    v_mfma_f32_16x16x32_bf16 v[104:107], a[152:155], v[56:59], v[104:107]
    ds_write_addtid_b32 v201 offset:14596
    ds_read_b64_tr_b16 a[170:171], v10 offset:54016
    v_mfma_f32_16x16x32_bf16 v[108:111], a[156:159], v[56:59], v[108:111]
    ds_write_addtid_b32 v202 offset:14852
    ds_read_b64_tr_b16 a[172:173], v10 offset:49928
    v_mfma_f32_16x16x32_bf16 v[108:111], a[188:191], v[60:63], v[108:111]
    s_waitcnt vmcnt(11)
    ds_write_addtid_b32 v203 offset:15108
    ds_read_b64_tr_b16 a[174:175], v10 offset:54024
    v_mfma_f32_16x16x32_bf16 v[16:19], v[204:207], v[240:243], 0
    s_mov_b32 m0, s50
    v_exp_f32 v67, v67
    v_mfma_f32_16x16x32_bf16 v[16:19], v[204:207], v[244:247], v[16:19]
    ds_read_b64_tr_b16 a[204:205], v10 offset:58120
    ds_read_b64_tr_b16 a[206:207], v10 offset:62216
    v_mfma_f32_16x16x32_bf16 v[20:23], v[204:207], v[248:251], 0
    buffer_load_dwordx4 v2, s[16:19], s35 offen offset:0 lds
    v_cvt_pk_bf16_f32 v48, v64, v65
    v_mfma_f32_16x16x32_bf16 v[20:23], v[204:207], v[252:255], v[20:23]
    v_exp_f32 v68, v68
    v_mfma_f32_16x16x32_bf16 v[72:75], a[112:115], a[16:19], -4.0
    buffer_load_dwordx4 v2, s[16:19], s35 offen offset:1024 lds
    v_cvt_pk_bf16_f32 v49, v66, v67
    v_mfma_f32_16x16x32_bf16 v[72:75], a[116:119], a[20:23], v[72:75]
    s_mov_b32 m0, s25
    v_exp_f32 v69, v69
    v_mfma_f32_16x16x32_bf16 v[72:75], a[120:123], a[24:27], v[72:75]
    s_waitcnt vmcnt(12)
    ds_read_b128 a[32:35], v15 offset:0
    v_cvt_pk_bf16_f32 v50, v68, v69
    v_mfma_f32_16x16x32_bf16 v[72:75], a[124:127], a[28:31], v[72:75]
    v_exp_f32 v70, v70
    v_mfma_f32_16x16x32_bf16 v[76:79], a[140:143], a[28:31], -4.0
    v_cvt_pk_bf16_f32 v204, v16, v20
    v_cvt_pk_bf16_f32 v205, v17, v21
    v_mfma_f32_16x16x32_bf16 v[76:79], a[136:139], a[24:27], v[76:79]
    s_mov_b32 s35, 0x16000
    ds_read_b128 a[36:39], v15 offset:256
    ds_write_addtid_b32 v204 offset:15364
    v_exp_f32 v71, v71
    v_cvt_pk_bf16_f32 v206, v18, v22
    v_cvt_pk_bf16_f32 v207, v19, v23
    v_mfma_f32_16x16x32_bf16 v[76:79], a[132:135], a[20:23], v[76:79]
    ds_write_addtid_b32 v205 offset:15620
    v_cvt_pk_bf16_f32 v51, v70, v71
    v_mfma_f32_16x16x32_bf16 v[76:79], a[128:131], a[16:19], v[76:79]
    ds_write_addtid_b32 v206 offset:15876
    ds_read_b128 a[40:43], v15 offset:512
    v_mfma_f32_16x16x32_bf16 v[112:115], a[192:195], v[60:63], v[112:115]
    s_waitcnt lgkmcnt(6)
    ds_write_addtid_b32 v207 offset:16132
    ds_read_b128 a[44:47], v15 offset:768
    v_mfma_f32_16x16x32_bf16 v[112:115], a[160:163], v[56:59], v[112:115]
    s_mov_b32 m0, s51
    v_exp_f32 v72, v72
    v_mfma_f32_16x16x32_bf16 v[116:119], a[164:167], v[56:59], v[116:119]
    v_exp_f32 v73, v73
    v_mfma_f32_16x16x32_bf16 v[116:119], a[196:199], v[60:63], v[116:119]
    buffer_load_dwordx4 v2, s[16:19], s35 offen offset:0 lds
    v_cvt_pk_bf16_f32 v52, v72, v73
    v_mfma_f32_16x16x32_bf16 v[120:123], a[200:203], v[60:63], v[120:123]
    v_exp_f32 v74, v74
    v_mfma_f32_16x16x32_bf16 v[120:123], a[168:171], v[56:59], v[120:123]
    buffer_load_dwordx4 v2, s[16:19], s35 offen offset:1024 lds
    v_mfma_f32_16x16x32_bf16 v[124:127], a[172:175], v[56:59], v[124:127]
    s_waitcnt lgkmcnt(1)
    v_exp_f32 v75, v75
    v_mfma_f32_16x16x32_bf16 v[124:127], a[204:207], v[60:63], v[124:127]
    s_barrier
    v_mfma_f32_16x16x32_bf16 v[64:67], a[80:83], a[32:35], -4.0
    v_exp_f32 v76, v76
    v_mfma_f32_16x16x32_bf16 v[64:67], a[84:87], a[36:39], v[64:67]
    ds_read_b128 a[80:83], v4 offset:0
    v_cvt_pk_bf16_f32 v53, v74, v75
    v_mfma_f32_16x16x32_bf16 v[64:67], a[88:91], a[40:43], v[64:67]
    s_waitcnt lgkmcnt(1)
    v_exp_f32 v77, v77
    v_mfma_f32_16x16x32_bf16 v[64:67], a[92:95], a[44:47], v[64:67]
    ds_read_b128 a[84:87], v4 offset:1024
    v_cvt_pk_bf16_f32 v54, v76, v77
    v_mfma_f32_16x16x32_bf16 v[68:71], a[108:111], a[44:47], -4.0
    v_exp_f32 v78, v78
    v_mfma_f32_16x16x32_bf16 v[68:71], a[104:107], a[40:43], v[68:71]
    v_exp_f32 v79, v79
    v_mfma_f32_16x16x32_bf16 v[68:71], a[100:103], a[36:39], v[68:71]
    v_cvt_pk_bf16_f32 v55, v78, v79
    v_mfma_f32_16x16x32_bf16 v[68:71], a[96:99], a[32:35], v[68:71]
    v_exp_f32 v64, v64
    v_smfmac_f32_16x16x64_bf16 v[38:41], v[24:27], v[48:55], v9
    ds_read_b128 a[88:91], v4 offset:2048
    v_mfma_f32_16x16x32_bf16 v[128:131], a[176:179], v[52:55], v[128:131]
    v_exp_f32 v65, v65
    v_mfma_f32_16x16x32_bf16 v[128:131], a[144:147], v[48:51], v[128:131]
    v_exp_f32 v66, v66
    v_mfma_f32_16x16x32_bf16 v[132:135], a[148:151], v[48:51], v[132:135]
    ds_read_b128 a[92:95], v4 offset:3072
    v_cvt_pk_bf16_f32 v56, v64, v65
    v_mfma_f32_16x16x32_bf16 v[132:135], a[180:183], v[52:55], v[132:135]
    v_exp_f32 v67, v67
    v_mfma_f32_16x16x32_bf16 v[136:139], a[184:187], v[52:55], v[136:139]
    v_exp_f32 v68, v68
    v_mfma_f32_16x16x32_bf16 v[136:139], a[152:155], v[48:51], v[136:139]
    v_exp_f32 v69, v69
    v_mfma_f32_16x16x32_bf16 v[140:143], a[156:159], v[48:51], v[140:143]
    v_cvt_pk_bf16_f32 v57, v66, v67
    v_cvt_pk_bf16_f32 v58, v68, v69
    v_mfma_f32_16x16x32_bf16 v[140:143], a[188:191], v[52:55], v[140:143]
    v_exp_f32 v70, v70
    v_mfma_f32_16x16x32_bf16 v[72:75], a[112:115], a[32:35], -4.0
    v_exp_f32 v71, v71
    v_mfma_f32_16x16x32_bf16 v[72:75], a[116:119], a[36:39], v[72:75]
    ds_read_b128 a[108:111], v4 offset:7168
    v_cvt_pk_bf16_f32 v59, v70, v71
    v_mfma_f32_16x16x32_bf16 v[72:75], a[120:123], a[40:43], v[72:75]
    ds_read_b128 a[104:107], v4 offset:6144
    v_mfma_f32_16x16x32_bf16 v[72:75], a[124:127], a[44:47], v[72:75]
    ds_read_b128 a[112:115], v4 offset:8192
    v_mfma_f32_16x16x32_bf16 v[76:79], a[140:143], a[44:47], -4.0
    ds_read_b128 a[116:119], v4 offset:9216
    v_mfma_f32_16x16x32_bf16 v[76:79], a[136:139], a[40:43], v[76:79]
    ds_read_b128 a[100:103], v4 offset:5120
    v_mfma_f32_16x16x32_bf16 v[76:79], a[132:135], a[36:39], v[76:79]
    s_mov_b32 m0, s26
    v_exp_f32 v72, v72
    v_mfma_f32_16x16x32_bf16 v[76:79], a[128:131], a[32:35], v[76:79]
    s_waitcnt vmcnt(13)
    v_exp_f32 v73, v73
    v_mfma_f32_16x16x32_bf16 v[16:19], v[208:211], v[240:243], 0
L_st1:
    s_cbranch_execz L_st2
    ds_read_b128 a[120:123], v4 offset:10240
    v_cvt_pk_bf16_f32 v60, v72, v73
    v_mfma_f32_16x16x32_bf16 v[16:19], v[208:211], v[244:247], v[16:19]
    v_exp_f32 v74, v74
    v_mfma_f32_16x16x32_bf16 v[20:23], v[208:211], v[248:251], 0
    v_exp_f32 v75, v75
    v_mfma_f32_16x16x32_bf16 v[20:23], v[208:211], v[252:255], v[20:23]
    buffer_load_dwordx4 v2, s[8:11], s33 offen offset:0 nt lds
    v_cvt_pk_bf16_f32 v61, v74, v75
    v_mfma_f32_16x16x32_bf16 v[144:147], a[192:195], v[52:55], v[144:147]
    v_exp_f32 v76, v76
    v_mfma_f32_16x16x32_bf16 v[144:147], a[160:163], v[48:51], v[144:147]
    v_exp_f32 v77, v77
    v_mfma_f32_16x16x32_bf16 v[148:151], a[164:167], v[48:51], v[148:151]
    buffer_load_dwordx4 v2, s[8:11], s33 offen offset:1024 nt lds
    v_cvt_pk_bf16_f32 v208, v16, v20
    v_mfma_f32_16x16x32_bf16 v[148:151], a[196:199], v[52:55], v[148:151]
    s_mov_b32 m0, s25
    v_exp_f32 v78, v78
    v_mfma_f32_16x16x32_bf16 v[152:155], a[200:203], v[52:55], v[152:155]
    v_cvt_pk_bf16_f32 v209, v17, v21
    v_cvt_pk_bf16_f32 v210, v18, v22
    v_mfma_f32_16x16x32_bf16 v[152:155], a[168:171], v[48:51], v[152:155]
    ds_write_addtid_b32 v208 offset:22532
    v_cvt_pk_bf16_f32 v211, v19, v23
    v_mfma_f32_16x16x32_bf16 v[156:159], a[172:175], v[48:51], v[156:159]
    ds_write_addtid_b32 v209 offset:22788
    ds_write_addtid_b32 v210 offset:23044
    v_mfma_f32_16x16x32_bf16 v[156:159], a[204:207], v[52:55], v[156:159]
    s_waitcnt vmcnt(14)
    v_exp_f32 v79, v79
    v_mfma_f32_16x16x32_bf16 v[16:19], v[212:215], v[240:243], 0
    ds_write_addtid_b32 v211 offset:23300
    ds_read_b128 a[96:99], v4 offset:4096
    v_mfma_f32_16x16x32_bf16 v[16:19], v[212:215], v[244:247], v[16:19]
    s_mov_b32 m0, s26
    v_cvt_pk_bf16_f32 v62, v76, v77
    v_cvt_pk_bf16_f32 v63, v78, v79
    v_mfma_f32_16x16x32_bf16 v[20:23], v[212:215], v[248:251], 0
    s_mov_b32 s36, 0x1a000
    buffer_load_dwordx4 v2, s[8:11], s33 offen offset:2048 nt lds
    v_mfma_f32_16x16x32_bf16 v[20:23], v[212:215], v[252:255], v[20:23]
    s_waitcnt lgkmcnt(5)
    ds_read_b128 a[124:127], v4 offset:11264
    ds_read_b128 a[140:143], v4 offset:15360
    v_mfma_f32_16x16x32_bf16 v[64:67], a[80:83], a[0:3], -4.0
    buffer_load_dwordx4 v2, s[8:11], s33 offen offset:3072 nt lds
    v_mfma_f32_16x16x32_bf16 v[64:67], a[84:87], a[4:7], v[64:67]
    s_mov_b32 m0, s25
    ds_read_b128 a[136:139], v4 offset:14336
    ds_read_b128 a[132:135], v4 offset:13312
    v_mfma_f32_16x16x32_bf16 v[64:67], a[88:91], a[8:11], v[64:67]
    s_add_u32 s33, s33, s38
    v_cvt_pk_bf16_f32 v212, v16, v20
    v_cvt_pk_bf16_f32 v213, v17, v21
    v_mfma_f32_16x16x32_bf16 v[64:67], a[92:95], a[12:15], v[64:67]
    buffer_load_dwordx4 v[232:235], v11, s[12:15], s36 offen offset:0
    v_cvt_pk_bf16_f32 v214, v18, v22
    v_mfma_f32_16x16x32_bf16 v[68:71], a[108:111], a[12:15], -4.0
    ds_write_addtid_b32 v212 offset:23556
    v_cvt_pk_bf16_f32 v215, v19, v23
    v_mfma_f32_16x16x32_bf16 v[68:71], a[104:107], a[8:11], v[68:71]
    buffer_load_dwordx4 v[236:239], v11, s[12:15], s36 offen offset:64
    v_mfma_f32_16x16x32_bf16 v[68:71], a[100:103], a[4:7], v[68:71]
    s_waitcnt lgkmcnt(5)
    ds_write_addtid_b32 v213 offset:23812
    ds_write_addtid_b32 v214 offset:24068
    v_mfma_f32_16x16x32_bf16 v[68:71], a[96:99], a[0:3], v[68:71]
    s_waitcnt vmcnt(14)
    ds_write_addtid_b32 v215 offset:24324
    ds_read_b128 a[128:131], v4 offset:12288
    v_smfmac_f32_16x16x64_bf16 v[40:43], v[24:27], v[56:63], v9
    s_barrier
    v_mfma_f32_16x16x32_bf16 v[160:163], a[176:179], v[60:63], v[32:35]
    v_exp_f32 v64, v64
    v_mfma_f32_16x16x32_bf16 v[160:163], a[144:147], v[56:59], v[160:163]
    v_exp_f32 v65, v65
    v_mfma_f32_16x16x32_bf16 v[164:167], a[148:151], v[56:59], v[32:35]
    ds_read_b64_tr_b16 a[176:177], v5 offset:8192
    v_cvt_pk_bf16_f32 v48, v64, v65
    v_mfma_f32_16x16x32_bf16 v[164:167], a[180:183], v[60:63], v[164:167]
    v_exp_f32 v66, v66
    v_mfma_f32_16x16x32_bf16 v[168:171], a[184:187], v[60:63], v[32:35]
    v_exp_f32 v67, v67
    v_mfma_f32_16x16x32_bf16 v[168:171], a[152:155], v[56:59], v[168:171]
    ds_read_b64_tr_b16 a[178:179], v5 offset:12288
    v_cvt_pk_bf16_f32 v49, v66, v67
    v_mfma_f32_16x16x32_bf16 v[172:175], a[156:159], v[56:59], v[32:35]
    v_exp_f32 v68, v68
    v_mfma_f32_16x16x32_bf16 v[172:175], a[188:191], v[60:63], v[172:175]
    v_exp_f32 v69, v69
    v_mfma_f32_16x16x32_bf16 v[72:75], a[112:115], a[0:3], -4.0
    ds_read_b64_tr_b16 a[144:145], v5 offset:0
    v_cvt_pk_bf16_f32 v50, v68, v69
    v_mfma_f32_16x16x32_bf16 v[72:75], a[116:119], a[4:7], v[72:75]
    v_exp_f32 v70, v70
    v_mfma_f32_16x16x32_bf16 v[72:75], a[120:123], a[8:11], v[72:75]
    s_waitcnt lgkmcnt(2)
    v_exp_f32 v71, v71
    v_mfma_f32_16x16x32_bf16 v[72:75], a[124:127], a[12:15], v[72:75]
    ds_read_b64_tr_b16 a[146:147], v5 offset:4096
    v_cvt_pk_bf16_f32 v51, v70, v71
    v_mfma_f32_16x16x32_bf16 v[76:79], a[140:143], a[12:15], -4.0
    ds_read_b64_tr_b16 a[148:149], v5 offset:8
    v_mfma_f32_16x16x32_bf16 v[76:79], a[136:139], a[8:11], v[76:79]
    ds_read_b64_tr_b16 a[150:151], v5 offset:4104
    v_mfma_f32_16x16x32_bf16 v[76:79], a[132:135], a[4:7], v[76:79]
    v_exp_f32 v72, v72
    v_mfma_f32_16x16x32_bf16 v[76:79], a[128:131], a[0:3], v[76:79]
    v_exp_f32 v73, v73
    v_mfma_f32_16x16x32_bf16 v[176:179], a[192:195], v[60:63], v[32:35]
    ds_read_b64_tr_b16 a[180:181], v5 offset:8200
    v_cvt_pk_bf16_f32 v52, v72, v73
    v_mfma_f32_16x16x32_bf16 v[176:179], a[160:163], v[56:59], v[176:179]
    v_exp_f32 v74, v74
    v_mfma_f32_16x16x32_bf16 v[180:183], a[164:167], v[56:59], v[32:35]
    ds_read_b64_tr_b16 a[182:183], v5 offset:12296
    ds_read_b64_tr_b16 a[184:185], v5 offset:8448
    v_mfma_f32_16x16x32_bf16 v[180:183], a[196:199], v[60:63], v[180:183]
    v_exp_f32 v75, v75
    v_mfma_f32_16x16x32_bf16 v[184:187], a[200:203], v[60:63], v[32:35]
    ds_read_b64_tr_b16 a[186:187], v5 offset:12544
    v_cvt_pk_bf16_f32 v53, v74, v75
    v_mfma_f32_16x16x32_bf16 v[184:187], a[168:171], v[56:59], v[184:187]
    v_exp_f32 v76, v76
    v_mfma_f32_16x16x32_bf16 v[188:191], a[172:175], v[56:59], v[32:35]
    ds_read_b64_tr_b16 a[152:153], v5 offset:256
    ds_read_b64_tr_b16 a[154:155], v5 offset:4352
    v_mfma_f32_16x16x32_bf16 v[188:191], a[204:207], v[60:63], v[188:191]
    v_exp_f32 v77, v77
    v_mfma_f32_16x16x32_bf16 v[64:67], a[80:83], a[16:19], -4.0
    ds_read_b64_tr_b16 a[156:157], v5 offset:264
    v_cvt_pk_bf16_f32 v54, v76, v77
    v_mfma_f32_16x16x32_bf16 v[64:67], a[84:87], a[20:23], v[64:67]
    v_exp_f32 v78, v78
    v_mfma_f32_16x16x32_bf16 v[64:67], a[88:91], a[24:27], v[64:67]
    ds_read_b64_tr_b16 a[158:159], v5 offset:4360
    ds_read_b64_tr_b16 a[188:189], v5 offset:8456
    v_mfma_f32_16x16x32_bf16 v[64:67], a[92:95], a[28:31], v[64:67]
    v_exp_f32 v79, v79
    v_mfma_f32_16x16x32_bf16 v[68:71], a[108:111], a[28:31], -4.0
    ds_read_b64_tr_b16 a[190:191], v5 offset:12552
    v_cvt_pk_bf16_f32 v55, v78, v79
    v_mfma_f32_16x16x32_bf16 v[68:71], a[104:107], a[24:27], v[68:71]
    ds_read_b64_tr_b16 a[192:193], v5 offset:8704
    v_mfma_f32_16x16x32_bf16 v[68:71], a[100:103], a[20:23], v[68:71]
    v_exp_f32 v64, v64
    v_mfma_f32_16x16x32_bf16 v[68:71], a[96:99], a[16:19], v[68:71]
    s_waitcnt vmcnt(13)
    v_exp_f32 v65, v65
    v_mfma_f32_16x16x32_bf16 v[16:19], v[216:219], v[240:243], 0
    ds_read_b64_tr_b16 a[194:195], v5 offset:12800
    v_cvt_pk_bf16_f32 v56, v64, v65
    v_mfma_f32_16x16x32_bf16 v[16:19], v[216:219], v[244:247], v[16:19]
    v_exp_f32 v66, v66
    v_mfma_f32_16x16x32_bf16 v[20:23], v[216:219], v[248:251], 0
    v_exp_f32 v67, v67
    v_mfma_f32_16x16x32_bf16 v[20:23], v[216:219], v[252:255], v[20:23]
    ds_read_b64_tr_b16 a[160:161], v5 offset:512
    ds_read_b64_tr_b16 a[162:163], v5 offset:4608
    v_smfmac_f32_16x16x64_bf16 v[36:39], v[24:27], v[48:55], v9
    s_waitcnt lgkmcnt(4)
    ds_read_b64_tr_b16 a[164:165], v5 offset:520
    ds_read_b64_tr_b16 a[166:167], v5 offset:4616
    v_mfma_f32_16x16x32_bf16 v[96:99], a[176:179], v[52:55], v[96:99]
    v_exp_f32 v68, v68
    v_mfma_f32_16x16x32_bf16 v[96:99], a[144:147], v[48:51], v[96:99]
    v_cvt_pk_bf16_f32 v216, v16, v20
    v_cvt_pk_bf16_f32 v217, v17, v21
    v_mfma_f32_16x16x32_bf16 v[100:103], a[148:151], v[48:51], v[100:103]
    v_exp_f32 v69, v69
    v_mfma_f32_16x16x32_bf16 v[100:103], a[180:183], v[52:55], v[100:103]
    v_cvt_pk_bf16_f32 v218, v18, v22
    v_cvt_pk_bf16_f32 v219, v19, v23
    v_mfma_f32_16x16x32_bf16 v[104:107], a[184:187], v[52:55], v[104:107]
    ds_write_addtid_b32 v216 offset:30724
    ds_write_addtid_b32 v217 offset:30980
    v_mfma_f32_16x16x32_bf16 v[104:107], a[152:155], v[48:51], v[104:107]
    v_exp_f32 v70, v70
    v_mfma_f32_16x16x32_bf16 v[108:111], a[156:159], v[48:51], v[108:111]
    ds_write_addtid_b32 v218 offset:31236
    ds_write_addtid_b32 v219 offset:31492
    v_mfma_f32_16x16x32_bf16 v[108:111], a[188:191], v[52:55], v[108:111]
    s_waitcnt vmcnt(12)
    v_exp_f32 v71, v71
    v_mfma_f32_16x16x32_bf16 v[16:19], v[220:223], v[240:243], 0
    ds_read_b64_tr_b16 a[196:197], v5 offset:8712
    ds_read_b64_tr_b16 a[198:199], v5 offset:12808
    v_mfma_f32_16x16x32_bf16 v[16:19], v[220:223], v[244:247], v[16:19]
    ds_read_b64_tr_b16 a[200:201], v5 offset:8960
    ds_read_b64_tr_b16 a[202:203], v5 offset:13056
    v_mfma_f32_16x16x32_bf16 v[20:23], v[220:223], v[248:251], 0
    v_cvt_pk_bf16_f32 v57, v66, v67
    v_cvt_pk_bf16_f32 v58, v68, v69
    v_mfma_f32_16x16x32_bf16 v[20:23], v[220:223], v[252:255], v[20:23]
    ds_read_b64_tr_b16 a[168:169], v5 offset:768
    v_cvt_pk_bf16_f32 v59, v70, v71
    v_mfma_f32_16x16x32_bf16 v[72:75], a[112:115], a[16:19], -4.0
    ds_read_b64_tr_b16 a[170:171], v5 offset:4864
    ds_read_b64_tr_b16 a[172:173], v5 offset:776
    v_mfma_f32_16x16x32_bf16 v[72:75], a[116:119], a[20:23], v[72:75]
    ds_read_b64_tr_b16 a[174:175], v5 offset:4872
    ds_read_b64_tr_b16 a[204:205], v5 offset:8968
    v_mfma_f32_16x16x32_bf16 v[72:75], a[120:123], a[24:27], v[72:75]
    v_cvt_pk_bf16_f32 v220, v16, v20
    v_cvt_pk_bf16_f32 v221, v17, v21
    v_mfma_f32_16x16x32_bf16 v[72:75], a[124:127], a[28:31], v[72:75]
    v_cvt_pk_bf16_f32 v222, v18, v22
    v_cvt_pk_bf16_f32 v223, v19, v23
    v_mfma_f32_16x16x32_bf16 v[76:79], a[140:143], a[28:31], -4.0
    ds_write_addtid_b32 v220 offset:31748
    ds_write_addtid_b32 v221 offset:32004
    v_mfma_f32_16x16x32_bf16 v[76:79], a[136:139], a[24:27], v[76:79]
    ds_write_addtid_b32 v222 offset:32260
    ds_write_addtid_b32 v223 offset:32516
    v_mfma_f32_16x16x32_bf16 v[76:79], a[132:135], a[20:23], v[76:79]
    v_exp_f32 v72, v72
    v_mfma_f32_16x16x32_bf16 v[76:79], a[128:131], a[16:19], v[76:79]
    s_waitcnt lgkmcnt(8)
    v_exp_f32 v73, v73
    v_mfma_f32_16x16x32_bf16 v[112:115], a[192:195], v[52:55], v[112:115]
    ds_read_b64_tr_b16 a[206:207], v5 offset:13064
    v_cvt_pk_bf16_f32 v60, v72, v73
    v_mfma_f32_16x16x32_bf16 v[112:115], a[160:163], v[48:51], v[112:115]
    v_exp_f32 v74, v74
    v_mfma_f32_16x16x32_bf16 v[116:119], a[164:167], v[48:51], v[116:119]
    v_exp_f32 v75, v75
    v_mfma_f32_16x16x32_bf16 v[116:119], a[196:199], v[52:55], v[116:119]
    s_mov_b32 s35, 0x18000
    v_exp_f32 v76, v76
    v_mfma_f32_16x16x32_bf16 v[120:123], a[200:203], v[52:55], v[120:123]
    s_waitcnt lgkmcnt(3)
    v_exp_f32 v77, v77
    v_mfma_f32_16x16x32_bf16 v[120:123], a[168:171], v[48:51], v[120:123]
    s_mov_b32 m0, s48
    v_cvt_pk_bf16_f32 v61, v74, v75
    v_cvt_pk_bf16_f32 v62, v76, v77
    v_mfma_f32_16x16x32_bf16 v[124:127], a[172:175], v[48:51], v[124:127]
    s_waitcnt lgkmcnt(0)
    v_exp_f32 v78, v78
    v_mfma_f32_16x16x32_bf16 v[124:127], a[204:207], v[52:55], v[124:127]
    s_barrier
    v_mfma_f32_16x16x32_bf16 v[64:67], a[80:83], a[32:35], -4.0
    v_exp_f32 v79, v79
    v_mfma_f32_16x16x32_bf16 v[64:67], a[84:87], a[36:39], v[64:67]
    buffer_load_dwordx4 v2, s[16:19], s35 offen offset:0 lds
    v_cvt_pk_bf16_f32 v63, v78, v79
    v_mfma_f32_16x16x32_bf16 v[64:67], a[88:91], a[40:43], v[64:67]
    buffer_load_dwordx4 v2, s[16:19], s35 offen offset:1024 lds
    v_mfma_f32_16x16x32_bf16 v[64:67], a[92:95], a[44:47], v[64:67]
    s_mov_b32 m0, s49
    ds_read_b128 a[80:83], v4 offset:16384
    v_mfma_f32_16x16x32_bf16 v[68:71], a[108:111], a[44:47], -4.0
    s_mov_b32 s35, 0x1a000
    ds_read_b128 a[84:87], v4 offset:17408
    v_mfma_f32_16x16x32_bf16 v[68:71], a[104:107], a[40:43], v[68:71]
    buffer_load_dwordx4 v2, s[16:19], s35 offen offset:0 lds
    v_mfma_f32_16x16x32_bf16 v[68:71], a[100:103], a[36:39], v[68:71]
    v_exp_f32 v64, v64
    v_mfma_f32_16x16x32_bf16 v[68:71], a[96:99], a[32:35], v[68:71]
    buffer_load_dwordx4 v2, s[16:19], s35 offen offset:1024 lds
    v_smfmac_f32_16x16x64_bf16 v[38:41], v[24:27], v[56:63], v9
    ds_read_b128 a[88:91], v4 offset:18432
    v_mfma_f32_16x16x32_bf16 v[128:131], a[176:179], v[60:63], v[128:131]
    v_exp_f32 v65, v65
    v_mfma_f32_16x16x32_bf16 v[128:131], a[144:147], v[56:59], v[128:131]
    v_exp_f32 v66, v66
    v_mfma_f32_16x16x32_bf16 v[132:135], a[148:151], v[56:59], v[132:135]
    ds_read_b128 a[92:95], v4 offset:19456
    v_cvt_pk_bf16_f32 v48, v64, v65
    v_mfma_f32_16x16x32_bf16 v[132:135], a[180:183], v[60:63], v[132:135]
    v_exp_f32 v67, v67
    v_mfma_f32_16x16x32_bf16 v[136:139], a[184:187], v[60:63], v[136:139]
    v_exp_f32 v68, v68
    v_mfma_f32_16x16x32_bf16 v[136:139], a[152:155], v[56:59], v[136:139]
    ds_read_b128 a[108:111], v4 offset:23552
    v_cvt_pk_bf16_f32 v49, v66, v67
    v_mfma_f32_16x16x32_bf16 v[140:143], a[156:159], v[56:59], v[140:143]
    v_exp_f32 v69, v69
    v_mfma_f32_16x16x32_bf16 v[140:143], a[188:191], v[60:63], v[140:143]
    v_exp_f32 v70, v70
    v_mfma_f32_16x16x32_bf16 v[72:75], a[112:115], a[32:35], -4.0
    ds_read_b128 a[112:115], v4 offset:24576
    v_cvt_pk_bf16_f32 v50, v68, v69
    v_mfma_f32_16x16x32_bf16 v[72:75], a[116:119], a[36:39], v[72:75]
    v_exp_f32 v71, v71
    v_mfma_f32_16x16x32_bf16 v[72:75], a[120:123], a[40:43], v[72:75]
    ds_read_b128 a[104:107], v4 offset:22528
    v_cvt_pk_bf16_f32 v51, v70, v71
    v_mfma_f32_16x16x32_bf16 v[72:75], a[124:127], a[44:47], v[72:75]
    ds_read_b128 a[116:119], v4 offset:25600
    v_mfma_f32_16x16x32_bf16 v[76:79], a[140:143], a[44:47], -4.0
    v_mfma_f32_16x16x32_bf16 v[76:79], a[136:139], a[40:43], v[76:79]
    ds_read_b128 a[100:103], v4 offset:21504
    v_mfma_f32_16x16x32_bf16 v[76:79], a[132:135], a[36:39], v[76:79]
    v_exp_f32 v72, v72
    v_mfma_f32_16x16x32_bf16 v[76:79], a[128:131], a[32:35], v[76:79]
    s_waitcnt vmcnt(15)
    v_exp_f32 v73, v73
    v_mfma_f32_16x16x32_bf16 v[16:19], v[224:227], v[240:243], 0
    ds_read_b128 a[96:99], v4 offset:20480
    v_cvt_pk_bf16_f32 v52, v72, v73
    v_mfma_f32_16x16x32_bf16 v[16:19], v[224:227], v[244:247], v[16:19]
    v_exp_f32 v74, v74
    v_mfma_f32_16x16x32_bf16 v[20:23], v[224:227], v[248:251], 0
    v_exp_f32 v75, v75
    v_mfma_f32_16x16x32_bf16 v[20:23], v[224:227], v[252:255], v[20:23]
    ds_read_b128 a[120:123], v4 offset:26624
    v_cvt_pk_bf16_f32 v53, v74, v75
    v_mfma_f32_16x16x32_bf16 v[144:147], a[192:195], v[60:63], v[144:147]
    v_exp_f32 v76, v76
    v_mfma_f32_16x16x32_bf16 v[144:147], a[160:163], v[56:59], v[144:147]
    s_mov_b32 m0, s25
    v_exp_f32 v77, v77
    v_mfma_f32_16x16x32_bf16 v[148:151], a[164:167], v[56:59], v[148:151]
    v_cvt_pk_bf16_f32 v224, v16, v20
    v_cvt_pk_bf16_f32 v225, v17, v21
    v_mfma_f32_16x16x32_bf16 v[148:151], a[196:199], v[60:63], v[148:151]
    v_exp_f32 v78, v78
    v_mfma_f32_16x16x32_bf16 v[152:155], a[200:203], v[60:63], v[152:155]
    v_cvt_pk_bf16_f32 v226, v18, v22
    v_cvt_pk_bf16_f32 v227, v19, v23
    v_mfma_f32_16x16x32_bf16 v[152:155], a[168:171], v[56:59], v[152:155]
    ds_write_addtid_b32 v224 offset:38916
    ds_write_addtid_b32 v225 offset:39172
    v_mfma_f32_16x16x32_bf16 v[156:159], a[172:175], v[56:59], v[156:159]
    v_exp_f32 v79, v79
    v_mfma_f32_16x16x32_bf16 v[156:159], a[204:207], v[60:63], v[156:159]
    s_waitcnt vmcnt(14)
    ds_write_addtid_b32 v226 offset:39428
    ds_write_addtid_b32 v227 offset:39684
    v_mfma_f32_16x16x32_bf16 v[16:19], v[228:231], v[240:243], 0
    v_cvt_pk_bf16_f32 v54, v76, v77
    v_cvt_pk_bf16_f32 v55, v78, v79
    v_mfma_f32_16x16x32_bf16 v[16:19], v[228:231], v[244:247], v[16:19]
    ds_read_b128 a[124:127], v4 offset:27648
    ds_read_b128 a[140:143], v4 offset:31744
    v_mfma_f32_16x16x32_bf16 v[20:23], v[228:231], v[248:251], 0
    ds_read_b128 a[136:139], v4 offset:30720
    v_mfma_f32_16x16x32_bf16 v[20:23], v[228:231], v[252:255], v[20:23]
    s_waitcnt lgkmcnt(7)
    ds_read_b128 a[132:135], v4 offset:29696
    v_mfma_f32_16x16x32_bf16 v[64:67], a[80:83], a[0:3], -4.0
    v_mfma_f32_16x16x32_bf16 v[64:67], a[84:87], a[4:7], v[64:67]
    ds_read_b128 a[128:131], v4 offset:28672
    v_mfma_f32_16x16x32_bf16 v[64:67], a[88:91], a[8:11], v[64:67]
    v_cvt_pk_bf16_f32 v228, v16, v20
    v_cvt_pk_bf16_f32 v229, v17, v21
    v_mfma_f32_16x16x32_bf16 v[64:67], a[92:95], a[12:15], v[64:67]
    v_cvt_pk_bf16_f32 v230, v18, v22
    v_cvt_pk_bf16_f32 v231, v19, v23
    v_mfma_f32_16x16x32_bf16 v[68:71], a[108:111], a[12:15], -4.0
    ds_write_addtid_b32 v228 offset:39940
    ds_write_addtid_b32 v229 offset:40196
    v_mfma_f32_16x16x32_bf16 v[68:71], a[104:107], a[8:11], v[68:71]
    ds_write_addtid_b32 v230 offset:40452
    ds_write_addtid_b32 v231 offset:40708
    v_mfma_f32_16x16x32_bf16 v[68:71], a[100:103], a[4:7], v[68:71]
    s_waitcnt vmcnt(10)
    v_exp_f32 v64, v64
    v_mfma_f32_16x16x32_bf16 v[68:71], a[96:99], a[0:3], v[68:71]
    s_mov_b32 s36, 0x1c000
    v_exp_f32 v65, v65
    v_smfmac_f32_16x16x64_bf16 v[40:43], v[24:27], v[48:55], v9
    s_barrier
    v_mfma_f32_16x16x32_bf16 v[160:163], a[176:179], v[52:55], v[160:163]
    v_exp_f32 v66, v66
    v_mfma_f32_16x16x32_bf16 v[160:163], a[144:147], v[48:51], v[160:163]
    ds_read_b64_tr_b16 a[176:177], v5 offset:24576
    v_cvt_pk_bf16_f32 v56, v64, v65
    v_mfma_f32_16x16x32_bf16 v[164:167], a[148:151], v[48:51], v[164:167]
    v_exp_f32 v67, v67
    v_mfma_f32_16x16x32_bf16 v[164:167], a[180:183], v[52:55], v[164:167]
    buffer_load_dwordx4 v[224:227], v11, s[12:15], s36 offen offset:0
    v_cvt_pk_bf16_f32 v57, v66, v67
    v_mfma_f32_16x16x32_bf16 v[168:171], a[184:187], v[52:55], v[168:171]
    v_exp_f32 v68, v68
    v_mfma_f32_16x16x32_bf16 v[168:171], a[152:155], v[48:51], v[168:171]
    v_exp_f32 v69, v69
    v_mfma_f32_16x16x32_bf16 v[172:175], a[156:159], v[48:51], v[172:175]
    buffer_load_dwordx4 v[228:231], v11, s[12:15], s36 offen offset:64
    v_cvt_pk_bf16_f32 v58, v68, v69
    v_mfma_f32_16x16x32_bf16 v[172:175], a[188:191], v[52:55], v[172:175]
    v_exp_f32 v70, v70
    v_mfma_f32_16x16x32_bf16 v[72:75], a[112:115], a[0:3], -4.0
    v_exp_f32 v71, v71
    v_mfma_f32_16x16x32_bf16 v[72:75], a[116:119], a[4:7], v[72:75]
    ds_read_b64_tr_b16 a[178:179], v5 offset:28672
    v_cvt_pk_bf16_f32 v59, v70, v71
    v_mfma_f32_16x16x32_bf16 v[72:75], a[120:123], a[8:11], v[72:75]
    s_waitcnt lgkmcnt(1)
    ds_read_b64_tr_b16 a[144:145], v5 offset:16384
    v_mfma_f32_16x16x32_bf16 v[72:75], a[124:127], a[12:15], v[72:75]
    ds_read_b64_tr_b16 a[146:147], v5 offset:20480
    v_mfma_f32_16x16x32_bf16 v[76:79], a[140:143], a[12:15], -4.0
    ds_read_b64_tr_b16 a[148:149], v5 offset:16392
    v_mfma_f32_16x16x32_bf16 v[76:79], a[136:139], a[8:11], v[76:79]
    ds_read_b64_tr_b16 a[150:151], v5 offset:20488
    v_mfma_f32_16x16x32_bf16 v[76:79], a[132:135], a[4:7], v[76:79]
    v_exp_f32 v72, v72
    v_mfma_f32_16x16x32_bf16 v[76:79], a[128:131], a[0:3], v[76:79]
    v_exp_f32 v73, v73
    v_mfma_f32_16x16x32_bf16 v[176:179], a[192:195], v[52:55], v[176:179]
    s_waitcnt vmcnt(8)
    ds_read_b128 a[48:51], v15 offset:0
    ds_read_b128 a[52:55], v15 offset:256
    v_mfma_f32_16x16x32_bf16 v[176:179], a[160:163], v[48:51], v[176:179]
    v_exp_f32 v74, v74
    v_mfma_f32_16x16x32_bf16 v[180:183], a[164:167], v[48:51], v[180:183]
    ds_read_b64_tr_b16 a[180:181], v5 offset:24584
    ds_read_b64_tr_b16 a[182:183], v5 offset:28680
    v_mfma_f32_16x16x32_bf16 v[180:183], a[196:199], v[52:55], v[180:183]
    v_exp_f32 v75, v75
    v_mfma_f32_16x16x32_bf16 v[184:187], a[200:203], v[52:55], v[184:187]
    ds_read_b128 a[56:59], v15 offset:512
    ds_read_b64_tr_b16 a[184:185], v5 offset:24832
    v_mfma_f32_16x16x32_bf16 v[184:187], a[168:171], v[48:51], v[184:187]
    v_exp_f32 v76, v76
    v_mfma_f32_16x16x32_bf16 v[188:191], a[172:175], v[48:51], v[188:191]
    ds_read_b128 a[60:63], v15 offset:768
    ds_read_b64_tr_b16 a[186:187], v5 offset:28928
    v_mfma_f32_16x16x32_bf16 v[188:191], a[204:207], v[52:55], v[188:191]
    v_exp_f32 v77, v77
    v_mfma_f32_16x16x32_bf16 v[64:67], a[80:83], a[16:19], -4.0
    v_cvt_pk_bf16_f32 v60, v72, v73
    v_cvt_pk_bf16_f32 v61, v74, v75
    v_mfma_f32_16x16x32_bf16 v[64:67], a[84:87], a[20:23], v[64:67]
    v_exp_f32 v78, v78
    v_mfma_f32_16x16x32_bf16 v[64:67], a[88:91], a[24:27], v[64:67]
    ds_read_b64_tr_b16 a[152:153], v5 offset:16640
    v_cvt_pk_bf16_f32 v62, v76, v77
    v_mfma_f32_16x16x32_bf16 v[64:67], a[92:95], a[28:31], v[64:67]
    v_exp_f32 v79, v79
    v_mfma_f32_16x16x32_bf16 v[68:71], a[108:111], a[28:31], -4.0
    ds_read_b64_tr_b16 a[154:155], v5 offset:20736
    v_cvt_pk_bf16_f32 v63, v78, v79
    v_mfma_f32_16x16x32_bf16 v[68:71], a[104:107], a[24:27], v[68:71]
    s_mov_b32 m0, s26
    ds_read_b64_tr_b16 a[156:157], v5 offset:16648
    ds_read_b64_tr_b16 a[158:159], v5 offset:20744
    v_mfma_f32_16x16x32_bf16 v[68:71], a[100:103], a[20:23], v[68:71]
    v_exp_f32 v64, v64
    v_mfma_f32_16x16x32_bf16 v[68:71], a[96:99], a[16:19], v[68:71]
    s_waitcnt vmcnt(7)
    ds_read_b64_tr_b16 a[188:189], v5 offset:24840
    ds_read_b64_tr_b16 a[190:191], v5 offset:28936
    v_mfma_f32_16x16x32_bf16 v[16:19], v[232:235], v[240:243], 0
    v_exp_f32 v65, v65
    v_mfma_f32_16x16x32_bf16 v[16:19], v[232:235], v[244:247], v[16:19]
    s_waitcnt lgkmcnt(6)
    buffer_load_dwordx4 v2, s[8:11], s33 offen offset:0 nt lds
    v_cvt_pk_bf16_f32 v48, v64, v65
    v_mfma_f32_16x16x32_bf16 v[20:23], v[232:235], v[248:251], 0
    v_exp_f32 v66, v66
    v_mfma_f32_16x16x32_bf16 v[20:23], v[232:235], v[252:255], v[20:23]
    v_exp_f32 v67, v67
    v_smfmac_f32_16x16x64_bf16 v[36:39], v[24:27], v[56:63], v9
    buffer_load_dwordx4 v2, s[8:11], s33 offen offset:1024 nt lds
    v_cvt_pk_bf16_f32 v49, v66, v67
    v_mfma_f32_16x16x32_bf16 v[96:99], a[176:179], v[60:63], v[96:99]
    v_exp_f32 v68, v68
    v_mfma_f32_16x16x32_bf16 v[96:99], a[144:147], v[56:59], v[96:99]
    buffer_load_dwordx4 v2, s[8:11], s33 offen offset:2048 nt lds
    v_cvt_pk_bf16_f32 v232, v16, v20
    v_mfma_f32_16x16x32_bf16 v[100:103], a[148:151], v[56:59], v[100:103]
    s_mov_b32 m0, s25
    v_exp_f32 v69, v69
    v_mfma_f32_16x16x32_bf16 v[100:103], a[180:183], v[60:63], v[100:103]
    v_cvt_pk_bf16_f32 v233, v17, v21
    v_cvt_pk_bf16_f32 v234, v18, v22
    v_mfma_f32_16x16x32_bf16 v[104:107], a[184:187], v[60:63], v[104:107]
    s_waitcnt lgkmcnt(0)
    ds_write_addtid_b32 v232 offset:47108
    v_cvt_pk_bf16_f32 v235, v19, v23
    v_mfma_f32_16x16x32_bf16 v[104:107], a[152:155], v[56:59], v[104:107]
    ds_write_addtid_b32 v233 offset:47364
    ds_write_addtid_b32 v234 offset:47620
    v_mfma_f32_16x16x32_bf16 v[108:111], a[156:159], v[56:59], v[108:111]
    v_exp_f32 v70, v70
    v_mfma_f32_16x16x32_bf16 v[108:111], a[188:191], v[60:63], v[108:111]
    s_waitcnt vmcnt(9)
    ds_write_addtid_b32 v235 offset:47876
    ds_read_b64_tr_b16 a[192:193], v5 offset:25088
    v_mfma_f32_16x16x32_bf16 v[16:19], v[236:239], v[240:243], 0
    s_mov_b32 m0, s26
    v_exp_f32 v71, v71
    v_mfma_f32_16x16x32_bf16 v[16:19], v[236:239], v[244:247], v[16:19]
    buffer_load_dwordx4 v2, s[8:11], s33 offen offset:3072 nt lds
    v_cvt_pk_bf16_f32 v50, v68, v69
    v_mfma_f32_16x16x32_bf16 v[20:23], v[236:239], v[248:251], 0
    s_add_u32 s33, s33, s38
    ds_read_b64_tr_b16 a[194:195], v5 offset:29184
    ds_read_b64_tr_b16 a[160:161], v5 offset:16896
    v_mfma_f32_16x16x32_bf16 v[20:23], v[236:239], v[252:255], v[20:23]
    ds_read_b64_tr_b16 a[162:163], v5 offset:20992
    ds_read_b64_tr_b16 a[164:165], v5 offset:16904
    v_mfma_f32_16x16x32_bf16 v[72:75], a[112:115], a[16:19], -4.0
    ds_read_b64_tr_b16 a[166:167], v5 offset:21000
    ds_read_b64_tr_b16 a[196:197], v5 offset:25096
    v_mfma_f32_16x16x32_bf16 v[72:75], a[116:119], a[20:23], v[72:75]
    s_mov_b32 m0, s25
    ds_read_b64_tr_b16 a[198:199], v5 offset:29192
    ds_read_b64_tr_b16 a[200:201], v5 offset:25344
    v_mfma_f32_16x16x32_bf16 v[72:75], a[120:123], a[24:27], v[72:75]
    v_cvt_pk_bf16_f32 v236, v16, v20
    v_cvt_pk_bf16_f32 v237, v17, v21
    v_mfma_f32_16x16x32_bf16 v[72:75], a[124:127], a[28:31], v[72:75]
    ds_read_b64_tr_b16 a[202:203], v5 offset:29440
    v_cvt_pk_bf16_f32 v238, v18, v22
    v_mfma_f32_16x16x32_bf16 v[76:79], a[140:143], a[28:31], -4.0
    ds_write_addtid_b32 v236 offset:48132
    v_cvt_pk_bf16_f32 v239, v19, v23
    v_mfma_f32_16x16x32_bf16 v[76:79], a[136:139], a[24:27], v[76:79]
    ds_read_b64_tr_b16 a[168:169], v5 offset:17152
    ds_read_b64_tr_b16 a[170:171], v5 offset:21248
    v_mfma_f32_16x16x32_bf16 v[76:79], a[132:135], a[20:23], v[76:79]
    s_waitcnt lgkmcnt(10)
    ds_write_addtid_b32 v237 offset:48388
    ds_read_b64_tr_b16 a[172:173], v5 offset:17160
    ds_read_b64_tr_b16 a[174:175], v5 offset:21256
    v_cvt_pk_bf16_f32 v51, v70, v71
    v_mfma_f32_16x16x32_bf16 v[76:79], a[128:131], a[16:19], v[76:79]
    s_mov_b32 s36, 0x1e000
    ds_write_addtid_b32 v238 offset:48644
    ds_write_addtid_b32 v239 offset:48900
    ds_read_b64_tr_b16 a[204:205], v5 offset:25352
    ds_read_b64_tr_b16 a[206:207], v5 offset:29448
    v_mfma_f32_16x16x32_bf16 v[112:115], a[192:195], v[60:63], v[112:115]
    s_waitcnt lgkmcnt(13)
    v_exp_f32 v72, v72
    v_mfma_f32_16x16x32_bf16 v[112:115], a[160:163], v[56:59], v[112:115]
    v_exp_f32 v73, v73
    v_mfma_f32_16x16x32_bf16 v[116:119], a[164:167], v[56:59], v[116:119]
    s_waitcnt lgkmcnt(10)
    v_exp_f32 v74, v74
    v_mfma_f32_16x16x32_bf16 v[116:119], a[196:199], v[60:63], v[116:119]
    s_mov_b32 s35, 0x1c000
    v_exp_f32 v75, v75
    v_mfma_f32_16x16x32_bf16 v[120:123], a[200:203], v[60:63], v[120:123]
    s_waitcnt lgkmcnt(4)
    buffer_load_dwordx4 v[232:235], v11, s[12:15], s36 offen offset:0
    v_cvt_pk_bf16_f32 v52, v72, v73
    v_mfma_f32_16x16x32_bf16 v[120:123], a[168:171], v[56:59], v[120:123]
    s_mov_b32 m0, s50
    v_exp_f32 v76, v76
    v_mfma_f32_16x16x32_bf16 v[124:127], a[172:175], v[56:59], v[124:127]
    s_waitcnt lgkmcnt(0)
    buffer_load_dwordx4 v[236:239], v11, s[12:15], s36 offen offset:64
    v_cvt_pk_bf16_f32 v53, v74, v75
    v_mfma_f32_16x16x32_bf16 v[124:127], a[204:207], v[60:63], v[124:127]
    s_barrier
    v_mfma_f32_16x16x32_bf16 v[64:67], a[80:83], a[32:35], -4.0
    v_exp_f32 v77, v77
    v_mfma_f32_16x16x32_bf16 v[64:67], a[84:87], a[36:39], v[64:67]
    buffer_load_dwordx4 v2, s[16:19], s35 offen offset:0 lds
    v_cvt_pk_bf16_f32 v54, v76, v77
    v_mfma_f32_16x16x32_bf16 v[64:67], a[88:91], a[40:43], v[64:67]
    v_exp_f32 v78, v78
    v_mfma_f32_16x16x32_bf16 v[64:67], a[92:95], a[44:47], v[64:67]
    buffer_load_dwordx4 v2, s[16:19], s35 offen offset:1024 lds
    v_mfma_f32_16x16x32_bf16 v[68:71], a[108:111], a[44:47], -4.0
    s_mov_b32 m0, s51
    v_exp_f32 v79, v79
    v_mfma_f32_16x16x32_bf16 v[68:71], a[104:107], a[40:43], v[68:71]
    s_mov_b32 s35, 0x1e000
    v_cvt_pk_bf16_f32 v55, v78, v79
    v_mfma_f32_16x16x32_bf16 v[68:71], a[100:103], a[36:39], v[68:71]
    buffer_load_dwordx4 v2, s[16:19], s35 offen offset:0 lds
    v_mfma_f32_16x16x32_bf16 v[68:71], a[96:99], a[32:35], v[68:71]
    v_exp_f32 v64, v64
    v_smfmac_f32_16x16x64_bf16 v[38:41], v[24:27], v[48:55], v9
    buffer_load_dwordx4 v2, s[16:19], s35 offen offset:1024 lds
    v_mfma_f32_16x16x32_bf16 v[128:131], a[176:179], v[52:55], v[128:131]
    v_exp_f32 v65, v65
    v_mfma_f32_16x16x32_bf16 v[128:131], a[144:147], v[48:51], v[128:131]
    v_exp_f32 v66, v66
    v_mfma_f32_16x16x32_bf16 v[132:135], a[148:151], v[48:51], v[132:135]
    v_exp_f32 v67, v67
    v_mfma_f32_16x16x32_bf16 v[132:135], a[180:183], v[52:55], v[132:135]
L_st2:
    s_cbranch_execz L_wret
    v_cvt_pk_bf16_f32 v56, v64, v65
    v_cvt_pk_bf16_f32 v57, v66, v67
    v_mfma_f32_16x16x32_bf16 v[136:139], a[184:187], v[52:55], v[136:139]
    v_exp_f32 v68, v68
    v_mfma_f32_16x16x32_bf16 v[136:139], a[152:155], v[48:51], v[136:139]
    v_exp_f32 v69, v69
    v_mfma_f32_16x16x32_bf16 v[140:143], a[156:159], v[48:51], v[140:143]
    v_exp_f32 v70, v70
    v_mfma_f32_16x16x32_bf16 v[140:143], a[188:191], v[52:55], v[140:143]
    v_exp_f32 v71, v71
    v_mfma_f32_16x16x32_bf16 v[72:75], a[112:115], a[32:35], -4.0
    v_cvt_pk_bf16_f32 v58, v68, v69
    v_cvt_pk_bf16_f32 v59, v70, v71
    v_mfma_f32_16x16x32_bf16 v[72:75], a[116:119], a[36:39], v[72:75]
    v_mfma_f32_16x16x32_bf16 v[72:75], a[120:123], a[40:43], v[72:75]
    v_mfma_f32_16x16x32_bf16 v[72:75], a[124:127], a[44:47], v[72:75]
    v_mfma_f32_16x16x32_bf16 v[76:79], a[140:143], a[44:47], -4.0
    v_mfma_f32_16x16x32_bf16 v[76:79], a[136:139], a[40:43], v[76:79]
    v_mfma_f32_16x16x32_bf16 v[76:79], a[132:135], a[36:39], v[76:79]
    v_exp_f32 v72, v72
    v_mfma_f32_16x16x32_bf16 v[76:79], a[128:131], a[32:35], v[76:79]
    v_exp_f32 v73, v73
    v_mfma_f32_16x16x32_bf16 v[144:147], a[192:195], v[52:55], v[144:147]
    v_exp_f32 v74, v74
    v_mfma_f32_16x16x32_bf16 v[144:147], a[160:163], v[48:51], v[144:147]
    v_exp_f32 v75, v75
    v_mfma_f32_16x16x32_bf16 v[148:151], a[164:167], v[48:51], v[148:151]
    v_cvt_pk_bf16_f32 v60, v72, v73
    v_cvt_pk_bf16_f32 v61, v74, v75
    v_mfma_f32_16x16x32_bf16 v[148:151], a[196:199], v[52:55], v[148:151]
    v_exp_f32 v76, v76
    v_mfma_f32_16x16x32_bf16 v[152:155], a[200:203], v[52:55], v[152:155]
    v_exp_f32 v77, v77
    v_mfma_f32_16x16x32_bf16 v[152:155], a[168:171], v[48:51], v[152:155]
    v_exp_f32 v78, v78
    v_mfma_f32_16x16x32_bf16 v[156:159], a[172:175], v[48:51], v[156:159]
    v_exp_f32 v79, v79
    v_mfma_f32_16x16x32_bf16 v[156:159], a[204:207], v[52:55], v[156:159]
    v_cvt_pk_bf16_f32 v62, v76, v77
    v_cvt_pk_bf16_f32 v63, v78, v79
    v_mfma_f32_16x16x32_bf16 v[64:67], a[80:83], a[48:51], -4.0
    ds_read_b128 a[80:83], v4 offset:32768
    v_mfma_f32_16x16x32_bf16 v[64:67], a[84:87], a[52:55], v[64:67]
    v_mfma_f32_16x16x32_bf16 v[64:67], a[88:91], a[56:59], v[64:67]
    ds_read_b128 a[84:87], v4 offset:33792
    v_mfma_f32_16x16x32_bf16 v[64:67], a[92:95], a[60:63], v[64:67]
    v_mfma_f32_16x16x32_bf16 v[68:71], a[108:111], a[60:63], -4.0
    v_mfma_f32_16x16x32_bf16 v[68:71], a[104:107], a[56:59], v[68:71]
    ds_read_b128 a[88:91], v4 offset:34816
    v_mfma_f32_16x16x32_bf16 v[68:71], a[100:103], a[52:55], v[68:71]
    v_exp_f32 v64, v64
    v_mfma_f32_16x16x32_bf16 v[68:71], a[96:99], a[48:51], v[68:71]
    v_exp_f32 v65, v65
    v_smfmac_f32_16x16x64_bf16 v[40:43], v[24:27], v[56:63], v9
    ds_read_b128 a[92:95], v4 offset:35840
    v_cvt_pk_bf16_f32 v48, v64, v65
    v_mfma_f32_16x16x32_bf16 v[160:163], a[176:179], v[60:63], v[160:163]
    v_exp_f32 v66, v66
    v_mfma_f32_16x16x32_bf16 v[160:163], a[144:147], v[56:59], v[160:163]
    v_exp_f32 v67, v67
    v_mfma_f32_16x16x32_bf16 v[164:167], a[148:151], v[56:59], v[164:167]
    ds_read_b128 a[108:111], v4 offset:39936
    v_cvt_pk_bf16_f32 v49, v66, v67
    v_mfma_f32_16x16x32_bf16 v[164:167], a[180:183], v[60:63], v[164:167]
    v_exp_f32 v68, v68
    v_mfma_f32_16x16x32_bf16 v[168:171], a[184:187], v[60:63], v[168:171]
    v_exp_f32 v69, v69
    v_mfma_f32_16x16x32_bf16 v[168:171], a[152:155], v[56:59], v[168:171]
    ds_read_b128 a[104:107], v4 offset:38912
    v_cvt_pk_bf16_f32 v50, v68, v69
    v_mfma_f32_16x16x32_bf16 v[172:175], a[156:159], v[56:59], v[172:175]
    v_exp_f32 v70, v70
    v_mfma_f32_16x16x32_bf16 v[172:175], a[188:191], v[60:63], v[172:175]
    v_exp_f32 v71, v71
    v_mfma_f32_16x16x32_bf16 v[72:75], a[112:115], a[48:51], -4.0
    ds_read_b128 a[100:103], v4 offset:37888
    v_cvt_pk_bf16_f32 v51, v70, v71
    v_mfma_f32_16x16x32_bf16 v[72:75], a[116:119], a[52:55], v[72:75]
    ds_read_b128 a[112:115], v4 offset:40960
    v_mfma_f32_16x16x32_bf16 v[72:75], a[120:123], a[56:59], v[72:75]
    ds_read_b128 a[116:119], v4 offset:41984
    v_mfma_f32_16x16x32_bf16 v[72:75], a[124:127], a[60:63], v[72:75]
    ds_read_b128 a[96:99], v4 offset:36864
    v_mfma_f32_16x16x32_bf16 v[76:79], a[140:143], a[60:63], -4.0
    v_mfma_f32_16x16x32_bf16 v[76:79], a[136:139], a[56:59], v[76:79]
    ds_read_b128 a[120:123], v4 offset:43008
    v_mfma_f32_16x16x32_bf16 v[76:79], a[132:135], a[52:55], v[76:79]
    v_exp_f32 v72, v72
    v_mfma_f32_16x16x32_bf16 v[76:79], a[128:131], a[48:51], v[76:79]
    v_exp_f32 v73, v73
    v_mfma_f32_16x16x32_bf16 v[176:179], a[192:195], v[60:63], v[176:179]
    ds_read_b128 a[124:127], v4 offset:44032
    v_cvt_pk_bf16_f32 v52, v72, v73
    v_mfma_f32_16x16x32_bf16 v[176:179], a[160:163], v[56:59], v[176:179]
    v_exp_f32 v74, v74
    v_mfma_f32_16x16x32_bf16 v[180:183], a[164:167], v[56:59], v[180:183]
    v_exp_f32 v75, v75
    v_mfma_f32_16x16x32_bf16 v[180:183], a[196:199], v[60:63], v[180:183]
    ds_read_b128 a[140:143], v4 offset:48128
    v_cvt_pk_bf16_f32 v53, v74, v75
    v_mfma_f32_16x16x32_bf16 v[184:187], a[200:203], v[60:63], v[184:187]
    v_exp_f32 v76, v76
    v_mfma_f32_16x16x32_bf16 v[184:187], a[168:171], v[56:59], v[184:187]
    v_exp_f32 v77, v77
    v_mfma_f32_16x16x32_bf16 v[188:191], a[172:175], v[56:59], v[188:191]
    ds_read_b128 a[136:139], v4 offset:47104
    v_cvt_pk_bf16_f32 v54, v76, v77
    v_mfma_f32_16x16x32_bf16 v[188:191], a[204:207], v[60:63], v[188:191]
    s_waitcnt lgkmcnt(3)
    v_exp_f32 v78, v78
    v_mfma_f32_16x16x32_bf16 v[64:67], a[80:83], a[0:3], -4.0
    v_exp_f32 v79, v79
    v_mfma_f32_16x16x32_bf16 v[64:67], a[84:87], a[4:7], v[64:67]
    ds_read_b128 a[132:135], v4 offset:46080
    v_cvt_pk_bf16_f32 v55, v78, v79
    v_mfma_f32_16x16x32_bf16 v[64:67], a[88:91], a[8:11], v[64:67]
    v_mfma_f32_16x16x32_bf16 v[64:67], a[92:95], a[12:15], v[64:67]
    v_mfma_f32_16x16x32_bf16 v[68:71], a[108:111], a[12:15], -4.0
    ds_read_b128 a[128:131], v4 offset:45056
    v_mfma_f32_16x16x32_bf16 v[68:71], a[104:107], a[8:11], v[68:71]
    v_mfma_f32_16x16x32_bf16 v[68:71], a[100:103], a[4:7], v[68:71]
    v_exp_f32 v64, v64
    v_mfma_f32_16x16x32_bf16 v[68:71], a[96:99], a[0:3], v[68:71]
    s_waitcnt vmcnt(12)
    v_exp_f32 v65, v65
    v_smfmac_f32_16x16x64_bf16 v[42:45], v[24:27], v[48:55], v9
    s_barrier
    v_mfma_f32_16x16x32_bf16 v[192:195], a[176:179], v[52:55], v[32:35]
    v_exp_f32 v66, v66
    v_mfma_f32_16x16x32_bf16 v[192:195], a[144:147], v[48:51], v[192:195]
    ds_read_b64_tr_b16 a[176:177], v5 offset:8192
    v_cvt_pk_bf16_f32 v56, v64, v65
    v_mfma_f32_16x16x32_bf16 v[196:199], a[148:151], v[48:51], v[32:35]
    v_exp_f32 v67, v67
    v_mfma_f32_16x16x32_bf16 v[196:199], a[180:183], v[52:55], v[196:199]
    ds_read_b64_tr_b16 a[178:179], v5 offset:12288
    v_cvt_pk_bf16_f32 v57, v66, v67
    v_mfma_f32_16x16x32_bf16 v[200:203], a[184:187], v[52:55], v[32:35]
    v_exp_f32 v68, v68
    v_mfma_f32_16x16x32_bf16 v[200:203], a[152:155], v[48:51], v[200:203]
    v_exp_f32 v69, v69
    v_mfma_f32_16x16x32_bf16 v[204:207], a[156:159], v[48:51], v[32:35]
    ds_read_b64_tr_b16 a[144:145], v5 offset:0
    v_cvt_pk_bf16_f32 v58, v68, v69
    v_mfma_f32_16x16x32_bf16 v[204:207], a[188:191], v[52:55], v[204:207]
    v_exp_f32 v70, v70
    v_mfma_f32_16x16x32_bf16 v[72:75], a[112:115], a[0:3], -4.0
    v_exp_f32 v71, v71
    v_mfma_f32_16x16x32_bf16 v[72:75], a[116:119], a[4:7], v[72:75]
    ds_read_b64_tr_b16 a[146:147], v5 offset:4096
    v_cvt_pk_bf16_f32 v59, v70, v71
    v_mfma_f32_16x16x32_bf16 v[72:75], a[120:123], a[8:11], v[72:75]
    s_waitcnt lgkmcnt(3)
    ds_read_b64_tr_b16 a[148:149], v5 offset:8
    v_mfma_f32_16x16x32_bf16 v[72:75], a[124:127], a[12:15], v[72:75]
    ds_read_b64_tr_b16 a[150:151], v5 offset:4104
    v_mfma_f32_16x16x32_bf16 v[76:79], a[140:143], a[12:15], -4.0
    ds_read_b64_tr_b16 a[180:181], v5 offset:8200
    ds_read_b64_tr_b16 a[182:183], v5 offset:12296
    v_mfma_f32_16x16x32_bf16 v[76:79], a[136:139], a[8:11], v[76:79]
    ds_read_b64_tr_b16 a[184:185], v5 offset:8448
    ds_read_b64_tr_b16 a[186:187], v5 offset:12544
    v_mfma_f32_16x16x32_bf16 v[76:79], a[132:135], a[4:7], v[76:79]
    v_exp_f32 v72, v72
    v_mfma_f32_16x16x32_bf16 v[76:79], a[128:131], a[0:3], v[76:79]
    ds_read_b64_tr_b16 a[152:153], v5 offset:256
    ds_read_b64_tr_b16 a[154:155], v5 offset:4352
    v_mfma_f32_16x16x32_bf16 v[208:211], a[192:195], v[52:55], v[32:35]
    v_exp_f32 v73, v73
    v_mfma_f32_16x16x32_bf16 v[208:211], a[160:163], v[48:51], v[208:211]
    ds_read_b64_tr_b16 a[156:157], v5 offset:264
    v_cvt_pk_bf16_f32 v60, v72, v73
    v_mfma_f32_16x16x32_bf16 v[212:215], a[164:167], v[48:51], v[32:35]
    v_exp_f32 v74, v74
    v_mfma_f32_16x16x32_bf16 v[212:215], a[196:199], v[52:55], v[212:215]
    ds_read_b64_tr_b16 a[158:159], v5 offset:4360
    ds_read_b64_tr_b16 a[188:189], v5 offset:8456
    v_mfma_f32_16x16x32_bf16 v[216:219], a[200:203], v[52:55], v[32:35]
    v_exp_f32 v75, v75
    v_mfma_f32_16x16x32_bf16 v[216:219], a[168:171], v[48:51], v[216:219]
    ds_read_b64_tr_b16 a[190:191], v5 offset:12552
    v_cvt_pk_bf16_f32 v61, v74, v75
    v_mfma_f32_16x16x32_bf16 v[220:223], a[172:175], v[48:51], v[32:35]
    v_exp_f32 v76, v76
    v_mfma_f32_16x16x32_bf16 v[220:223], a[204:207], v[52:55], v[220:223]
    v_exp_f32 v77, v77
    v_mfma_f32_16x16x32_bf16 v[64:67], a[80:83], a[16:19], -4.0
    ds_read_b64_tr_b16 a[192:193], v5 offset:8704
    v_cvt_pk_bf16_f32 v62, v76, v77
    v_mfma_f32_16x16x32_bf16 v[64:67], a[84:87], a[20:23], v[64:67]
    v_exp_f32 v78, v78
    v_mfma_f32_16x16x32_bf16 v[64:67], a[88:91], a[24:27], v[64:67]
    ds_read_b64_tr_b16 a[194:195], v5 offset:12800
    ds_read_b64_tr_b16 a[160:161], v5 offset:512
    v_mfma_f32_16x16x32_bf16 v[64:67], a[92:95], a[28:31], v[64:67]
    v_exp_f32 v79, v79
    v_mfma_f32_16x16x32_bf16 v[68:71], a[108:111], a[28:31], -4.0
    ds_read_b64_tr_b16 a[162:163], v5 offset:4608
    v_cvt_pk_bf16_f32 v63, v78, v79
    v_mfma_f32_16x16x32_bf16 v[68:71], a[104:107], a[24:27], v[68:71]
    ds_read_b64_tr_b16 a[164:165], v5 offset:520
    ds_read_b64_tr_b16 a[166:167], v5 offset:4616
    v_mfma_f32_16x16x32_bf16 v[68:71], a[100:103], a[20:23], v[68:71]
    v_exp_f32 v64, v64
    v_mfma_f32_16x16x32_bf16 v[68:71], a[96:99], a[16:19], v[68:71]
    ds_read_b64_tr_b16 a[196:197], v5 offset:8712
    ds_read_b64_tr_b16 a[198:199], v5 offset:12808
    v_smfmac_f32_16x16x64_bf16 v[36:39], v[24:27], v[56:63], v9
    s_waitcnt lgkmcnt(7)
    ds_read_b64_tr_b16 a[200:201], v5 offset:8960
    ds_read_b64_tr_b16 a[202:203], v5 offset:13056
    v_mfma_f32_16x16x32_bf16 v[96:99], a[176:179], v[60:63], v[96:99]
    v_exp_f32 v65, v65
    v_mfma_f32_16x16x32_bf16 v[96:99], a[144:147], v[56:59], v[96:99]
    ds_read_b64_tr_b16 a[168:169], v5 offset:768
    ds_read_b64_tr_b16 a[170:171], v5 offset:4864
    v_mfma_f32_16x16x32_bf16 v[100:103], a[148:151], v[56:59], v[100:103]
    v_exp_f32 v66, v66
    v_mfma_f32_16x16x32_bf16 v[100:103], a[180:183], v[60:63], v[100:103]
    s_waitcnt vmcnt(6)
    ds_read_b128 a[64:67], v15 offset:0
    ds_read_b64_tr_b16 a[172:173], v5 offset:776
    v_mfma_f32_16x16x32_bf16 v[104:107], a[184:187], v[60:63], v[104:107]
    v_exp_f32 v67, v67
    v_mfma_f32_16x16x32_bf16 v[104:107], a[152:155], v[56:59], v[104:107]
    ds_read_b128 a[68:71], v15 offset:256
    ds_read_b64_tr_b16 a[174:175], v5 offset:4872
    v_mfma_f32_16x16x32_bf16 v[108:111], a[156:159], v[56:59], v[108:111]
    v_exp_f32 v68, v68
    v_mfma_f32_16x16x32_bf16 v[108:111], a[188:191], v[60:63], v[108:111]
    ds_read_b128 a[72:75], v15 offset:512
    ds_read_b64_tr_b16 a[204:205], v5 offset:8968
    v_mfma_f32_16x16x32_bf16 v[72:75], a[112:115], a[16:19], -4.0
    v_exp_f32 v69, v69
    v_mfma_f32_16x16x32_bf16 v[72:75], a[116:119], a[20:23], v[72:75]
    ds_read_b64_tr_b16 a[206:207], v5 offset:13064
    v_cvt_pk_bf16_f32 v48, v64, v65
    v_mfma_f32_16x16x32_bf16 v[72:75], a[120:123], a[24:27], v[72:75]
    v_exp_f32 v70, v70
    v_mfma_f32_16x16x32_bf16 v[72:75], a[124:127], a[28:31], v[72:75]
    ds_read_b128 a[76:79], v15 offset:768
    v_cvt_pk_bf16_f32 v49, v66, v67
    v_mfma_f32_16x16x32_bf16 v[76:79], a[140:143], a[28:31], -4.0
    v_exp_f32 v71, v71
    v_mfma_f32_16x16x32_bf16 v[76:79], a[136:139], a[24:27], v[76:79]
    v_cvt_pk_bf16_f32 v50, v68, v69
    v_cvt_pk_bf16_f32 v51, v70, v71
    v_mfma_f32_16x16x32_bf16 v[76:79], a[132:135], a[20:23], v[76:79]
    v_exp_f32 v72, v72
    v_mfma_f32_16x16x32_bf16 v[76:79], a[128:131], a[16:19], v[76:79]
    s_waitcnt lgkmcnt(2)
    v_exp_f32 v73, v73
    v_mfma_f32_16x16x32_bf16 v[112:115], a[192:195], v[60:63], v[112:115]
    v_exp_f32 v74, v74
    v_mfma_f32_16x16x32_bf16 v[112:115], a[160:163], v[56:59], v[112:115]
    s_mov_b32 m0, s26
    v_exp_f32 v75, v75
    v_mfma_f32_16x16x32_bf16 v[116:119], a[164:167], v[56:59], v[116:119]
    v_cvt_pk_bf16_f32 v52, v72, v73
    v_cvt_pk_bf16_f32 v53, v74, v75
    v_mfma_f32_16x16x32_bf16 v[116:119], a[196:199], v[60:63], v[116:119]
    v_exp_f32 v76, v76
    v_mfma_f32_16x16x32_bf16 v[120:123], a[200:203], v[60:63], v[120:123]
    v_exp_f32 v77, v77
    v_mfma_f32_16x16x32_bf16 v[120:123], a[168:171], v[56:59], v[120:123]
    s_waitcnt lgkmcnt(0)
    buffer_load_dwordx4 v2, s[8:11], s33 offen offset:0 nt lds
    v_cvt_pk_bf16_f32 v54, v76, v77
    v_mfma_f32_16x16x32_bf16 v[124:127], a[172:175], v[56:59], v[124:127]
    v_exp_f32 v78, v78
    v_mfma_f32_16x16x32_bf16 v[124:127], a[204:207], v[60:63], v[124:127]
    s_barrier
    v_mfma_f32_16x16x32_bf16 v[64:67], a[80:83], a[32:35], -4.0
    s_movk_i32 s35, 0x0
    buffer_load_dwordx4 v2, s[8:11], s33 offen offset:1024 nt lds
    v_mfma_f32_16x16x32_bf16 v[64:67], a[84:87], a[36:39], v[64:67]
    v_exp_f32 v79, v79
    v_mfma_f32_16x16x32_bf16 v[64:67], a[88:91], a[40:43], v[64:67]
    buffer_load_dwordx4 v2, s[8:11], s33 offen offset:2048 nt lds
    v_cvt_pk_bf16_f32 v55, v78, v79
    v_mfma_f32_16x16x32_bf16 v[64:67], a[92:95], a[44:47], v[64:67]
    buffer_load_dwordx4 v2, s[8:11], s33 offen offset:3072 nt lds
    v_mfma_f32_16x16x32_bf16 v[68:71], a[108:111], a[44:47], -4.0
    s_mov_b32 m0, s48
    v_mfma_f32_16x16x32_bf16 v[68:71], a[104:107], a[40:43], v[68:71]
    s_add_u32 s33, s33, s38
    buffer_load_dwordx4 v2, s[16:19], s35 offen offset:0 lds
    v_mfma_f32_16x16x32_bf16 v[68:71], a[100:103], a[36:39], v[68:71]
    v_exp_f32 v64, v64
    v_mfma_f32_16x16x32_bf16 v[68:71], a[96:99], a[32:35], v[68:71]
    v_exp_f32 v65, v65
    v_mfma_f32_16x16x32_bf16 v[16:19], v[224:227], v[240:243], 0
    v_exp_f32 v66, v66
    v_mfma_f32_16x16x32_bf16 v[16:19], v[224:227], v[244:247], v[16:19]
    buffer_load_dwordx4 v2, s[16:19], s35 offen offset:1024 lds
    v_cvt_pk_bf16_f32 v56, v64, v65
    v_mfma_f32_16x16x32_bf16 v[20:23], v[224:227], v[248:251], 0
    s_mov_b32 m0, s49
    v_exp_f32 v67, v67
    v_mfma_f32_16x16x32_bf16 v[20:23], v[224:227], v[252:255], v[20:23]
    s_movk_i32 s35, 0x2000
    v_exp_f32 v68, v68
    v_smfmac_f32_16x16x64_bf16 v[38:41], v[24:27], v[48:55], v9
    v_cvt_pk_bf16_f32 v57, v66, v67
    v_mfma_f32_16x16x32_bf16 v[128:131], a[176:179], v[52:55], v[128:131]
    v_exp_f32 v69, v69
    v_mfma_f32_16x16x32_bf16 v[128:131], a[144:147], v[48:51], v[128:131]
    buffer_load_dwordx4 v2, s[16:19], s35 offen offset:0 lds
    v_cvt_pk_bf16_f32 v224, v16, v20
    v_mfma_f32_16x16x32_bf16 v[132:135], a[148:151], v[48:51], v[132:135]
    v_exp_f32 v70, v70
    v_mfma_f32_16x16x32_bf16 v[132:135], a[180:183], v[52:55], v[132:135]
    v_cvt_pk_bf16_f32 v225, v17, v21
    v_cvt_pk_bf16_f32 v226, v18, v22
    v_mfma_f32_16x16x32_bf16 v[136:139], a[184:187], v[52:55], v[136:139]
    buffer_load_dwordx4 v2, s[16:19], s35 offen offset:1024 lds
    v_cvt_pk_bf16_f32 v227, v19, v23
    v_mfma_f32_16x16x32_bf16 v[136:139], a[152:155], v[48:51], v[136:139]
    s_mov_b32 m0, s25
    v_exp_f32 v71, v71
    v_mfma_f32_16x16x32_bf16 v[140:143], a[156:159], v[48:51], v[140:143]
    ds_write_addtid_b32 v224 offset:55300
    ds_write_addtid_b32 v225 offset:55556
    ds_write_addtid_b32 v226 offset:55812
    v_mfma_f32_16x16x32_bf16 v[140:143], a[188:191], v[52:55], v[140:143]
    ds_write_addtid_b32 v227 offset:56068
    v_cvt_pk_bf16_f32 v58, v68, v69
    v_mfma_f32_16x16x32_bf16 v[16:19], v[228:231], v[240:243], 0
    v_cvt_pk_bf16_f32 v59, v70, v71
    v_mfma_f32_16x16x32_bf16 v[16:19], v[228:231], v[244:247], v[16:19]
    v_mfma_f32_16x16x32_bf16 v[20:23], v[228:231], v[248:251], 0
    v_mfma_f32_16x16x32_bf16 v[20:23], v[228:231], v[252:255], v[20:23]
    v_mfma_f32_16x16x32_bf16 v[72:75], a[112:115], a[32:35], -4.0
    v_mfma_f32_16x16x32_bf16 v[72:75], a[116:119], a[36:39], v[72:75]
    v_mfma_f32_16x16x32_bf16 v[72:75], a[120:123], a[40:43], v[72:75]
    v_cvt_pk_bf16_f32 v228, v16, v20
    v_cvt_pk_bf16_f32 v229, v17, v21
    v_mfma_f32_16x16x32_bf16 v[72:75], a[124:127], a[44:47], v[72:75]
    v_cvt_pk_bf16_f32 v230, v18, v22
    v_cvt_pk_bf16_f32 v231, v19, v23
    v_mfma_f32_16x16x32_bf16 v[76:79], a[140:143], a[44:47], -4.0
    ds_write_addtid_b32 v228 offset:56324
    ds_write_addtid_b32 v229 offset:56580
    v_mfma_f32_16x16x32_bf16 v[76:79], a[136:139], a[40:43], v[76:79]
    ds_write_addtid_b32 v230 offset:56836
    ds_write_addtid_b32 v231 offset:57092
    v_mfma_f32_16x16x32_bf16 v[76:79], a[132:135], a[36:39], v[76:79]
    v_exp_f32 v72, v72
    v_mfma_f32_16x16x32_bf16 v[76:79], a[128:131], a[32:35], v[76:79]
    s_waitcnt vmcnt(13)
    v_exp_f32 v73, v73
    v_mfma_f32_16x16x32_bf16 v[16:19], v[232:235], v[240:243], 0
    v_exp_f32 v74, v74
    v_mfma_f32_16x16x32_bf16 v[16:19], v[232:235], v[244:247], v[16:19]
    v_exp_f32 v75, v75
    v_mfma_f32_16x16x32_bf16 v[20:23], v[232:235], v[248:251], 0
    v_cvt_pk_bf16_f32 v60, v72, v73
    v_cvt_pk_bf16_f32 v61, v74, v75
    v_mfma_f32_16x16x32_bf16 v[20:23], v[232:235], v[252:255], v[20:23]
    v_exp_f32 v76, v76
    v_mfma_f32_16x16x32_bf16 v[144:147], a[192:195], v[52:55], v[144:147]
    v_exp_f32 v77, v77
    v_mfma_f32_16x16x32_bf16 v[144:147], a[160:163], v[48:51], v[144:147]
    v_exp_f32 v78, v78
    v_mfma_f32_16x16x32_bf16 v[148:151], a[164:167], v[48:51], v[148:151]
    v_cvt_pk_bf16_f32 v232, v16, v20
    v_cvt_pk_bf16_f32 v233, v17, v21
    v_mfma_f32_16x16x32_bf16 v[148:151], a[196:199], v[52:55], v[148:151]
    v_exp_f32 v79, v79
    v_mfma_f32_16x16x32_bf16 v[152:155], a[200:203], v[52:55], v[152:155]
    v_cvt_pk_bf16_f32 v234, v18, v22
    v_cvt_pk_bf16_f32 v235, v19, v23
    v_mfma_f32_16x16x32_bf16 v[152:155], a[168:171], v[48:51], v[152:155]
    ds_write_addtid_b32 v232 offset:63492
    ds_write_addtid_b32 v233 offset:63748
    v_mfma_f32_16x16x32_bf16 v[156:159], a[172:175], v[48:51], v[156:159]
    ds_write_addtid_b32 v234 offset:64004
    ds_write_addtid_b32 v235 offset:64260
    v_mfma_f32_16x16x32_bf16 v[156:159], a[204:207], v[52:55], v[156:159]
    s_waitcnt vmcnt(12)
    v_cvt_pk_bf16_f32 v62, v76, v77
    v_cvt_pk_bf16_f32 v63, v78, v79
    v_mfma_f32_16x16x32_bf16 v[16:19], v[236:239], v[240:243], 0
    v_mfma_f32_16x16x32_bf16 v[16:19], v[236:239], v[244:247], v[16:19]
    v_mfma_f32_16x16x32_bf16 v[20:23], v[236:239], v[248:251], 0
    v_mfma_f32_16x16x32_bf16 v[20:23], v[236:239], v[252:255], v[20:23]
    v_mfma_f32_16x16x32_bf16 v[64:67], a[80:83], a[48:51], -4.0
    v_mfma_f32_16x16x32_bf16 v[64:67], a[84:87], a[52:55], v[64:67]
    v_mfma_f32_16x16x32_bf16 v[64:67], a[88:91], a[56:59], v[64:67]
    v_cvt_pk_bf16_f32 v236, v16, v20
    v_cvt_pk_bf16_f32 v237, v17, v21
    v_mfma_f32_16x16x32_bf16 v[64:67], a[92:95], a[60:63], v[64:67]
    v_cvt_pk_bf16_f32 v238, v18, v22
    v_cvt_pk_bf16_f32 v239, v19, v23
    v_mfma_f32_16x16x32_bf16 v[68:71], a[108:111], a[60:63], -4.0
    ds_write_addtid_b32 v236 offset:64516
    ds_write_addtid_b32 v237 offset:64772
    v_mfma_f32_16x16x32_bf16 v[68:71], a[104:107], a[56:59], v[68:71]
    ds_write_addtid_b32 v238 offset:65028
    ds_write_addtid_b32 v239 offset:65284
    v_mfma_f32_16x16x32_bf16 v[68:71], a[100:103], a[52:55], v[68:71]
    v_exp_f32 v64, v64
    v_mfma_f32_16x16x32_bf16 v[68:71], a[96:99], a[48:51], v[68:71]
    v_lshrrev_b32 v20, 2, v0
    v_lshrrev_b32 v19, 4, v0
    v_smfmac_f32_16x16x64_bf16 v[40:43], v[24:27], v[56:63], v9
    v_and_b32 v21, 3, v0
    v_mfma_f32_16x16x32_bf16 v[160:163], a[176:179], v[60:63], v[160:163]
    v_exp_f32 v65, v65
    v_mfma_f32_16x16x32_bf16 v[160:163], a[144:147], v[56:59], v[160:163]
    v_cvt_pk_bf16_f32 v48, v64, v65
    v_lshlrev_b32 v17, 8, v20
    v_mfma_f32_16x16x32_bf16 v[164:167], a[148:151], v[56:59], v[164:167]
    v_exp_f32 v66, v66
    v_mfma_f32_16x16x32_bf16 v[164:167], a[180:183], v[60:63], v[164:167]
    v_lshlrev_b32 v19, 2, v19
    v_lshl_add_u32 v17, v21, 4, v17
    v_mfma_f32_16x16x32_bf16 v[168:171], a[184:187], v[60:63], v[168:171]
    v_exp_f32 v67, v67
    v_mfma_f32_16x16x32_bf16 v[168:171], a[152:155], v[56:59], v[168:171]
    v_cvt_pk_bf16_f32 v49, v66, v67
    v_mul_u32_u24 v21, 20, v21
    v_mfma_f32_16x16x32_bf16 v[172:175], a[156:159], v[56:59], v[172:175]
    v_exp_f32 v68, v68
    v_mfma_f32_16x16x32_bf16 v[172:175], a[188:191], v[60:63], v[172:175]
    s_waitcnt lgkmcnt(0)
    v_xor_b32 v19, v19, v0
    v_xor_b32 v20, v20, v21
    v_mfma_f32_16x16x32_bf16 v[72:75], a[112:115], a[48:51], -4.0
    s_barrier
    v_mfma_f32_16x16x32_bf16 v[72:75], a[116:119], a[52:55], v[72:75]
    v_exp_f32 v69, v69
    v_mfma_f32_16x16x32_bf16 v[72:75], a[120:123], a[56:59], v[72:75]
    ds_read_b128 a[80:83], v4 offset:49152
    ds_read_b128 a[84:87], v4 offset:50176
    v_mfma_f32_16x16x32_bf16 v[72:75], a[124:127], a[60:63], v[72:75]
    v_exp_f32 v70, v70
    v_mfma_f32_16x16x32_bf16 v[76:79], a[140:143], a[60:63], -4.0
    ds_read_b128 a[88:91], v4 offset:51200
    ds_read_b128 a[92:95], v4 offset:52224
    v_mfma_f32_16x16x32_bf16 v[76:79], a[136:139], a[56:59], v[76:79]
    v_exp_f32 v71, v71
    v_mfma_f32_16x16x32_bf16 v[76:79], a[132:135], a[52:55], v[76:79]
    ds_read_b128 a[108:111], v4 offset:56320
    ds_read_b128 a[104:107], v4 offset:55296
    v_mfma_f32_16x16x32_bf16 v[76:79], a[128:131], a[48:51], v[76:79]
    v_exp_f32 v72, v72
    v_mfma_f32_16x16x32_bf16 v[176:179], a[192:195], v[60:63], v[176:179]
    v_cvt_pk_bf16_f32 v50, v68, v69
    v_cvt_pk_bf16_f32 v51, v70, v71
    v_mfma_f32_16x16x32_bf16 v[176:179], a[160:163], v[56:59], v[176:179]
    v_exp_f32 v73, v73
    v_mfma_f32_16x16x32_bf16 v[180:183], a[164:167], v[56:59], v[180:183]
    ds_read_b128 a[100:103], v4 offset:54272
    ds_read_b128 a[96:99], v4 offset:53248
    v_mfma_f32_16x16x32_bf16 v[180:183], a[196:199], v[60:63], v[180:183]
    v_exp_f32 v74, v74
    v_mfma_f32_16x16x32_bf16 v[184:187], a[200:203], v[60:63], v[184:187]
    ds_read_b128 a[112:115], v4 offset:57344
    v_cvt_pk_bf16_f32 v52, v72, v73
    v_mfma_f32_16x16x32_bf16 v[184:187], a[168:171], v[56:59], v[184:187]
    v_exp_f32 v75, v75
    v_mfma_f32_16x16x32_bf16 v[188:191], a[172:175], v[56:59], v[188:191]
    ds_read_b128 a[116:119], v4 offset:58368
    v_cvt_pk_bf16_f32 v53, v74, v75
    v_mfma_f32_16x16x32_bf16 v[188:191], a[204:207], v[60:63], v[188:191]
    s_waitcnt lgkmcnt(4)
    v_exp_f32 v76, v76
    v_mfma_f32_16x16x32_bf16 v[64:67], a[80:83], a[0:3], -4.0
    ds_read_b128 a[120:123], v4 offset:59392
    ds_read_b128 a[124:127], v4 offset:60416
    v_mfma_f32_16x16x32_bf16 v[64:67], a[84:87], a[4:7], v[64:67]
    v_exp_f32 v77, v77
    v_mfma_f32_16x16x32_bf16 v[64:67], a[88:91], a[8:11], v[64:67]
    ds_read_b128 a[140:143], v4 offset:64512
    v_cvt_pk_bf16_f32 v54, v76, v77
    v_mfma_f32_16x16x32_bf16 v[64:67], a[92:95], a[12:15], v[64:67]
    v_exp_f32 v78, v78
    v_mfma_f32_16x16x32_bf16 v[68:71], a[108:111], a[12:15], -4.0
    ds_read_b128 a[136:139], v4 offset:63488
    ds_read_b128 a[132:135], v4 offset:62464
    v_mfma_f32_16x16x32_bf16 v[68:71], a[104:107], a[8:11], v[68:71]
    s_waitcnt lgkmcnt(6)
    v_exp_f32 v79, v79
    v_mfma_f32_16x16x32_bf16 v[68:71], a[100:103], a[4:7], v[68:71]
    ds_read_b128 a[128:131], v4 offset:61440
    v_cvt_pk_bf16_f32 v55, v78, v79
    v_mfma_f32_16x16x32_bf16 v[68:71], a[96:99], a[0:3], v[68:71]
    s_waitcnt vmcnt(8)
    v_exp_f32 v64, v64
    v_smfmac_f32_16x16x64_bf16 v[42:45], v[24:27], v[48:55], v9
    s_barrier
    v_mfma_f32_16x16x32_bf16 v[192:195], a[176:179], v[52:55], v[192:195]
    v_exp_f32 v65, v65
    v_mfma_f32_16x16x32_bf16 v[192:195], a[144:147], v[48:51], v[192:195]
    ds_read_b64_tr_b16 a[176:177], v5 offset:24576
    v_cvt_pk_bf16_f32 v56, v64, v65
    v_mfma_f32_16x16x32_bf16 v[196:199], a[148:151], v[48:51], v[196:199]
    v_exp_f32 v66, v66
    v_mfma_f32_16x16x32_bf16 v[196:199], a[180:183], v[52:55], v[196:199]
    ds_read_b64_tr_b16 a[178:179], v5 offset:28672
    v_lshl_add_u32 v18, v19, 4, s26
    v_mfma_f32_16x16x32_bf16 v[200:203], a[184:187], v[52:55], v[200:203]
    v_exp_f32 v67, v67
    v_mfma_f32_16x16x32_bf16 v[200:203], a[152:155], v[48:51], v[200:203]
    ds_read_b64_tr_b16 a[144:145], v5 offset:16384
    v_cvt_pk_bf16_f32 v57, v66, v67
    v_mfma_f32_16x16x32_bf16 v[204:207], a[156:159], v[48:51], v[204:207]
    v_exp_f32 v68, v68
    v_mfma_f32_16x16x32_bf16 v[204:207], a[188:191], v[52:55], v[204:207]
    ds_read_b64_tr_b16 a[146:147], v5 offset:20480
    v_lshl_add_u32 v16, v20, 4, s26
    v_mfma_f32_16x16x32_bf16 v[72:75], a[112:115], a[0:3], -4.0
    s_waitcnt lgkmcnt(4)
    v_exp_f32 v69, v69
    v_mfma_f32_16x16x32_bf16 v[72:75], a[116:119], a[4:7], v[72:75]
    ds_read_b64_tr_b16 a[148:149], v5 offset:16392
    v_cvt_pk_bf16_f32 v58, v68, v69
    v_mfma_f32_16x16x32_bf16 v[72:75], a[120:123], a[8:11], v[72:75]
    v_exp_f32 v70, v70
    v_mfma_f32_16x16x32_bf16 v[72:75], a[124:127], a[12:15], v[72:75]
    v_exp_f32 v71, v71
    v_mfma_f32_16x16x32_bf16 v[76:79], a[140:143], a[12:15], -4.0
    ds_read_b64_tr_b16 a[150:151], v5 offset:20488
    v_cvt_pk_bf16_f32 v59, v70, v71
    v_mfma_f32_16x16x32_bf16 v[76:79], a[136:139], a[8:11], v[76:79]
    ds_read_b64_tr_b16 a[180:181], v5 offset:24584
    ds_read_b64_tr_b16 a[182:183], v5 offset:28680
    v_mfma_f32_16x16x32_bf16 v[76:79], a[132:135], a[4:7], v[76:79]
    v_exp_f32 v72, v72
    v_mfma_f32_16x16x32_bf16 v[76:79], a[128:131], a[0:3], v[76:79]
    ds_read_b64_tr_b16 a[184:185], v5 offset:24832
    ds_read_b64_tr_b16 a[186:187], v5 offset:28928
    v_mfma_f32_16x16x32_bf16 v[208:211], a[192:195], v[52:55], v[208:211]
    v_exp_f32 v73, v73
    v_mfma_f32_16x16x32_bf16 v[208:211], a[160:163], v[48:51], v[208:211]
    ds_read_b64_tr_b16 a[152:153], v5 offset:16640
    v_cvt_pk_bf16_f32 v60, v72, v73
    v_mfma_f32_16x16x32_bf16 v[212:215], a[164:167], v[48:51], v[212:215]
    v_exp_f32 v74, v74
    v_mfma_f32_16x16x32_bf16 v[212:215], a[196:199], v[52:55], v[212:215]
    ds_read_b64_tr_b16 a[154:155], v5 offset:20736
    ds_read_b64_tr_b16 a[156:157], v5 offset:16648
    v_mfma_f32_16x16x32_bf16 v[216:219], a[200:203], v[52:55], v[216:219]
    v_exp_f32 v75, v75
    v_mfma_f32_16x16x32_bf16 v[216:219], a[168:171], v[48:51], v[216:219]
    ds_read_b64_tr_b16 a[158:159], v5 offset:20744
    v_cvt_pk_bf16_f32 v61, v74, v75
    v_mfma_f32_16x16x32_bf16 v[220:223], a[172:175], v[48:51], v[220:223]
    v_exp_f32 v76, v76
    v_mfma_f32_16x16x32_bf16 v[220:223], a[204:207], v[52:55], v[220:223]
    ds_read_b64_tr_b16 a[188:189], v5 offset:24840
    ds_read_b64_tr_b16 a[190:191], v5 offset:28936
    v_mfma_f32_16x16x32_bf16 v[64:67], a[80:83], a[16:19], -4.0
    v_exp_f32 v77, v77
    v_mfma_f32_16x16x32_bf16 v[64:67], a[84:87], a[20:23], v[64:67]
    ds_read_b64_tr_b16 a[192:193], v5 offset:25088
    v_cvt_pk_bf16_f32 v62, v76, v77
    v_mfma_f32_16x16x32_bf16 v[64:67], a[88:91], a[24:27], v[64:67]
    v_exp_f32 v78, v78
    v_mfma_f32_16x16x32_bf16 v[64:67], a[92:95], a[28:31], v[64:67]
    ds_read_b64_tr_b16 a[194:195], v5 offset:29184
    ds_read_b64_tr_b16 a[160:161], v5 offset:16896
    v_mfma_f32_16x16x32_bf16 v[68:71], a[108:111], a[28:31], -4.0
    v_exp_f32 v79, v79
    v_mfma_f32_16x16x32_bf16 v[68:71], a[104:107], a[24:27], v[68:71]
    ds_read_b64_tr_b16 a[162:163], v5 offset:20992
    v_cvt_pk_bf16_f32 v63, v78, v79
    v_mfma_f32_16x16x32_bf16 v[68:71], a[100:103], a[20:23], v[68:71]
    v_exp_f32 v64, v64
    v_mfma_f32_16x16x32_bf16 v[68:71], a[96:99], a[16:19], v[68:71]
    ds_read_b64_tr_b16 a[164:165], v5 offset:16904
    ds_read_b64_tr_b16 a[166:167], v5 offset:21000
    v_smfmac_f32_16x16x64_bf16 v[36:39], v[24:27], v[56:63], v9
    s_waitcnt lgkmcnt(6)
    ds_read_b64_tr_b16 a[196:197], v5 offset:25096
    ds_read_b64_tr_b16 a[198:199], v5 offset:29192
    v_mfma_f32_16x16x32_bf16 v[96:99], a[176:179], v[60:63], v[96:99]
    v_exp_f32 v65, v65
    v_mfma_f32_16x16x32_bf16 v[96:99], a[144:147], v[56:59], v[96:99]
    ds_read_b64_tr_b16 a[200:201], v5 offset:25344
    ds_read_b64_tr_b16 a[202:203], v5 offset:29440
    v_mfma_f32_16x16x32_bf16 v[100:103], a[148:151], v[56:59], v[100:103]
L_st3:
    s_cbranch_execz L_st4
    v_exp_f32 v66, v66
    v_mfma_f32_16x16x32_bf16 v[100:103], a[180:183], v[60:63], v[100:103]
    ds_read_b64_tr_b16 a[168:169], v5 offset:17152
    ds_read_b64_tr_b16 a[170:171], v5 offset:21248
    v_mfma_f32_16x16x32_bf16 v[104:107], a[184:187], v[60:63], v[104:107]
    v_exp_f32 v67, v67
    v_mfma_f32_16x16x32_bf16 v[104:107], a[152:155], v[56:59], v[104:107]
    ds_read_b64_tr_b16 a[172:173], v5 offset:17160
    ds_read_b64_tr_b16 a[174:175], v5 offset:21256
    v_mfma_f32_16x16x32_bf16 v[108:111], a[156:159], v[56:59], v[108:111]
    v_exp_f32 v68, v68
    v_mfma_f32_16x16x32_bf16 v[108:111], a[188:191], v[60:63], v[108:111]
    ds_read_b64_tr_b16 a[204:205], v5 offset:25352
    ds_read_b64_tr_b16 a[206:207], v5 offset:29448
    v_mfma_f32_16x16x32_bf16 v[72:75], a[112:115], a[16:19], -4.0
    v_exp_f32 v69, v69
    v_mfma_f32_16x16x32_bf16 v[72:75], a[116:119], a[20:23], v[72:75]
    v_cvt_pk_bf16_f32 v48, v64, v65
    v_cvt_pk_bf16_f32 v49, v66, v67
    v_mfma_f32_16x16x32_bf16 v[72:75], a[120:123], a[24:27], v[72:75]
    v_exp_f32 v70, v70
    v_mfma_f32_16x16x32_bf16 v[72:75], a[124:127], a[28:31], v[72:75]
    v_cvt_pk_bf16_f32 v50, v68, v69
    v_add_f32 v28, v36, v37
    v_mfma_f32_16x16x32_bf16 v[76:79], a[140:143], a[28:31], -4.0
    v_exp_f32 v71, v71
    v_mfma_f32_16x16x32_bf16 v[76:79], a[136:139], a[24:27], v[76:79]
    v_cvt_pk_bf16_f32 v51, v70, v71
    v_mov_b64 v[36:37], 0
    v_mfma_f32_16x16x32_bf16 v[76:79], a[132:135], a[20:23], v[76:79]
    v_rcp_f32 v12, v28
    v_mfma_f32_16x16x32_bf16 v[76:79], a[128:131], a[16:19], v[76:79]
    s_waitcnt lgkmcnt(0)
    v_mul_f32_e64 v30, -v32, v12
    v_subrev_u32 v28, s30, v28
    v_mfma_f32_16x16x32_bf16 v[112:115], a[192:195], v[60:63], v[112:115]
    v_exp_f32 v72, v72
    v_mfma_f32_16x16x32_bf16 v[112:115], a[160:163], v[56:59], v[112:115]
    v_fma_f32 v96, v96, v12, v30
    v_fma_f32 v97, v97, v12, v30
    v_mfma_f32_16x16x32_bf16 v[116:119], a[164:167], v[56:59], v[116:119]
    v_exp_f32 v73, v73
    v_mfma_f32_16x16x32_bf16 v[116:119], a[196:199], v[60:63], v[116:119]
    v_cvt_pk_bf16_f32 v52, v72, v73
    v_fma_f32 v98, v98, v12, v30
    v_mfma_f32_16x16x32_bf16 v[120:123], a[200:203], v[60:63], v[120:123]
    v_exp_f32 v74, v74
    v_mfma_f32_16x16x32_bf16 v[120:123], a[168:171], v[56:59], v[120:123]
    v_fma_f32 v99, v99, v12, v30
    v_fma_f32 v100, v100, v12, v30
    v_mfma_f32_16x16x32_bf16 v[124:127], a[172:175], v[56:59], v[124:127]
    v_exp_f32 v75, v75
    v_mfma_f32_16x16x32_bf16 v[124:127], a[204:207], v[60:63], v[124:127]
    s_barrier
    v_mfma_f32_16x16x32_bf16 v[64:67], a[80:83], a[32:35], -4.0
    s_movk_i32 s35, 0x4000
    v_exp_f32 v76, v76
    v_mfma_f32_16x16x32_bf16 v[64:67], a[84:87], a[36:39], v[64:67]
    v_cvt_pk_bf16_f32 v53, v74, v75
    v_max3_f32 v14, abs(v96), abs(v97), abs(v98)
    v_mfma_f32_16x16x32_bf16 v[64:67], a[88:91], a[40:43], v[64:67]
    s_mov_b32 m0, s50
    v_exp_f32 v77, v77
    v_mfma_f32_16x16x32_bf16 v[64:67], a[92:95], a[44:47], v[64:67]
    v_exp_f32 v78, v78
    v_mfma_f32_16x16x32_bf16 v[68:71], a[108:111], a[44:47], -4.0
    v_exp_f32 v79, v79
    v_mfma_f32_16x16x32_bf16 v[68:71], a[104:107], a[40:43], v[68:71]
    buffer_load_dwordx4 v2, s[16:19], s35 offen offset:0 lds
    v_mfma_f32_16x16x32_bf16 v[68:71], a[100:103], a[36:39], v[68:71]
    v_cvt_pk_bf16_f32 v54, v76, v77
    v_cvt_pk_bf16_f32 v55, v78, v79
    v_mfma_f32_16x16x32_bf16 v[68:71], a[96:99], a[32:35], v[68:71]
    v_exp_f32 v64, v64
    v_smfmac_f32_16x16x64_bf16 v[38:41], v[24:27], v[48:55], v9
    v_fma_f32 v101, v101, v12, v30
    v_mfma_f32_16x16x32_bf16 v[128:131], a[176:179], v[52:55], v[128:131]
    buffer_load_dwordx4 v2, s[16:19], s35 offen offset:1024 lds
    v_mfma_f32_16x16x32_bf16 v[128:131], a[144:147], v[48:51], v[128:131]
    s_mov_b32 m0, s51
    v_exp_f32 v65, v65
    v_mfma_f32_16x16x32_bf16 v[132:135], a[148:151], v[48:51], v[132:135]
    s_movk_i32 s35, 0x6000
    v_cvt_pk_bf16_f32 v56, v64, v65
    v_fma_f32 v102, v102, v12, v30
    v_mfma_f32_16x16x32_bf16 v[132:135], a[180:183], v[52:55], v[132:135]
    v_exp_f32 v66, v66
    v_mfma_f32_16x16x32_bf16 v[136:139], a[184:187], v[52:55], v[136:139]
    buffer_load_dwordx4 v2, s[16:19], s35 offen offset:0 lds
    v_mfma_f32_16x16x32_bf16 v[136:139], a[152:155], v[48:51], v[136:139]
    v_exp_f32 v67, v67
    v_mfma_f32_16x16x32_bf16 v[140:143], a[156:159], v[48:51], v[140:143]
    v_cvt_pk_bf16_f32 v57, v66, v67
    v_fma_f32 v103, v103, v12, v30
    v_mfma_f32_16x16x32_bf16 v[140:143], a[188:191], v[52:55], v[140:143]
    v_exp_f32 v68, v68
    v_mfma_f32_16x16x32_bf16 v[72:75], a[112:115], a[32:35], -4.0
    buffer_load_dwordx4 v2, s[16:19], s35 offen offset:1024 lds
    v_mfma_f32_16x16x32_bf16 v[72:75], a[116:119], a[36:39], v[72:75]
    v_exp_f32 v69, v69
    v_mfma_f32_16x16x32_bf16 v[72:75], a[120:123], a[40:43], v[72:75]
    v_cvt_pk_bf16_f32 v58, v68, v69
    v_max3_f32 v14, v14, abs(v99), abs(v100)
    v_mfma_f32_16x16x32_bf16 v[72:75], a[124:127], a[44:47], v[72:75]
    v_exp_f32 v70, v70
    v_mfma_f32_16x16x32_bf16 v[76:79], a[140:143], a[44:47], -4.0
    v_fma_f32 v104, v104, v12, v30
    v_fma_f32 v105, v105, v12, v30
    v_mfma_f32_16x16x32_bf16 v[76:79], a[136:139], a[40:43], v[76:79]
    v_exp_f32 v71, v71
    v_mfma_f32_16x16x32_bf16 v[76:79], a[132:135], a[36:39], v[76:79]
    v_cvt_pk_bf16_f32 v59, v70, v71
    v_fma_f32 v106, v106, v12, v30
    v_mfma_f32_16x16x32_bf16 v[76:79], a[128:131], a[32:35], v[76:79]
    v_exp_f32 v72, v72
    v_mfma_f32_16x16x32_bf16 v[144:147], a[192:195], v[52:55], v[144:147]
    v_fma_f32 v107, v107, v12, v30
    v_fma_f32 v108, v108, v12, v30
    v_mfma_f32_16x16x32_bf16 v[144:147], a[160:163], v[48:51], v[144:147]
    v_exp_f32 v73, v73
    v_mfma_f32_16x16x32_bf16 v[148:151], a[164:167], v[48:51], v[148:151]
    v_cvt_pk_bf16_f32 v60, v72, v73
    v_fma_f32 v109, v109, v12, v30
    v_mfma_f32_16x16x32_bf16 v[148:151], a[196:199], v[52:55], v[148:151]
    v_exp_f32 v74, v74
    v_mfma_f32_16x16x32_bf16 v[152:155], a[200:203], v[52:55], v[152:155]
    v_fma_f32 v110, v110, v12, v30
    v_fma_f32 v111, v111, v12, v30
    v_mfma_f32_16x16x32_bf16 v[152:155], a[168:171], v[48:51], v[152:155]
    v_exp_f32 v75, v75
    v_mfma_f32_16x16x32_bf16 v[156:159], a[172:175], v[48:51], v[156:159]
    v_cvt_pk_bf16_f32 v61, v74, v75
    v_fma_f32 v14, v14, s42, v30
    v_mfma_f32_16x16x32_bf16 v[156:159], a[204:207], v[52:55], v[156:159]
    v_exp_f32 v76, v76
    v_mfma_f32_16x16x32_bf16 v[64:67], a[80:83], a[48:51], -4.0
    v_cvt_pk_bf16_f32 v96, v96, v97
    v_cvt_pk_bf16_f32 v104, v104, v105
    v_mfma_f32_16x16x32_bf16 v[64:67], a[84:87], a[52:55], v[64:67]
    v_exp_f32 v77, v77
    v_mfma_f32_16x16x32_bf16 v[64:67], a[88:91], a[56:59], v[64:67]
    v_cvt_pk_bf16_f32 v62, v76, v77
    v_cvt_pk_bf16_f32 v97, v98, v99
    v_mfma_f32_16x16x32_bf16 v[64:67], a[92:95], a[60:63], v[64:67]
    v_exp_f32 v78, v78
    v_mfma_f32_16x16x32_bf16 v[68:71], a[108:111], a[60:63], -4.0
    v_cvt_pk_bf16_f32 v98, v100, v101
    v_cvt_pk_bf16_f32 v99, v102, v103
    v_mfma_f32_16x16x32_bf16 v[68:71], a[104:107], a[56:59], v[68:71]
    v_exp_f32 v79, v79
    v_mfma_f32_16x16x32_bf16 v[68:71], a[100:103], a[52:55], v[68:71]
    v_cvt_pk_bf16_f32 v63, v78, v79
    v_cvt_pk_bf16_f32 v105, v106, v107
    v_mfma_f32_16x16x32_bf16 v[68:71], a[96:99], a[48:51], v[68:71]
    v_exp_f32 v64, v64
    v_smfmac_f32_16x16x64_bf16 v[40:43], v[24:27], v[56:63], v9
    v_cvt_pk_bf16_f32 v106, v108, v109
    v_mfma_f32_16x16x32_bf16 v[160:163], a[176:179], v[60:63], v[160:163]
    v_exp_f32 v65, v65
    v_mfma_f32_16x16x32_bf16 v[160:163], a[144:147], v[56:59], v[160:163]
    v_cvt_pk_bf16_f32 v48, v64, v65
    v_cvt_pk_bf16_f32 v107, v110, v111
    v_mfma_f32_16x16x32_bf16 v[164:167], a[148:151], v[56:59], v[164:167]
    v_exp_f32 v66, v66
    v_mfma_f32_16x16x32_bf16 v[164:167], a[180:183], v[60:63], v[164:167]
    v_and_or_b32 v14, v14, s43, v28
    v_cndmask_b32_dpp v100, v104, v96, vcc row_ror:8 row_mask:0xf bank_mask:0xf
    v_mfma_f32_16x16x32_bf16 v[168:171], a[184:187], v[60:63], v[168:171]
    v_exp_f32 v67, v67
    v_mfma_f32_16x16x32_bf16 v[168:171], a[152:155], v[56:59], v[168:171]
    v_cvt_pk_bf16_f32 v49, v66, v67
    v_cmp_lt_u32_e64 s[4:5], s31, v14
    v_mfma_f32_16x16x32_bf16 v[172:175], a[156:159], v[56:59], v[172:175]
    v_exp_f32 v68, v68
    v_mfma_f32_16x16x32_bf16 v[172:175], a[188:191], v[60:63], v[172:175]
    v_cndmask_b32_dpp v101, v105, v97, vcc row_ror:8 row_mask:0xf bank_mask:0xf
    v_cndmask_b32_dpp v102, v106, v98, vcc row_ror:8 row_mask:0xf bank_mask:0xf
    v_mfma_f32_16x16x32_bf16 v[72:75], a[112:115], a[48:51], -4.0
    v_exp_f32 v69, v69
    v_mfma_f32_16x16x32_bf16 v[72:75], a[116:119], a[52:55], v[72:75]
    v_cvt_pk_bf16_f32 v50, v68, v69
    v_cndmask_b32_dpp v103, v107, v99, vcc row_ror:8 row_mask:0xf bank_mask:0xf
    v_mfma_f32_16x16x32_bf16 v[72:75], a[120:123], a[56:59], v[72:75]
    v_exp_f32 v70, v70
    v_mfma_f32_16x16x32_bf16 v[72:75], a[124:127], a[60:63], v[72:75]
    v_mov_b32_dpp v104, v96 row_ror:8 row_mask:0xf bank_mask:0x3
    v_mov_b32_dpp v105, v97 row_ror:8 row_mask:0xf bank_mask:0x3
    v_mfma_f32_16x16x32_bf16 v[76:79], a[140:143], a[60:63], -4.0
    v_exp_f32 v71, v71
    v_mfma_f32_16x16x32_bf16 v[76:79], a[136:139], a[56:59], v[76:79]
    s_waitcnt vmcnt(8)
    ds_read_b128 a[0:3], v15 offset:0
    v_cvt_pk_bf16_f32 v51, v70, v71
    v_mfma_f32_16x16x32_bf16 v[76:79], a[132:135], a[52:55], v[76:79]
    v_exp_f32 v72, v72
    v_mfma_f32_16x16x32_bf16 v[76:79], a[128:131], a[48:51], v[76:79]
    ds_read_b128 a[4:7], v15 offset:256
    v_mov_b32_dpp v106, v98 row_ror:8 row_mask:0xf bank_mask:0x3
    v_mfma_f32_16x16x32_bf16 v[176:179], a[192:195], v[60:63], v[176:179]
    v_exp_f32 v73, v73
    v_mfma_f32_16x16x32_bf16 v[176:179], a[160:163], v[56:59], v[176:179]
    v_cvt_pk_bf16_f32 v52, v72, v73
    v_mov_b32_dpp v107, v99 row_ror:8 row_mask:0xf bank_mask:0x3
    v_mfma_f32_16x16x32_bf16 v[180:183], a[164:167], v[56:59], v[180:183]
    v_exp_f32 v74, v74
    v_mfma_f32_16x16x32_bf16 v[180:183], a[196:199], v[60:63], v[180:183]
    ds_read_b128 a[8:11], v15 offset:512
    v_fma_f32 v112, v112, v12, v30
    v_mfma_f32_16x16x32_bf16 v[184:187], a[200:203], v[60:63], v[184:187]
    v_exp_f32 v75, v75
    v_mfma_f32_16x16x32_bf16 v[184:187], a[168:171], v[56:59], v[184:187]
    ds_read_b128 a[12:15], v15 offset:768
    v_cvt_pk_bf16_f32 v53, v74, v75
    v_mfma_f32_16x16x32_bf16 v[188:191], a[172:175], v[56:59], v[188:191]
    v_exp_f32 v76, v76
    v_mfma_f32_16x16x32_bf16 v[188:191], a[204:207], v[60:63], v[188:191]
    v_fma_f32 v113, v113, v12, v30
    v_fma_f32 v114, v114, v12, v30
    v_mfma_f32_16x16x32_bf16 v[64:67], a[80:83], a[64:67], -4.0
    v_exp_f32 v77, v77
    v_mfma_f32_16x16x32_bf16 v[64:67], a[84:87], a[68:71], v[64:67]
    v_cvt_pk_bf16_f32 v54, v76, v77
    v_fma_f32 v115, v115, v12, v30
    v_mfma_f32_16x16x32_bf16 v[64:67], a[88:91], a[72:75], v[64:67]
    v_exp_f32 v78, v78
    v_mfma_f32_16x16x32_bf16 v[64:67], a[92:95], a[76:79], v[64:67]
    v_exp_f32 v79, v79
    v_mfma_f32_16x16x32_bf16 v[68:71], a[108:111], a[76:79], -4.0
    v_cvt_pk_bf16_f32 v55, v78, v79
    v_mfma_f32_16x16x32_bf16 v[68:71], a[104:107], a[72:75], v[68:71]
    v_mfma_f32_16x16x32_bf16 v[68:71], a[100:103], a[68:71], v[68:71]
    v_exp_f32 v64, v64
    v_mfma_f32_16x16x32_bf16 v[68:71], a[96:99], a[64:67], v[68:71]
    v_exp_f32 v65, v65
    v_smfmac_f32_16x16x64_bf16 v[42:45], v[24:27], v[48:55], v9
    s_mov_b32 m0, s26
    v_cvt_pk_bf16_f32 v56, v64, v65
    v_mfma_f32_16x16x32_bf16 v[192:195], a[176:179], v[52:55], v[192:195]
    v_exp_f32 v66, v66
    v_mfma_f32_16x16x32_bf16 v[192:195], a[144:147], v[48:51], v[192:195]
    v_exp_f32 v67, v67
    v_mfma_f32_16x16x32_bf16 v[196:199], a[148:151], v[48:51], v[196:199]
    s_waitcnt lgkmcnt(0)
    buffer_load_dwordx4 v2, s[8:11], s33 offen offset:0 nt lds
    v_mfma_f32_16x16x32_bf16 v[196:199], a[180:183], v[52:55], v[196:199]
    v_exp_f32 v68, v68
    v_mfma_f32_16x16x32_bf16 v[200:203], a[184:187], v[52:55], v[200:203]
    v_exp_f32 v69, v69
    v_mfma_f32_16x16x32_bf16 v[200:203], a[152:155], v[48:51], v[200:203]
    v_cvt_pk_bf16_f32 v57, v66, v67
    v_cvt_pk_bf16_f32 v58, v68, v69
    v_mfma_f32_16x16x32_bf16 v[204:207], a[156:159], v[48:51], v[204:207]
    buffer_load_dwordx4 v2, s[8:11], s33 offen offset:1024 nt lds
    v_mfma_f32_16x16x32_bf16 v[204:207], a[188:191], v[52:55], v[204:207]
    v_exp_f32 v70, v70
    v_mfma_f32_16x16x32_bf16 v[72:75], a[112:115], a[64:67], -4.0
    v_exp_f32 v71, v71
    v_mfma_f32_16x16x32_bf16 v[72:75], a[116:119], a[68:71], v[72:75]
    v_cvt_pk_bf16_f32 v59, v70, v71
    v_mfma_f32_16x16x32_bf16 v[72:75], a[120:123], a[72:75], v[72:75]
    buffer_load_dwordx4 v2, s[8:11], s33 offen offset:2048 nt lds
    v_mfma_f32_16x16x32_bf16 v[72:75], a[124:127], a[76:79], v[72:75]
    v_mfma_f32_16x16x32_bf16 v[76:79], a[140:143], a[76:79], -4.0
    v_mfma_f32_16x16x32_bf16 v[76:79], a[136:139], a[72:75], v[76:79]
    v_mfma_f32_16x16x32_bf16 v[76:79], a[132:135], a[68:71], v[76:79]
    buffer_load_dwordx4 v2, s[8:11], s33 offen offset:3072 nt lds
    v_mfma_f32_16x16x32_bf16 v[76:79], a[128:131], a[64:67], v[76:79]
    s_add_u32 s33, s33, s38
    v_exp_f32 v72, v72
    v_mfma_f32_16x16x32_bf16 v[208:211], a[192:195], v[52:55], v[208:211]
    v_exp_f32 v73, v73
    v_mfma_f32_16x16x32_bf16 v[208:211], a[160:163], v[48:51], v[208:211]
    v_exp_f32 v74, v74
    v_mfma_f32_16x16x32_bf16 v[212:215], a[164:167], v[48:51], v[212:215]
    v_exp_f32 v75, v75
    v_mfma_f32_16x16x32_bf16 v[212:215], a[196:199], v[52:55], v[212:215]
    v_cvt_pk_bf16_f32 v60, v72, v73
    v_cvt_pk_bf16_f32 v61, v74, v75
    v_mfma_f32_16x16x32_bf16 v[216:219], a[200:203], v[52:55], v[216:219]
    v_exp_f32 v76, v76
    v_mfma_f32_16x16x32_bf16 v[216:219], a[168:171], v[48:51], v[216:219]
    v_exp_f32 v77, v77
    v_mfma_f32_16x16x32_bf16 v[220:223], a[172:175], v[48:51], v[220:223]
    v_exp_f32 v78, v78
    v_mfma_f32_16x16x32_bf16 v[220:223], a[204:207], v[52:55], v[220:223]
    v_exp_f32 v79, v79
    v_mfma_f32_16x16x32_bf16 v[64:67], a[208:211], a[16:19], -4.0
    v_cvt_pk_bf16_f32 v62, v76, v77
    v_cvt_pk_bf16_f32 v63, v78, v79
    v_mfma_f32_16x16x32_bf16 v[64:67], a[212:215], a[20:23], v[64:67]
    v_mfma_f32_16x16x32_bf16 v[64:67], a[216:219], a[24:27], v[64:67]
    v_mfma_f32_16x16x32_bf16 v[64:67], a[220:223], a[28:31], v[64:67]
    v_mfma_f32_16x16x32_bf16 v[68:71], a[236:239], a[28:31], -4.0
    v_mfma_f32_16x16x32_bf16 v[68:71], a[232:235], a[24:27], v[68:71]
    v_mfma_f32_16x16x32_bf16 v[68:71], a[228:231], a[20:23], v[68:71]
    v_exp_f32 v64, v64
    v_mfma_f32_16x16x32_bf16 v[68:71], a[224:227], a[16:19], v[68:71]
    s_waitcnt vmcnt(8)
    v_exp_f32 v65, v65
    v_smfmac_f32_16x16x64_bf16 v[44:47], v[24:27], v[56:63], v9
    s_barrier
    v_mfma_f32_16x16x32_bf16 v[224:227], a[176:179], v[60:63], v[32:35]
    v_exp_f32 v66, v66
    v_mfma_f32_16x16x32_bf16 v[224:227], a[144:147], v[56:59], v[224:227]
    ds_read_b64_tr_b16 a[176:177], v5 offset:8192
    v_cvt_pk_bf16_f32 v48, v64, v65
    v_mfma_f32_16x16x32_bf16 v[228:231], a[148:151], v[56:59], v[32:35]
    v_exp_f32 v67, v67
    v_mfma_f32_16x16x32_bf16 v[228:231], a[180:183], v[60:63], v[228:231]
    ds_read_b64_tr_b16 a[178:179], v5 offset:12288
    v_cvt_pk_bf16_f32 v49, v66, v67
    v_mfma_f32_16x16x32_bf16 v[232:235], a[184:187], v[60:63], v[32:35]
    v_exp_f32 v68, v68
    v_mfma_f32_16x16x32_bf16 v[232:235], a[152:155], v[56:59], v[232:235]
    v_exp_f32 v69, v69
    v_mfma_f32_16x16x32_bf16 v[236:239], a[156:159], v[56:59], v[32:35]
    ds_read_b64_tr_b16 a[144:145], v5 offset:0
    v_cvt_pk_bf16_f32 v50, v68, v69
    v_mfma_f32_16x16x32_bf16 v[236:239], a[188:191], v[60:63], v[236:239]
    v_exp_f32 v70, v70
    v_mfma_f32_16x16x32_bf16 v[72:75], a[240:243], a[16:19], -4.0
    v_exp_f32 v71, v71
    v_mfma_f32_16x16x32_bf16 v[72:75], a[244:247], a[20:23], v[72:75]
    ds_read_b64_tr_b16 a[146:147], v5 offset:4096
    v_cvt_pk_bf16_f32 v51, v70, v71
    v_mfma_f32_16x16x32_bf16 v[72:75], a[248:251], a[24:27], v[72:75]
    ds_read_b64_tr_b16 a[148:149], v5 offset:8
    v_mfma_f32_16x16x32_bf16 v[72:75], a[252:255], a[28:31], v[72:75]
    ds_read_b64_tr_b16 a[150:151], v5 offset:4104
    v_mfma_f32_16x16x32_bf16 v[76:79], v[92:95], a[28:31], -4.0
    ds_read_b64_tr_b16 a[180:181], v5 offset:8200
    ds_read_b64_tr_b16 a[182:183], v5 offset:12296
    v_mfma_f32_16x16x32_bf16 v[76:79], v[88:91], a[24:27], v[76:79]
    ds_read_b64_tr_b16 a[184:185], v5 offset:8448
    ds_read_b64_tr_b16 a[186:187], v5 offset:12544
    v_mfma_f32_16x16x32_bf16 v[76:79], v[84:87], a[20:23], v[76:79]
    v_exp_f32 v72, v72
    v_mfma_f32_16x16x32_bf16 v[76:79], v[80:83], a[16:19], v[76:79]
    ds_read_b64_tr_b16 a[152:153], v5 offset:256
    ds_read_b64_tr_b16 a[154:155], v5 offset:4352
    v_mfma_f32_16x16x32_bf16 v[240:243], a[192:195], v[60:63], v[32:35]
    v_exp_f32 v73, v73
    v_mfma_f32_16x16x32_bf16 v[240:243], a[160:163], v[56:59], v[240:243]
    ds_read_b64_tr_b16 a[156:157], v5 offset:264
    v_cvt_pk_bf16_f32 v52, v72, v73
    v_mfma_f32_16x16x32_bf16 v[244:247], a[164:167], v[56:59], v[32:35]
    v_exp_f32 v74, v74
    v_mfma_f32_16x16x32_bf16 v[244:247], a[196:199], v[60:63], v[244:247]
    ds_read_b64_tr_b16 a[158:159], v5 offset:4360
    ds_read_b64_tr_b16 a[188:189], v5 offset:8456
    v_mfma_f32_16x16x32_bf16 v[248:251], a[200:203], v[60:63], v[32:35]
    v_exp_f32 v75, v75
    v_mfma_f32_16x16x32_bf16 v[248:251], a[168:171], v[56:59], v[248:251]
    ds_read_b64_tr_b16 a[190:191], v5 offset:12552
    v_cvt_pk_bf16_f32 v53, v74, v75
    v_mfma_f32_16x16x32_bf16 v[252:255], a[172:175], v[56:59], v[32:35]
    v_exp_f32 v76, v76
    v_mfma_f32_16x16x32_bf16 v[252:255], a[204:207], v[60:63], v[252:255]
    ds_read_b64_tr_b16 a[192:193], v5 offset:8704
    ds_read_b64_tr_b16 a[194:195], v5 offset:12800
    v_mfma_f32_16x16x32_bf16 v[64:67], a[208:211], a[32:35], -4.0
    v_exp_f32 v77, v77
    v_mfma_f32_16x16x32_bf16 v[64:67], a[212:215], a[36:39], v[64:67]
    ds_read_b64_tr_b16 a[160:161], v5 offset:512
    v_cvt_pk_bf16_f32 v54, v76, v77
    v_mfma_f32_16x16x32_bf16 v[64:67], a[216:219], a[40:43], v[64:67]
    v_exp_f32 v78, v78
    v_mfma_f32_16x16x32_bf16 v[64:67], a[220:223], a[44:47], v[64:67]
    v_exp_f32 v79, v79
    v_mfma_f32_16x16x32_bf16 v[68:71], a[236:239], a[44:47], -4.0
    v_cvt_pk_bf16_f32 v55, v78, v79
    v_mfma_f32_16x16x32_bf16 v[68:71], a[232:235], a[40:43], v[68:71]
    v_mfma_f32_16x16x32_bf16 v[68:71], a[228:231], a[36:39], v[68:71]
    v_exp_f32 v64, v64
    v_mfma_f32_16x16x32_bf16 v[68:71], a[224:227], a[32:35], v[68:71]
L_loop:
    v_smfmac_f32_16x16x64_bf16 v[38:41], v[24:27], v[48:55], v9
    s_waitcnt lgkmcnt(1)
    ds_read_b64_tr_b16 a[162:163], v5 offset:4608
    ds_read_b64_tr_b16 a[164:165], v5 offset:520
    v_mfma_f32_16x16x32_bf16 v[128:131], a[176:179], v[52:55], v[128:131]
    v_exp_f32 v65, v65
    v_mfma_f32_16x16x32_bf16 v[128:131], a[144:147], v[48:51], v[128:131]
    ds_read_b64_tr_b16 a[166:167], v5 offset:4616
    ds_read_b64_tr_b16 a[196:197], v5 offset:8712
    v_mfma_f32_16x16x32_bf16 v[132:135], a[148:151], v[48:51], v[132:135]
    v_exp_f32 v66, v66
    v_mfma_f32_16x16x32_bf16 v[132:135], a[180:183], v[52:55], v[132:135]
    ds_read_b64_tr_b16 a[198:199], v5 offset:12808
    ds_read_b64_tr_b16 a[200:201], v5 offset:8960
    v_mfma_f32_16x16x32_bf16 v[136:139], a[184:187], v[52:55], v[136:139]
    v_exp_f32 v67, v67
    v_mfma_f32_16x16x32_bf16 v[136:139], a[152:155], v[48:51], v[136:139]
    ds_read_b64_tr_b16 a[202:203], v5 offset:13056
    ds_read_b64_tr_b16 a[168:169], v5 offset:768
    v_mfma_f32_16x16x32_bf16 v[140:143], a[156:159], v[48:51], v[140:143]
    s_waitcnt lgkmcnt(8)
    v_exp_f32 v68, v68
    v_mfma_f32_16x16x32_bf16 v[140:143], a[188:191], v[52:55], v[140:143]
    ds_read_b64_tr_b16 a[170:171], v5 offset:4864
    ds_read_b64_tr_b16 a[172:173], v5 offset:776
    v_mfma_f32_16x16x32_bf16 v[72:75], a[240:243], a[32:35], -4.0
    v_exp_f32 v69, v69
    v_mfma_f32_16x16x32_bf16 v[72:75], a[244:247], a[36:39], v[72:75]
    ds_read_b64_tr_b16 a[174:175], v5 offset:4872
    ds_read_b64_tr_b16 a[204:205], v5 offset:8968
    v_mfma_f32_16x16x32_bf16 v[72:75], a[248:251], a[40:43], v[72:75]
    v_exp_f32 v70, v70
    v_mfma_f32_16x16x32_bf16 v[72:75], a[252:255], a[44:47], v[72:75]
    ds_read_b64_tr_b16 a[206:207], v5 offset:13064
    v_cvt_pk_bf16_f32 v56, v64, v65
    v_mfma_f32_16x16x32_bf16 v[76:79], v[92:95], a[44:47], -4.0
    v_exp_f32 v71, v71
    v_mfma_f32_16x16x32_bf16 v[76:79], v[88:91], a[40:43], v[76:79]
    v_cvt_pk_bf16_f32 v57, v66, v67
    v_cvt_pk_bf16_f32 v58, v68, v69
    v_mfma_f32_16x16x32_bf16 v[76:79], v[84:87], a[36:39], v[76:79]
    v_exp_f32 v72, v72
    v_mfma_f32_16x16x32_bf16 v[76:79], v[80:83], a[32:35], v[76:79]
    v_cvt_pk_bf16_f32 v59, v70, v71
    v_add_f32 v29, v38, v39
    v_mfma_f32_16x16x32_bf16 v[144:147], a[192:195], v[52:55], v[144:147]
    s_waitcnt lgkmcnt(3)
    v_rcp_f32 v13, v29
    v_mfma_f32_16x16x32_bf16 v[144:147], a[160:163], v[48:51], v[144:147]
    v_mov_b64 v[38:39], 0
    v_mul_f32_e64 v31, -v32, v13
    v_mfma_f32_16x16x32_bf16 v[148:151], a[164:167], v[48:51], v[148:151]
    v_exp_f32 v73, v73
    v_mfma_f32_16x16x32_bf16 v[148:151], a[196:199], v[52:55], v[148:151]
    v_fma_f32 v116, v116, v12, v30
    v_cvt_pk_bf16_f32 v60, v72, v73
    v_mfma_f32_16x16x32_bf16 v[152:155], a[200:203], v[52:55], v[152:155]
    v_exp_f32 v74, v74
    v_mfma_f32_16x16x32_bf16 v[152:155], a[168:171], v[48:51], v[152:155]
    s_waitcnt lgkmcnt(0)
    v_fma_f32 v117, v117, v12, v30
    v_fma_f32 v118, v118, v12, v30
    v_mfma_f32_16x16x32_bf16 v[156:159], a[172:175], v[48:51], v[156:159]
    v_exp_f32 v75, v75
    v_mfma_f32_16x16x32_bf16 v[156:159], a[204:207], v[52:55], v[156:159]
    s_barrier
    v_mfma_f32_16x16x32_bf16 v[64:67], a[208:211], a[48:51], -4.0
    s_mov_b32 s35, 0x8000
    v_exp_f32 v76, v76
    v_mfma_f32_16x16x32_bf16 v[64:67], a[212:215], a[52:55], v[64:67]
    v_fma_f32 v119, v119, v12, v30
    v_cvt_pk_bf16_f32 v61, v74, v75
    v_mfma_f32_16x16x32_bf16 v[64:67], a[216:219], a[56:59], v[64:67]
    s_mov_b32 m0, s48
    v_exp_f32 v77, v77
    v_mfma_f32_16x16x32_bf16 v[64:67], a[220:223], a[60:63], v[64:67]
    v_exp_f32 v78, v78
    v_mfma_f32_16x16x32_bf16 v[68:71], a[236:239], a[60:63], -4.0
    v_exp_f32 v79, v79
    v_mfma_f32_16x16x32_bf16 v[68:71], a[232:235], a[56:59], v[68:71]
    buffer_load_dwordx4 v2, s[16:19], s35 offen offset:0 lds
    v_mfma_f32_16x16x32_bf16 v[68:71], a[228:231], a[52:55], v[68:71]
    v_cvt_pk_bf16_f32 v62, v76, v77
    v_cvt_pk_bf16_f32 v63, v78, v79
    v_mfma_f32_16x16x32_bf16 v[68:71], a[224:227], a[48:51], v[68:71]
    v_exp_f32 v64, v64
    v_smfmac_f32_16x16x64_bf16 v[40:43], v[24:27], v[56:63], v9
    v_fma_f32 v120, v120, v12, v30
    v_mfma_f32_16x16x32_bf16 v[160:163], a[176:179], v[60:63], v[160:163]
    buffer_load_dwordx4 v2, s[16:19], s35 offen offset:1024 lds
    v_mfma_f32_16x16x32_bf16 v[160:163], a[144:147], v[56:59], v[160:163]
    s_mov_b32 m0, s49
    v_exp_f32 v65, v65
    v_mfma_f32_16x16x32_bf16 v[164:167], a[148:151], v[56:59], v[164:167]
    s_mov_b32 s35, 0xa000
    v_fma_f32 v121, v121, v12, v30
    v_cvt_pk_bf16_f32 v48, v64, v65
    v_mfma_f32_16x16x32_bf16 v[164:167], a[180:183], v[60:63], v[164:167]
    v_exp_f32 v66, v66
    v_mfma_f32_16x16x32_bf16 v[168:171], a[184:187], v[60:63], v[168:171]
    buffer_load_dwordx4 v2, s[16:19], s35 offen offset:0 lds
    v_mfma_f32_16x16x32_bf16 v[168:171], a[152:155], v[56:59], v[168:171]
    v_exp_f32 v67, v67
    v_mfma_f32_16x16x32_bf16 v[172:175], a[156:159], v[56:59], v[172:175]
    v_fma_f32 v122, v122, v12, v30
    v_cvt_pk_bf16_f32 v49, v66, v67
    v_mfma_f32_16x16x32_bf16 v[172:175], a[188:191], v[60:63], v[172:175]
    v_exp_f32 v68, v68
    v_mfma_f32_16x16x32_bf16 v[72:75], a[240:243], a[48:51], -4.0
    buffer_load_dwordx4 v2, s[16:19], s35 offen offset:1024 lds
    v_mfma_f32_16x16x32_bf16 v[72:75], a[244:247], a[52:55], v[72:75]
    v_exp_f32 v69, v69
    v_mfma_f32_16x16x32_bf16 v[72:75], a[248:251], a[56:59], v[72:75]
    v_fma_f32 v123, v123, v12, v30
    v_cvt_pk_bf16_f32 v50, v68, v69
    v_mfma_f32_16x16x32_bf16 v[72:75], a[252:255], a[60:63], v[72:75]
    v_exp_f32 v70, v70
    v_mfma_f32_16x16x32_bf16 v[76:79], v[92:95], a[60:63], -4.0
    v_fma_f32 v124, v124, v12, v30
    v_fma_f32 v125, v125, v12, v30
    v_mfma_f32_16x16x32_bf16 v[76:79], v[88:91], a[56:59], v[76:79]
    v_exp_f32 v71, v71
    v_mfma_f32_16x16x32_bf16 v[76:79], v[84:87], a[52:55], v[76:79]
    v_fma_f32 v126, v126, v12, v30
    v_cvt_pk_bf16_f32 v51, v70, v71
    v_mfma_f32_16x16x32_bf16 v[76:79], v[80:83], a[48:51], v[76:79]
    v_exp_f32 v72, v72
    v_mfma_f32_16x16x32_bf16 v[176:179], a[192:195], v[60:63], v[176:179]
    v_cvt_pk_bf16_f32 v112, v112, v113
    v_fma_f32 v127, v127, v12, v30
    v_mfma_f32_16x16x32_bf16 v[176:179], a[160:163], v[56:59], v[176:179]
    v_exp_f32 v73, v73
    v_mfma_f32_16x16x32_bf16 v[180:183], a[164:167], v[56:59], v[180:183]
    v_cvt_pk_bf16_f32 v113, v114, v115
    v_cvt_pk_bf16_f32 v52, v72, v73
    v_mfma_f32_16x16x32_bf16 v[180:183], a[196:199], v[60:63], v[180:183]
    v_exp_f32 v74, v74
    v_mfma_f32_16x16x32_bf16 v[184:187], a[200:203], v[60:63], v[184:187]
    v_cvt_pk_bf16_f32 v114, v116, v117
    v_cvt_pk_bf16_f32 v115, v118, v119
    v_mfma_f32_16x16x32_bf16 v[184:187], a[168:171], v[56:59], v[184:187]
    v_exp_f32 v75, v75
    v_mfma_f32_16x16x32_bf16 v[188:191], a[172:175], v[56:59], v[188:191]
    v_cvt_pk_bf16_f32 v120, v120, v121
    v_cvt_pk_bf16_f32 v53, v74, v75
    v_mfma_f32_16x16x32_bf16 v[188:191], a[204:207], v[60:63], v[188:191]
    v_exp_f32 v76, v76
    v_mfma_f32_16x16x32_bf16 v[64:67], a[208:211], a[64:67], -4.0
    v_cvt_pk_bf16_f32 v121, v122, v123
    v_cndmask_b32_dpp v116, v120, v112, vcc row_ror:8 row_mask:0xf bank_mask:0xf
    v_mfma_f32_16x16x32_bf16 v[64:67], a[212:215], a[68:71], v[64:67]
    v_exp_f32 v77, v77
    v_mfma_f32_16x16x32_bf16 v[64:67], a[216:219], a[72:75], v[64:67]
    v_cvt_pk_bf16_f32 v122, v124, v125
    v_cvt_pk_bf16_f32 v54, v76, v77
    v_mfma_f32_16x16x32_bf16 v[64:67], a[220:223], a[76:79], v[64:67]
    v_exp_f32 v78, v78
    v_mfma_f32_16x16x32_bf16 v[68:71], a[236:239], a[76:79], -4.0
    v_cvt_pk_bf16_f32 v123, v126, v127
    v_cndmask_b32_dpp v117, v121, v113, vcc row_ror:8 row_mask:0xf bank_mask:0xf
    v_mfma_f32_16x16x32_bf16 v[68:71], a[232:235], a[72:75], v[68:71]
    v_exp_f32 v79, v79
    v_mfma_f32_16x16x32_bf16 v[68:71], a[228:231], a[68:71], v[68:71]
    v_cndmask_b32_dpp v118, v122, v114, vcc row_ror:8 row_mask:0xf bank_mask:0xf
    v_cvt_pk_bf16_f32 v55, v78, v79
    v_mfma_f32_16x16x32_bf16 v[68:71], a[224:227], a[64:67], v[68:71]
    v_exp_f32 v64, v64
    v_smfmac_f32_16x16x64_bf16 v[42:45], v[24:27], v[48:55], v9
    v_cndmask_b32_dpp v119, v123, v115, vcc row_ror:8 row_mask:0xf bank_mask:0xf
    v_mfma_f32_16x16x32_bf16 v[192:195], a[176:179], v[52:55], v[192:195]
    v_exp_f32 v65, v65
    v_mfma_f32_16x16x32_bf16 v[192:195], a[144:147], v[48:51], v[192:195]
    v_mov_b32_dpp v120, v112 row_ror:8 row_mask:0xf bank_mask:0x3
    v_cvt_pk_bf16_f32 v56, v64, v65
    v_mfma_f32_16x16x32_bf16 v[196:199], a[148:151], v[48:51], v[196:199]
    v_exp_f32 v66, v66
    v_mfma_f32_16x16x32_bf16 v[196:199], a[180:183], v[52:55], v[196:199]
    v_mov_b32_dpp v121, v113 row_ror:8 row_mask:0xf bank_mask:0x3
    v_mov_b32_dpp v122, v114 row_ror:8 row_mask:0xf bank_mask:0x3
    v_mfma_f32_16x16x32_bf16 v[200:203], a[184:187], v[52:55], v[200:203]
    v_exp_f32 v67, v67
    v_mfma_f32_16x16x32_bf16 v[200:203], a[152:155], v[48:51], v[200:203]
    v_mov_b32_dpp v123, v115 row_ror:8 row_mask:0xf bank_mask:0x3
    v_cvt_pk_bf16_f32 v57, v66, v67
    v_mfma_f32_16x16x32_bf16 v[204:207], a[156:159], v[48:51], v[204:207]
    v_exp_f32 v68, v68
    v_mfma_f32_16x16x32_bf16 v[204:207], a[188:191], v[52:55], v[204:207]
    buffer_store_dwordx4 v[100:103], v8, s[20:23], s34 offen offset:0 sc1
    v_mfma_f32_16x16x32_bf16 v[72:75], a[240:243], a[64:67], -4.0
    v_fma_f32 v128, v128, v13, v31
    v_fma_f32 v129, v129, v13, v31
    v_mfma_f32_16x16x32_bf16 v[72:75], a[244:247], a[68:71], v[72:75]
    s_cmp_lg_u64 s[4:5], 0
    v_exp_f32 v69, v69
    v_mfma_f32_16x16x32_bf16 v[72:75], a[248:251], a[72:75], v[72:75]
    s_addc_u32 s32, s32, s32
    v_fma_f32 v130, v130, v13, v31
    v_cvt_pk_bf16_f32 v58, v68, v69
    v_mfma_f32_16x16x32_bf16 v[72:75], a[252:255], a[76:79], v[72:75]
    v_exp_f32 v70, v70
    v_mfma_f32_16x16x32_bf16 v[76:79], v[92:95], a[76:79], -4.0
    v_fma_f32 v131, v131, v13, v31
    v_fma_f32 v132, v132, v13, v31
    v_mfma_f32_16x16x32_bf16 v[76:79], v[88:91], a[72:75], v[76:79]
    v_exp_f32 v71, v71
    v_mfma_f32_16x16x32_bf16 v[76:79], v[84:87], a[68:71], v[76:79]
    ds_read_b128 a[80:83], v3 offset:16384
    v_cvt_pk_bf16_f32 v59, v70, v71
    v_mfma_f32_16x16x32_bf16 v[76:79], v[80:83], a[64:67], v[76:79]
L_st4:
    s_cbranch_execz L_st5
    v_exp_f32 v72, v72
    v_mfma_f32_16x16x32_bf16 v[208:211], a[192:195], v[52:55], v[208:211]
    v_fma_f32 v133, v133, v13, v31
    v_fma_f32 v134, v134, v13, v31
    v_mfma_f32_16x16x32_bf16 v[208:211], a[160:163], v[48:51], v[208:211]
    v_exp_f32 v73, v73
    v_mfma_f32_16x16x32_bf16 v[212:215], a[164:167], v[48:51], v[212:215]
    ds_read_b128 a[84:87], v3 offset:17408
    v_cvt_pk_bf16_f32 v60, v72, v73
    v_mfma_f32_16x16x32_bf16 v[212:215], a[196:199], v[52:55], v[212:215]
    v_exp_f32 v74, v74
    v_mfma_f32_16x16x32_bf16 v[216:219], a[200:203], v[52:55], v[216:219]
    v_fma_f32 v135, v135, v13, v31
    v_max3_f32 v14, abs(v128), abs(v129), abs(v130)
    v_mfma_f32_16x16x32_bf16 v[216:219], a[168:171], v[48:51], v[216:219]
    v_exp_f32 v75, v75
    v_mfma_f32_16x16x32_bf16 v[220:223], a[172:175], v[48:51], v[220:223]
    ds_read_b128 a[88:91], v3 offset:18432
    v_cvt_pk_bf16_f32 v61, v74, v75
    v_mfma_f32_16x16x32_bf16 v[220:223], a[204:207], v[52:55], v[220:223]
    buffer_store_dwordx4 v[104:107], v8, s[20:23], s34 offen offset:2048 sc1
    v_mfma_f32_16x16x32_bf16 v[64:67], a[208:211], a[0:3], -4.0
    v_fma_f32 v136, v136, v13, v31
    v_fma_f32 v137, v137, v13, v31
    v_mfma_f32_16x16x32_bf16 v[64:67], a[212:215], a[4:7], v[64:67]
    v_exp_f32 v76, v76
    v_mfma_f32_16x16x32_bf16 v[64:67], a[216:219], a[8:11], v[64:67]
    ds_read_b128 a[92:95], v3 offset:19456
    v_fma_f32 v138, v138, v13, v31
    v_mfma_f32_16x16x32_bf16 v[64:67], a[220:223], a[12:15], v[64:67]
    v_exp_f32 v77, v77
    v_mfma_f32_16x16x32_bf16 v[68:71], a[236:239], a[12:15], -4.0
    v_exp_f32 v78, v78
    v_mfma_f32_16x16x32_bf16 v[68:71], a[232:235], a[8:11], v[68:71]
    v_exp_f32 v79, v79
    v_mfma_f32_16x16x32_bf16 v[68:71], a[228:231], a[4:7], v[68:71]
    v_cvt_pk_bf16_f32 v62, v76, v77
    v_cvt_pk_bf16_f32 v63, v78, v79
    v_mfma_f32_16x16x32_bf16 v[68:71], a[224:227], a[0:3], v[68:71]
    v_exp_f32 v64, v64
    v_smfmac_f32_16x16x64_bf16 v[44:47], v[24:27], v[56:63], v9
    ds_read_b128 a[108:111], v3 offset:23552
    v_fma_f32 v139, v139, v13, v31
    v_mfma_f32_16x16x32_bf16 v[224:227], a[176:179], v[60:63], v[224:227]
    v_exp_f32 v65, v65
    v_mfma_f32_16x16x32_bf16 v[224:227], a[144:147], v[56:59], v[224:227]
    ds_read_b128 a[104:107], v3 offset:22528
    v_cvt_pk_bf16_f32 v48, v64, v65
    v_mfma_f32_16x16x32_bf16 v[228:231], a[148:151], v[56:59], v[228:231]
    v_exp_f32 v66, v66
    v_mfma_f32_16x16x32_bf16 v[228:231], a[180:183], v[60:63], v[228:231]
    ds_read_b128 a[112:115], v3 offset:24576
    v_fma_f32 v140, v140, v13, v31
    v_mfma_f32_16x16x32_bf16 v[232:235], a[184:187], v[60:63], v[232:235]
    v_exp_f32 v67, v67
    v_mfma_f32_16x16x32_bf16 v[232:235], a[152:155], v[56:59], v[232:235]
    ds_read_b128 a[100:103], v3 offset:21504
    v_cvt_pk_bf16_f32 v49, v66, v67
    v_mfma_f32_16x16x32_bf16 v[236:239], a[156:159], v[56:59], v[236:239]
    v_exp_f32 v68, v68
    v_mfma_f32_16x16x32_bf16 v[236:239], a[188:191], v[60:63], v[236:239]
    ds_read_b128 a[116:119], v3 offset:25600
    v_fma_f32 v141, v141, v13, v31
    v_mfma_f32_16x16x32_bf16 v[72:75], a[240:243], a[0:3], -4.0
    buffer_store_dwordx4 v[116:119], v8, s[20:23], s34 offen offset:128 sc1
    v_mfma_f32_16x16x32_bf16 v[72:75], a[244:247], a[4:7], v[72:75]
    ds_read_b128 a[96:99], v3 offset:20480
    v_fma_f32 v142, v142, v13, v31
    v_mfma_f32_16x16x32_bf16 v[72:75], a[248:251], a[8:11], v[72:75]
    v_exp_f32 v69, v69
    v_mfma_f32_16x16x32_bf16 v[72:75], a[252:255], a[12:15], v[72:75]
    ds_read_b128 a[120:123], v3 offset:26624
    v_cvt_pk_bf16_f32 v50, v68, v69
    v_mfma_f32_16x16x32_bf16 v[76:79], v[92:95], a[12:15], -4.0
    v_exp_f32 v70, v70
    v_mfma_f32_16x16x32_bf16 v[76:79], v[88:91], a[8:11], v[76:79]
    ds_read_b128 a[124:127], v3 offset:27648
    v_fma_f32 v143, v143, v13, v31
    v_mfma_f32_16x16x32_bf16 v[76:79], v[84:87], a[4:7], v[76:79]
    v_exp_f32 v71, v71
    v_mfma_f32_16x16x32_bf16 v[76:79], v[80:83], a[0:3], v[76:79]
    ds_read_b128 a[140:143], v3 offset:31744
    v_cvt_pk_bf16_f32 v51, v70, v71
    v_mfma_f32_16x16x32_bf16 v[240:243], a[192:195], v[60:63], v[240:243]
    v_exp_f32 v72, v72
    v_mfma_f32_16x16x32_bf16 v[240:243], a[160:163], v[56:59], v[240:243]
    ds_read_b128 a[136:139], v3 offset:30720
    v_max3_f32 v14, v14, abs(v131), abs(v132)
    v_mfma_f32_16x16x32_bf16 v[244:247], a[164:167], v[56:59], v[244:247]
    v_exp_f32 v73, v73
    v_mfma_f32_16x16x32_bf16 v[244:247], a[196:199], v[60:63], v[244:247]
    v_cvt_pk_bf16_f32 v128, v128, v129
    v_cvt_pk_bf16_f32 v52, v72, v73
    v_mfma_f32_16x16x32_bf16 v[248:251], a[200:203], v[60:63], v[248:251]
    v_exp_f32 v74, v74
    v_mfma_f32_16x16x32_bf16 v[248:251], a[168:171], v[56:59], v[248:251]
    ds_read_b128 a[132:135], v3 offset:29696
    v_cvt_pk_bf16_f32 v129, v130, v131
    v_mfma_f32_16x16x32_bf16 v[252:255], a[172:175], v[56:59], v[252:255]
    v_exp_f32 v75, v75
    v_mfma_f32_16x16x32_bf16 v[252:255], a[204:207], v[60:63], v[252:255]
    s_waitcnt lgkmcnt(2)
    v_cvt_pk_bf16_f32 v130, v132, v133
    v_cvt_pk_bf16_f32 v53, v74, v75
    v_mfma_f32_16x16x32_bf16 v[64:67], a[80:83], a[32:35], -4.0
    buffer_store_dwordx4 v[120:123], v8, s[20:23], s34 offen offset:2176 sc1
    v_mfma_f32_16x16x32_bf16 v[64:67], a[84:87], a[36:39], v[64:67]
    s_add_u32 s34, s34, s38
    ds_read_b128 a[128:131], v3 offset:28672
    v_cvt_pk_bf16_f32 v131, v134, v135
    v_mfma_f32_16x16x32_bf16 v[64:67], a[88:91], a[40:43], v[64:67]
    v_exp_f32 v76, v76
    v_mfma_f32_16x16x32_bf16 v[64:67], a[92:95], a[44:47], v[64:67]
    v_exp_f32 v77, v77
    v_mfma_f32_16x16x32_bf16 v[68:71], a[108:111], a[44:47], -4.0
    v_exp_f32 v78, v78
    v_mfma_f32_16x16x32_bf16 v[68:71], a[104:107], a[40:43], v[68:71]
    v_exp_f32 v79, v79
    v_mfma_f32_16x16x32_bf16 v[68:71], a[100:103], a[36:39], v[68:71]
    v_cvt_pk_bf16_f32 v54, v76, v77
    v_cvt_pk_bf16_f32 v55, v78, v79
    v_mfma_f32_16x16x32_bf16 v[68:71], a[96:99], a[32:35], v[68:71]
    s_waitcnt vmcnt(12)
    v_exp_f32 v64, v64
    v_smfmac_f32_16x16x64_bf16 v[36:39], v[24:27], v[48:55], v9
    s_barrier
    v_mfma_f32_16x16x32_bf16 v[96:99], a[176:179], v[52:55], v[32:35]
    v_exp_f32 v65, v65
    v_mfma_f32_16x16x32_bf16 v[96:99], a[144:147], v[48:51], v[96:99]
    ds_read_b64_tr_b16 a[176:177], v5 offset:24576
    v_cvt_pk_bf16_f32 v56, v64, v65
    v_mfma_f32_16x16x32_bf16 v[100:103], a[148:151], v[48:51], v[32:35]
    v_exp_f32 v66, v66
    v_mfma_f32_16x16x32_bf16 v[100:103], a[180:183], v[52:55], v[100:103]
    ds_read_b64_tr_b16 a[178:179], v5 offset:28672
    v_cvt_pk_bf16_f32 v136, v136, v137
    v_mfma_f32_16x16x32_bf16 v[104:107], a[184:187], v[52:55], v[32:35]
    v_exp_f32 v67, v67
    v_mfma_f32_16x16x32_bf16 v[104:107], a[152:155], v[48:51], v[104:107]
    ds_read_b64_tr_b16 a[144:145], v5 offset:16384
    v_cvt_pk_bf16_f32 v57, v66, v67
    v_mfma_f32_16x16x32_bf16 v[108:111], a[156:159], v[48:51], v[32:35]
    v_exp_f32 v68, v68
    v_mfma_f32_16x16x32_bf16 v[108:111], a[188:191], v[52:55], v[108:111]
    ds_read_b64_tr_b16 a[146:147], v5 offset:20480
    v_cvt_pk_bf16_f32 v137, v138, v139
    v_mfma_f32_16x16x32_bf16 v[72:75], a[112:115], a[32:35], -4.0
    v_exp_f32 v69, v69
    v_mfma_f32_16x16x32_bf16 v[72:75], a[116:119], a[36:39], v[72:75]
    ds_read_b64_tr_b16 a[148:149], v5 offset:16392
    v_cvt_pk_bf16_f32 v58, v68, v69
    v_mfma_f32_16x16x32_bf16 v[72:75], a[120:123], a[40:43], v[72:75]
    v_exp_f32 v70, v70
    v_mfma_f32_16x16x32_bf16 v[72:75], a[124:127], a[44:47], v[72:75]
    ds_read_b64_tr_b16 a[150:151], v5 offset:20488
    v_cvt_pk_bf16_f32 v138, v140, v141
    v_mfma_f32_16x16x32_bf16 v[76:79], a[140:143], a[44:47], -4.0
    s_waitcnt lgkmcnt(4)
    v_exp_f32 v71, v71
    v_mfma_f32_16x16x32_bf16 v[76:79], a[136:139], a[40:43], v[76:79]
    ds_read_b64_tr_b16 a[180:181], v5 offset:24584
    v_cvt_pk_bf16_f32 v59, v70, v71
    v_mfma_f32_16x16x32_bf16 v[76:79], a[132:135], a[36:39], v[76:79]
    v_exp_f32 v72, v72
    v_mfma_f32_16x16x32_bf16 v[76:79], a[128:131], a[32:35], v[76:79]
    ds_read_b64_tr_b16 a[182:183], v5 offset:28680
    ds_read_b64_tr_b16 a[184:185], v5 offset:24832
    v_mfma_f32_16x16x32_bf16 v[112:115], a[192:195], v[52:55], v[32:35]
    v_exp_f32 v73, v73
    v_mfma_f32_16x16x32_bf16 v[112:115], a[160:163], v[48:51], v[112:115]
    ds_read_b64_tr_b16 a[186:187], v5 offset:28928
    v_cvt_pk_bf16_f32 v60, v72, v73
    v_mfma_f32_16x16x32_bf16 v[116:119], a[164:167], v[48:51], v[32:35]
    v_exp_f32 v74, v74
    v_mfma_f32_16x16x32_bf16 v[116:119], a[196:199], v[52:55], v[116:119]
    ds_read_b64_tr_b16 a[152:153], v5 offset:16640
    ds_read_b64_tr_b16 a[154:155], v5 offset:20736
    v_mfma_f32_16x16x32_bf16 v[120:123], a[200:203], v[52:55], v[32:35]
    v_exp_f32 v75, v75
    v_mfma_f32_16x16x32_bf16 v[120:123], a[168:171], v[48:51], v[120:123]
    ds_read_b64_tr_b16 a[156:157], v5 offset:16648
    v_cvt_pk_bf16_f32 v61, v74, v75
    v_mfma_f32_16x16x32_bf16 v[124:127], a[172:175], v[48:51], v[32:35]
    v_exp_f32 v76, v76
    v_mfma_f32_16x16x32_bf16 v[124:127], a[204:207], v[52:55], v[124:127]
    ds_read_b64_tr_b16 a[158:159], v5 offset:20744
    ds_read_b64_tr_b16 a[188:189], v5 offset:24840
    v_mfma_f32_16x16x32_bf16 v[64:67], a[80:83], a[48:51], -4.0
    v_exp_f32 v77, v77
    v_mfma_f32_16x16x32_bf16 v[64:67], a[84:87], a[52:55], v[64:67]
    ds_read_b64_tr_b16 a[190:191], v5 offset:28936
    v_cvt_pk_bf16_f32 v62, v76, v77
    v_mfma_f32_16x16x32_bf16 v[64:67], a[88:91], a[56:59], v[64:67]
    v_exp_f32 v78, v78
    v_mfma_f32_16x16x32_bf16 v[64:67], a[92:95], a[60:63], v[64:67]
    ds_read_b64_tr_b16 a[192:193], v5 offset:25088
    ds_read_b64_tr_b16 a[194:195], v5 offset:29184
    v_mfma_f32_16x16x32_bf16 v[68:71], a[108:111], a[60:63], -4.0
    v_exp_f32 v79, v79
    v_mfma_f32_16x16x32_bf16 v[68:71], a[104:107], a[56:59], v[68:71]
    ds_read_b64_tr_b16 a[160:161], v5 offset:16896
    v_cvt_pk_bf16_f32 v63, v78, v79
    v_mfma_f32_16x16x32_bf16 v[68:71], a[100:103], a[52:55], v[68:71]
    v_exp_f32 v64, v64
    v_mfma_f32_16x16x32_bf16 v[68:71], a[96:99], a[48:51], v[68:71]
    ds_read_b64_tr_b16 a[162:163], v5 offset:20992
    ds_read_b64_tr_b16 a[164:165], v5 offset:16904
    v_smfmac_f32_16x16x64_bf16 v[40:43], v[24:27], v[56:63], v9
    ds_read_b64_tr_b16 a[166:167], v5 offset:21000
    ds_read_b64_tr_b16 a[196:197], v5 offset:25096
    v_mfma_f32_16x16x32_bf16 v[160:163], a[176:179], v[60:63], v[160:163]
    s_waitcnt lgkmcnt(7)
    v_exp_f32 v65, v65
    v_mfma_f32_16x16x32_bf16 v[160:163], a[144:147], v[56:59], v[160:163]
    ds_read_b64_tr_b16 a[198:199], v5 offset:29192
    ds_read_b64_tr_b16 a[200:201], v5 offset:25344
    v_mfma_f32_16x16x32_bf16 v[164:167], a[148:151], v[56:59], v[164:167]
    v_exp_f32 v66, v66
    v_mfma_f32_16x16x32_bf16 v[164:167], a[180:183], v[60:63], v[164:167]
    ds_read_b64_tr_b16 a[202:203], v5 offset:29440
    ds_read_b64_tr_b16 a[168:169], v5 offset:17152
    v_mfma_f32_16x16x32_bf16 v[168:171], a[184:187], v[60:63], v[168:171]
    v_exp_f32 v67, v67
    v_mfma_f32_16x16x32_bf16 v[168:171], a[152:155], v[56:59], v[168:171]
    ds_read_b64_tr_b16 a[170:171], v5 offset:21248
    ds_read_b64_tr_b16 a[172:173], v5 offset:17160
    v_mfma_f32_16x16x32_bf16 v[172:175], a[156:159], v[56:59], v[172:175]
    v_exp_f32 v68, v68
    v_mfma_f32_16x16x32_bf16 v[172:175], a[188:191], v[60:63], v[172:175]
    ds_read_b64_tr_b16 a[174:175], v5 offset:21256
    ds_read_b64_tr_b16 a[204:205], v5 offset:25352
    v_mfma_f32_16x16x32_bf16 v[72:75], a[112:115], a[48:51], -4.0
    v_exp_f32 v69, v69
    v_mfma_f32_16x16x32_bf16 v[72:75], a[116:119], a[52:55], v[72:75]
    ds_read_b64_tr_b16 a[206:207], v5 offset:29448
    v_cvt_pk_bf16_f32 v48, v64, v65
    v_mfma_f32_16x16x32_bf16 v[72:75], a[120:123], a[56:59], v[72:75]
    v_exp_f32 v70, v70
    v_mfma_f32_16x16x32_bf16 v[72:75], a[124:127], a[60:63], v[72:75]
    v_cvt_pk_bf16_f32 v49, v66, v67
    v_cvt_pk_bf16_f32 v50, v68, v69
    v_mfma_f32_16x16x32_bf16 v[76:79], a[140:143], a[60:63], -4.0
    v_exp_f32 v71, v71
    v_mfma_f32_16x16x32_bf16 v[76:79], a[136:139], a[56:59], v[76:79]
    v_cvt_pk_bf16_f32 v139, v142, v143
    v_cvt_pk_bf16_f32 v51, v70, v71
    v_mfma_f32_16x16x32_bf16 v[76:79], a[132:135], a[52:55], v[76:79]
    v_exp_f32 v72, v72
    v_mfma_f32_16x16x32_bf16 v[76:79], a[128:131], a[48:51], v[76:79]
    s_waitcnt lgkmcnt(1)
    v_cndmask_b32_dpp v132, v136, v128, vcc row_ror:8 row_mask:0xf bank_mask:0xf
    v_cndmask_b32_dpp v133, v137, v129, vcc row_ror:8 row_mask:0xf bank_mask:0xf
    v_mfma_f32_16x16x32_bf16 v[176:179], a[192:195], v[60:63], v[176:179]
    v_exp_f32 v73, v73
    v_mfma_f32_16x16x32_bf16 v[176:179], a[160:163], v[56:59], v[176:179]
    v_cndmask_b32_dpp v134, v138, v130, vcc row_ror:8 row_mask:0xf bank_mask:0xf
    v_cvt_pk_bf16_f32 v52, v72, v73
    v_mfma_f32_16x16x32_bf16 v[180:183], a[164:167], v[56:59], v[180:183]
    v_exp_f32 v74, v74
    v_mfma_f32_16x16x32_bf16 v[180:183], a[196:199], v[60:63], v[180:183]
    v_subrev_u32 v29, s30, v29
    v_cndmask_b32_dpp v135, v139, v131, vcc row_ror:8 row_mask:0xf bank_mask:0xf
    v_mfma_f32_16x16x32_bf16 v[184:187], a[200:203], v[60:63], v[184:187]
    v_exp_f32 v75, v75
    v_mfma_f32_16x16x32_bf16 v[184:187], a[168:171], v[56:59], v[184:187]
    v_fma_f32 v14, v14, s42, v31
    v_cvt_pk_bf16_f32 v53, v74, v75
    v_mfma_f32_16x16x32_bf16 v[188:191], a[172:175], v[56:59], v[188:191]
    s_waitcnt lgkmcnt(0)
    v_exp_f32 v76, v76
    v_mfma_f32_16x16x32_bf16 v[188:191], a[204:207], v[60:63], v[188:191]
    s_barrier
    v_mfma_f32_16x16x32_bf16 v[64:67], a[80:83], a[64:67], -4.0
    s_mov_b32 s35, 0xc000
    v_exp_f32 v77, v77
    v_mfma_f32_16x16x32_bf16 v[64:67], a[84:87], a[68:71], v[64:67]
    s_waitcnt vmcnt(8)
    ds_read_b128 a[16:19], v15 offset:0
    v_cvt_pk_bf16_f32 v54, v76, v77
    v_mfma_f32_16x16x32_bf16 v[64:67], a[88:91], a[72:75], v[64:67]
    s_mov_b32 m0, s50
    v_exp_f32 v78, v78
    v_mfma_f32_16x16x32_bf16 v[64:67], a[92:95], a[76:79], v[64:67]
    ds_read_b128 a[20:23], v15 offset:256
    v_and_or_b32 v14, v14, s43, v29
    v_mfma_f32_16x16x32_bf16 v[68:71], a[108:111], a[76:79], -4.0
    v_exp_f32 v79, v79
    v_mfma_f32_16x16x32_bf16 v[68:71], a[104:107], a[72:75], v[68:71]
    buffer_load_dwordx4 v2, s[16:19], s35 offen offset:0 lds
    v_mfma_f32_16x16x32_bf16 v[68:71], a[100:103], a[68:71], v[68:71]
    ds_read_b128 a[24:27], v15 offset:512
    v_cvt_pk_bf16_f32 v55, v78, v79
    v_mfma_f32_16x16x32_bf16 v[68:71], a[96:99], a[64:67], v[68:71]
    v_exp_f32 v64, v64
    v_smfmac_f32_16x16x64_bf16 v[42:45], v[24:27], v[48:55], v9
    v_cmp_lt_u32_e64 s[4:5], s31, v14
    v_mfma_f32_16x16x32_bf16 v[192:195], a[176:179], v[52:55], v[192:195]
    buffer_load_dwordx4 v2, s[16:19], s35 offen offset:1024 lds
    v_mfma_f32_16x16x32_bf16 v[192:195], a[144:147], v[48:51], v[192:195]
    s_mov_b32 m0, s51
    v_exp_f32 v65, v65
    v_mfma_f32_16x16x32_bf16 v[196:199], a[148:151], v[48:51], v[196:199]
    s_mov_b32 s35, 0xe000
    ds_read_b128 a[28:31], v15 offset:768
    v_cvt_pk_bf16_f32 v56, v64, v65
    v_mfma_f32_16x16x32_bf16 v[196:199], a[180:183], v[52:55], v[196:199]
    v_exp_f32 v66, v66
    v_mfma_f32_16x16x32_bf16 v[200:203], a[184:187], v[52:55], v[200:203]
    buffer_load_dwordx4 v2, s[16:19], s35 offen offset:0 lds
    v_mfma_f32_16x16x32_bf16 v[200:203], a[152:155], v[48:51], v[200:203]
    v_exp_f32 v67, v67
    v_mfma_f32_16x16x32_bf16 v[204:207], a[156:159], v[48:51], v[204:207]
    v_mov_b32_dpp v136, v128 row_ror:8 row_mask:0xf bank_mask:0x3
    v_cvt_pk_bf16_f32 v57, v66, v67
    v_mfma_f32_16x16x32_bf16 v[204:207], a[188:191], v[52:55], v[204:207]
    v_exp_f32 v68, v68
    v_mfma_f32_16x16x32_bf16 v[72:75], a[112:115], a[64:67], -4.0
    buffer_load_dwordx4 v2, s[16:19], s35 offen offset:1024 lds
    v_mfma_f32_16x16x32_bf16 v[72:75], a[116:119], a[68:71], v[72:75]
    v_exp_f32 v69, v69
    v_mfma_f32_16x16x32_bf16 v[72:75], a[120:123], a[72:75], v[72:75]
    v_mov_b32_dpp v137, v129 row_ror:8 row_mask:0xf bank_mask:0x3
    v_cvt_pk_bf16_f32 v58, v68, v69
    v_mfma_f32_16x16x32_bf16 v[72:75], a[124:127], a[76:79], v[72:75]
    s_mov_b32 m0, s26
    v_exp_f32 v70, v70
    v_mfma_f32_16x16x32_bf16 v[76:79], a[140:143], a[76:79], -4.0
    v_mov_b32_dpp v138, v130 row_ror:8 row_mask:0xf bank_mask:0x3
    v_mov_b32_dpp v139, v131 row_ror:8 row_mask:0xf bank_mask:0x3
    v_mfma_f32_16x16x32_bf16 v[76:79], a[136:139], a[72:75], v[76:79]
    v_exp_f32 v71, v71
    v_mfma_f32_16x16x32_bf16 v[76:79], a[132:135], a[68:71], v[76:79]
    s_waitcnt lgkmcnt(0)
    buffer_load_dwordx4 v2, s[8:11], s33 offen offset:0 nt lds
    v_mfma_f32_16x16x32_bf16 v[76:79], a[128:131], a[64:67], v[76:79]
    v_exp_f32 v72, v72
    v_mfma_f32_16x16x32_bf16 v[208:211], a[192:195], v[52:55], v[208:211]
    v_fma_f32 v144, v144, v13, v31
    v_cvt_pk_bf16_f32 v59, v70, v71
    v_mfma_f32_16x16x32_bf16 v[208:211], a[160:163], v[48:51], v[208:211]
    v_exp_f32 v73, v73
    v_mfma_f32_16x16x32_bf16 v[212:215], a[164:167], v[48:51], v[212:215]
    buffer_load_dwordx4 v2, s[8:11], s33 offen offset:1024 nt lds
    v_mfma_f32_16x16x32_bf16 v[212:215], a[196:199], v[52:55], v[212:215]
    v_exp_f32 v74, v74
    v_mfma_f32_16x16x32_bf16 v[216:219], a[200:203], v[52:55], v[216:219]
    v_fma_f32 v145, v145, v13, v31
    v_cvt_pk_bf16_f32 v60, v72, v73
    v_mfma_f32_16x16x32_bf16 v[216:219], a[168:171], v[48:51], v[216:219]
    v_exp_f32 v75, v75
    v_mfma_f32_16x16x32_bf16 v[220:223], a[172:175], v[48:51], v[220:223]
    buffer_load_dwordx4 v2, s[8:11], s33 offen offset:2048 nt lds
    v_mfma_f32_16x16x32_bf16 v[220:223], a[204:207], v[52:55], v[220:223]
    v_exp_f32 v76, v76
    v_mfma_f32_16x16x32_bf16 v[64:67], a[80:83], a[0:3], -4.0
    v_fma_f32 v146, v146, v13, v31
    v_cvt_pk_bf16_f32 v61, v74, v75
    v_mfma_f32_16x16x32_bf16 v[64:67], a[84:87], a[4:7], v[64:67]
    v_exp_f32 v77, v77
    v_mfma_f32_16x16x32_bf16 v[64:67], a[88:91], a[8:11], v[64:67]
    buffer_load_dwordx4 v2, s[8:11], s33 offen offset:3072 nt lds
    v_mfma_f32_16x16x32_bf16 v[64:67], a[92:95], a[12:15], v[64:67]
    s_add_u32 s33, s33, s38
    v_exp_f32 v78, v78
    v_mfma_f32_16x16x32_bf16 v[68:71], a[108:111], a[12:15], -4.0
    v_fma_f32 v147, v147, v13, v31
    v_cvt_pk_bf16_f32 v62, v76, v77
    v_mfma_f32_16x16x32_bf16 v[68:71], a[104:107], a[8:11], v[68:71]
    v_exp_f32 v79, v79
    v_mfma_f32_16x16x32_bf16 v[68:71], a[100:103], a[4:7], v[68:71]
    v_fma_f32 v148, v148, v13, v31
    v_cvt_pk_bf16_f32 v63, v78, v79
    v_mfma_f32_16x16x32_bf16 v[68:71], a[96:99], a[0:3], v[68:71]
    v_exp_f32 v64, v64
    v_smfmac_f32_16x16x64_bf16 v[44:47], v[24:27], v[56:63], v9
    v_fma_f32 v149, v149, v13, v31
    v_mfma_f32_16x16x32_bf16 v[224:227], a[176:179], v[60:63], v[224:227]
    v_exp_f32 v65, v65
    v_mfma_f32_16x16x32_bf16 v[224:227], a[144:147], v[56:59], v[224:227]
    v_fma_f32 v150, v150, v13, v31
    v_cvt_pk_bf16_f32 v48, v64, v65
    v_mfma_f32_16x16x32_bf16 v[228:231], a[148:151], v[56:59], v[228:231]
    v_exp_f32 v66, v66
    v_mfma_f32_16x16x32_bf16 v[228:231], a[180:183], v[60:63], v[228:231]
    v_fma_f32 v151, v151, v13, v31
    v_fma_f32 v152, v152, v13, v31
    v_mfma_f32_16x16x32_bf16 v[232:235], a[184:187], v[60:63], v[232:235]
    v_exp_f32 v67, v67
    v_mfma_f32_16x16x32_bf16 v[232:235], a[152:155], v[56:59], v[232:235]
    v_fma_f32 v153, v153, v13, v31
    v_cvt_pk_bf16_f32 v49, v66, v67
    v_mfma_f32_16x16x32_bf16 v[236:239], a[156:159], v[56:59], v[236:239]
    v_exp_f32 v68, v68
    v_mfma_f32_16x16x32_bf16 v[236:239], a[188:191], v[60:63], v[236:239]
    v_fma_f32 v154, v154, v13, v31
    v_fma_f32 v155, v155, v13, v31
    v_mfma_f32_16x16x32_bf16 v[72:75], a[112:115], a[0:3], -4.0
    v_exp_f32 v69, v69
    v_mfma_f32_16x16x32_bf16 v[72:75], a[116:119], a[4:7], v[72:75]
    v_fma_f32 v156, v156, v13, v31
    v_cvt_pk_bf16_f32 v50, v68, v69
    v_mfma_f32_16x16x32_bf16 v[72:75], a[120:123], a[8:11], v[72:75]
    v_exp_f32 v70, v70
    v_mfma_f32_16x16x32_bf16 v[72:75], a[124:127], a[12:15], v[72:75]
    v_fma_f32 v157, v157, v13, v31
    v_fma_f32 v158, v158, v13, v31
    v_mfma_f32_16x16x32_bf16 v[76:79], a[140:143], a[12:15], -4.0
    v_exp_f32 v71, v71
    v_mfma_f32_16x16x32_bf16 v[76:79], a[136:139], a[8:11], v[76:79]
    v_fma_f32 v159, v159, v13, v31
    v_cvt_pk_bf16_f32 v51, v70, v71
    v_mfma_f32_16x16x32_bf16 v[76:79], a[132:135], a[4:7], v[76:79]
    v_exp_f32 v72, v72
    v_mfma_f32_16x16x32_bf16 v[76:79], a[128:131], a[0:3], v[76:79]
    buffer_store_dwordx4 v[132:135], v8, s[20:23], s34 offen offset:0 sc1
    v_mfma_f32_16x16x32_bf16 v[240:243], a[192:195], v[60:63], v[240:243]
    v_cvt_pk_bf16_f32 v144, v144, v145
    v_cvt_pk_bf16_f32 v152, v152, v153
    v_mfma_f32_16x16x32_bf16 v[240:243], a[160:163], v[56:59], v[240:243]
    s_cmp_lg_u64 s[4:5], 0
    v_exp_f32 v73, v73
    v_mfma_f32_16x16x32_bf16 v[244:247], a[164:167], v[56:59], v[244:247]
    s_addc_u32 s32, s32, s32
    v_cvt_pk_bf16_f32 v145, v146, v147
    v_cvt_pk_bf16_f32 v52, v72, v73
    v_mfma_f32_16x16x32_bf16 v[244:247], a[196:199], v[60:63], v[244:247]
    v_exp_f32 v74, v74
    v_mfma_f32_16x16x32_bf16 v[248:251], a[200:203], v[60:63], v[248:251]
    v_cvt_pk_bf16_f32 v146, v148, v149
    v_cvt_pk_bf16_f32 v147, v150, v151
    v_mfma_f32_16x16x32_bf16 v[248:251], a[168:171], v[56:59], v[248:251]
    v_exp_f32 v75, v75
    v_mfma_f32_16x16x32_bf16 v[252:255], a[172:175], v[56:59], v[252:255]
    v_cvt_pk_bf16_f32 v153, v154, v155
    v_cvt_pk_bf16_f32 v53, v74, v75
    v_mfma_f32_16x16x32_bf16 v[252:255], a[204:207], v[60:63], v[252:255]
    v_exp_f32 v76, v76
    v_mfma_f32_16x16x32_bf16 v[64:67], a[80:83], a[16:19], -4.0
    v_cvt_pk_bf16_f32 v154, v156, v157
    v_cvt_pk_bf16_f32 v155, v158, v159
    v_mfma_f32_16x16x32_bf16 v[64:67], a[84:87], a[20:23], v[64:67]
    v_exp_f32 v77, v77
    v_mfma_f32_16x16x32_bf16 v[64:67], a[88:91], a[24:27], v[64:67]
    v_cndmask_b32_dpp v148, v152, v144, vcc row_ror:8 row_mask:0xf bank_mask:0xf
    v_cvt_pk_bf16_f32 v54, v76, v77
    v_mfma_f32_16x16x32_bf16 v[64:67], a[92:95], a[28:31], v[64:67]
    v_exp_f32 v78, v78
    v_mfma_f32_16x16x32_bf16 v[68:71], a[108:111], a[28:31], -4.0
    v_exp_f32 v79, v79
    v_mfma_f32_16x16x32_bf16 v[68:71], a[104:107], a[24:27], v[68:71]
    buffer_store_dwordx4 v[136:139], v8, s[20:23], s34 offen offset:2048 sc1
    v_mfma_f32_16x16x32_bf16 v[68:71], a[100:103], a[20:23], v[68:71]
    v_cndmask_b32_dpp v149, v153, v145, vcc row_ror:8 row_mask:0xf bank_mask:0xf
    v_cvt_pk_bf16_f32 v55, v78, v79
    v_mfma_f32_16x16x32_bf16 v[68:71], a[96:99], a[16:19], v[68:71]
    v_exp_f32 v64, v64
    v_smfmac_f32_16x16x64_bf16 v[36:39], v[24:27], v[48:55], v9
    ds_read_b128 a[80:83], v3 offset:32768
    v_cndmask_b32_dpp v150, v154, v146, vcc row_ror:8 row_mask:0xf bank_mask:0xf
    v_mfma_f32_16x16x32_bf16 v[96:99], a[176:179], v[52:55], v[96:99]
    v_exp_f32 v65, v65
    v_mfma_f32_16x16x32_bf16 v[96:99], a[144:147], v[48:51], v[96:99]
    ds_read_b128 a[84:87], v3 offset:33792
    v_cndmask_b32_dpp v151, v155, v147, vcc row_ror:8 row_mask:0xf bank_mask:0xf
    v_mfma_f32_16x16x32_bf16 v[100:103], a[148:151], v[48:51], v[100:103]
    v_exp_f32 v66, v66
    v_mfma_f32_16x16x32_bf16 v[100:103], a[180:183], v[52:55], v[100:103]
    ds_read_b128 a[88:91], v3 offset:34816
    ds_read_b128 a[92:95], v3 offset:35840
    v_mfma_f32_16x16x32_bf16 v[104:107], a[184:187], v[52:55], v[104:107]
    v_exp_f32 v67, v67
    v_mfma_f32_16x16x32_bf16 v[104:107], a[152:155], v[48:51], v[104:107]
    ds_read_b128 a[108:111], v3 offset:39936
    ds_read_b128 a[104:107], v3 offset:38912
    v_mfma_f32_16x16x32_bf16 v[108:111], a[156:159], v[48:51], v[108:111]
    v_exp_f32 v68, v68
    v_mfma_f32_16x16x32_bf16 v[108:111], a[188:191], v[52:55], v[108:111]
    v_cvt_pk_bf16_f32 v56, v64, v65
    v_cvt_pk_bf16_f32 v57, v66, v67
    v_mfma_f32_16x16x32_bf16 v[72:75], a[112:115], a[16:19], -4.0
    v_exp_f32 v69, v69
    v_mfma_f32_16x16x32_bf16 v[72:75], a[116:119], a[20:23], v[72:75]
    ds_read_b128 a[100:103], v3 offset:37888
    v_cvt_pk_bf16_f32 v58, v68, v69
    v_mfma_f32_16x16x32_bf16 v[72:75], a[120:123], a[24:27], v[72:75]
    v_exp_f32 v70, v70
    v_mfma_f32_16x16x32_bf16 v[72:75], a[124:127], a[28:31], v[72:75]
    ds_read_b128 a[96:99], v3 offset:36864
    v_mov_b32_dpp v152, v144 row_ror:8 row_mask:0xf bank_mask:0x3
    v_mfma_f32_16x16x32_bf16 v[76:79], a[140:143], a[28:31], -4.0
    buffer_store_dwordx4 v[148:151], v8, s[20:23], s34 offen offset:128 sc1
    v_mfma_f32_16x16x32_bf16 v[76:79], a[136:139], a[24:27], v[76:79]
    v_mov_b32_dpp v153, v145 row_ror:8 row_mask:0xf bank_mask:0x3
    v_mov_b32_dpp v154, v146 row_ror:8 row_mask:0xf bank_mask:0x3
    v_mfma_f32_16x16x32_bf16 v[76:79], a[132:135], a[20:23], v[76:79]
    v_exp_f32 v71, v71
    v_mfma_f32_16x16x32_bf16 v[76:79], a[128:131], a[16:19], v[76:79]
    v_mov_b32_dpp v155, v147 row_ror:8 row_mask:0xf bank_mask:0x3
    v_cvt_pk_bf16_f32 v59, v70, v71
    v_mfma_f32_16x16x32_bf16 v[112:115], a[192:195], v[52:55], v[112:115]
    v_exp_f32 v72, v72
    v_mfma_f32_16x16x32_bf16 v[112:115], a[160:163], v[48:51], v[112:115]
    v_exp_f32 v73, v73
    v_mfma_f32_16x16x32_bf16 v[116:119], a[164:167], v[48:51], v[116:119]
    ds_read_b128 a[112:115], v3 offset:40960
    v_cvt_pk_bf16_f32 v60, v72, v73
    v_mfma_f32_16x16x32_bf16 v[116:119], a[196:199], v[52:55], v[116:119]
    v_exp_f32 v74, v74
    v_mfma_f32_16x16x32_bf16 v[120:123], a[200:203], v[52:55], v[120:123]
    ds_read_b128 a[116:119], v3 offset:41984
    ds_read_b128 a[120:123], v3 offset:43008
    v_mfma_f32_16x16x32_bf16 v[120:123], a[168:171], v[48:51], v[120:123]
    v_exp_f32 v75, v75
    v_mfma_f32_16x16x32_bf16 v[124:127], a[172:175], v[48:51], v[124:127]
    ds_read_b128 a[124:127], v3 offset:44032
    v_cvt_pk_bf16_f32 v61, v74, v75
    v_mfma_f32_16x16x32_bf16 v[124:127], a[204:207], v[52:55], v[124:127]
    s_waitcnt lgkmcnt(4)
    v_exp_f32 v76, v76
    v_mfma_f32_16x16x32_bf16 v[64:67], a[80:83], a[32:35], -4.0
    ds_read_b128 a[140:143], v3 offset:48128
    ds_read_b128 a[136:139], v3 offset:47104
    v_mfma_f32_16x16x32_bf16 v[64:67], a[84:87], a[36:39], v[64:67]
    v_exp_f32 v77, v77
    v_mfma_f32_16x16x32_bf16 v[64:67], a[88:91], a[40:43], v[64:67]
    buffer_store_dwordx4 v[152:155], v8, s[20:23], s34 offen offset:2176 sc1
    v_mfma_f32_16x16x32_bf16 v[64:67], a[92:95], a[44:47], v[64:67]
    s_add_u32 s34, s34, s38
    ds_read_b128 a[132:135], v3 offset:46080
    v_cvt_pk_bf16_f32 v62, v76, v77
    v_mfma_f32_16x16x32_bf16 v[68:71], a[108:111], a[44:47], -4.0
    v_exp_f32 v78, v78
    v_mfma_f32_16x16x32_bf16 v[68:71], a[104:107], a[40:43], v[68:71]
    v_exp_f32 v79, v79
    v_mfma_f32_16x16x32_bf16 v[68:71], a[100:103], a[36:39], v[68:71]
    ds_read_b128 a[128:131], v3 offset:45056
    v_cvt_pk_bf16_f32 v63, v78, v79
    v_mfma_f32_16x16x32_bf16 v[68:71], a[96:99], a[32:35], v[68:71]
    s_waitcnt vmcnt(16)
    v_exp_f32 v64, v64
    v_smfmac_f32_16x16x64_bf16 v[38:41], v[24:27], v[56:63], v9
    s_barrier
    v_mfma_f32_16x16x32_bf16 v[128:131], a[176:179], v[60:63], v[32:35]
    v_exp_f32 v65, v65
    v_mfma_f32_16x16x32_bf16 v[128:131], a[144:147], v[56:59], v[128:131]
    ds_read_b64_tr_b16 a[176:177], v5 offset:8192
    v_cvt_pk_bf16_f32 v48, v64, v65
    v_mfma_f32_16x16x32_bf16 v[132:135], a[148:151], v[56:59], v[32:35]
    v_exp_f32 v66, v66
    v_mfma_f32_16x16x32_bf16 v[132:135], a[180:183], v[60:63], v[132:135]
    v_exp_f32 v67, v67
    v_mfma_f32_16x16x32_bf16 v[136:139], a[184:187], v[60:63], v[32:35]
    ds_read_b64_tr_b16 a[178:179], v5 offset:12288
    v_cvt_pk_bf16_f32 v49, v66, v67
    v_mfma_f32_16x16x32_bf16 v[136:139], a[152:155], v[56:59], v[136:139]
    v_exp_f32 v68, v68
    v_mfma_f32_16x16x32_bf16 v[140:143], a[156:159], v[56:59], v[32:35]
    v_exp_f32 v69, v69
    v_mfma_f32_16x16x32_bf16 v[140:143], a[188:191], v[60:63], v[140:143]
    s_waitcnt lgkmcnt(2)
    ds_read_b64_tr_b16 a[144:145], v5 offset:0
    v_cvt_pk_bf16_f32 v50, v68, v69
    v_mfma_f32_16x16x32_bf16 v[72:75], a[112:115], a[32:35], -4.0
    v_exp_f32 v70, v70
    v_mfma_f32_16x16x32_bf16 v[72:75], a[116:119], a[36:39], v[72:75]
    v_exp_f32 v71, v71
    v_mfma_f32_16x16x32_bf16 v[72:75], a[120:123], a[40:43], v[72:75]
    ds_read_b64_tr_b16 a[146:147], v5 offset:4096
    v_cvt_pk_bf16_f32 v51, v70, v71
    v_mfma_f32_16x16x32_bf16 v[72:75], a[124:127], a[44:47], v[72:75]
    ds_read_b64_tr_b16 a[148:149], v5 offset:8
    ds_read_b64_tr_b16 a[150:151], v5 offset:4104
    v_mfma_f32_16x16x32_bf16 v[76:79], a[140:143], a[44:47], -4.0
    ds_read_b64_tr_b16 a[180:181], v5 offset:8200
    ds_read_b64_tr_b16 a[182:183], v5 offset:12296
    v_mfma_f32_16x16x32_bf16 v[76:79], a[136:139], a[40:43], v[76:79]
    ds_read_b64_tr_b16 a[184:185], v5 offset:8448
    ds_read_b64_tr_b16 a[186:187], v5 offset:12544
    v_mfma_f32_16x16x32_bf16 v[76:79], a[132:135], a[36:39], v[76:79]
L_st5:
    s_cbranch_execz L_wret
    v_exp_f32 v72, v72
    v_mfma_f32_16x16x32_bf16 v[76:79], a[128:131], a[32:35], v[76:79]
    ds_read_b64_tr_b16 a[152:153], v5 offset:256
    ds_read_b64_tr_b16 a[154:155], v5 offset:4352
    v_mfma_f32_16x16x32_bf16 v[144:147], a[192:195], v[60:63], v[32:35]
    v_exp_f32 v73, v73
    v_mfma_f32_16x16x32_bf16 v[144:147], a[160:163], v[56:59], v[144:147]
    ds_read_b64_tr_b16 a[156:157], v5 offset:264
    v_cvt_pk_bf16_f32 v52, v72, v73
    v_mfma_f32_16x16x32_bf16 v[148:151], a[164:167], v[56:59], v[32:35]
    v_exp_f32 v74, v74
    v_mfma_f32_16x16x32_bf16 v[148:151], a[196:199], v[60:63], v[148:151]
    ds_read_b64_tr_b16 a[158:159], v5 offset:4360
    ds_read_b64_tr_b16 a[188:189], v5 offset:8456
    v_mfma_f32_16x16x32_bf16 v[152:155], a[200:203], v[60:63], v[32:35]
    v_exp_f32 v75, v75
    v_mfma_f32_16x16x32_bf16 v[152:155], a[168:171], v[56:59], v[152:155]
    ds_read_b64_tr_b16 a[190:191], v5 offset:12552
    v_cvt_pk_bf16_f32 v53, v74, v75
    v_mfma_f32_16x16x32_bf16 v[156:159], a[172:175], v[56:59], v[32:35]
    v_exp_f32 v76, v76
    v_mfma_f32_16x16x32_bf16 v[156:159], a[204:207], v[60:63], v[156:159]
    v_exp_f32 v77, v77
    v_mfma_f32_16x16x32_bf16 v[64:67], a[80:83], a[48:51], -4.0
    ds_read_b64_tr_b16 a[192:193], v5 offset:8704
    v_cvt_pk_bf16_f32 v54, v76, v77
    v_mfma_f32_16x16x32_bf16 v[64:67], a[84:87], a[52:55], v[64:67]
    v_exp_f32 v78, v78
    v_mfma_f32_16x16x32_bf16 v[64:67], a[88:91], a[56:59], v[64:67]
    ds_read_b64_tr_b16 a[194:195], v5 offset:12800
    ds_read_b64_tr_b16 a[160:161], v5 offset:512
    v_mfma_f32_16x16x32_bf16 v[64:67], a[92:95], a[60:63], v[64:67]
    v_exp_f32 v79, v79
    v_mfma_f32_16x16x32_bf16 v[68:71], a[108:111], a[60:63], -4.0
    ds_read_b64_tr_b16 a[162:163], v5 offset:4608
    v_cvt_pk_bf16_f32 v55, v78, v79
    v_mfma_f32_16x16x32_bf16 v[68:71], a[104:107], a[56:59], v[68:71]
    ds_read_b64_tr_b16 a[164:165], v5 offset:520
    ds_read_b64_tr_b16 a[166:167], v5 offset:4616
    v_mfma_f32_16x16x32_bf16 v[68:71], a[100:103], a[52:55], v[68:71]
    v_exp_f32 v64, v64
    v_mfma_f32_16x16x32_bf16 v[68:71], a[96:99], a[48:51], v[68:71]
    ds_read_b64_tr_b16 a[196:197], v5 offset:8712
    ds_read_b64_tr_b16 a[198:199], v5 offset:12808
    v_smfmac_f32_16x16x64_bf16 v[40:43], v[24:27], v[48:55], v9
    s_waitcnt lgkmcnt(7)
    ds_read_b64_tr_b16 a[200:201], v5 offset:8960
    ds_read_b64_tr_b16 a[202:203], v5 offset:13056
    v_mfma_f32_16x16x32_bf16 v[160:163], a[176:179], v[52:55], v[160:163]
    v_exp_f32 v65, v65
    v_mfma_f32_16x16x32_bf16 v[160:163], a[144:147], v[48:51], v[160:163]
    ds_read_b64_tr_b16 a[168:169], v5 offset:768
    ds_read_b64_tr_b16 a[170:171], v5 offset:4864
    v_mfma_f32_16x16x32_bf16 v[164:167], a[148:151], v[48:51], v[164:167]
    v_exp_f32 v66, v66
    v_mfma_f32_16x16x32_bf16 v[164:167], a[180:183], v[52:55], v[164:167]
    ds_read_b64_tr_b16 a[172:173], v5 offset:776
    ds_read_b64_tr_b16 a[174:175], v5 offset:4872
    v_mfma_f32_16x16x32_bf16 v[168:171], a[184:187], v[52:55], v[168:171]
    v_exp_f32 v67, v67
    v_mfma_f32_16x16x32_bf16 v[168:171], a[152:155], v[48:51], v[168:171]
    ds_read_b64_tr_b16 a[204:205], v5 offset:8968
    ds_read_b64_tr_b16 a[206:207], v5 offset:13064
    v_mfma_f32_16x16x32_bf16 v[172:175], a[156:159], v[48:51], v[172:175]
    v_exp_f32 v68, v68
    v_mfma_f32_16x16x32_bf16 v[172:175], a[188:191], v[52:55], v[172:175]
    v_cvt_pk_bf16_f32 v56, v64, v65
    v_cvt_pk_bf16_f32 v57, v66, v67
    v_mfma_f32_16x16x32_bf16 v[72:75], a[112:115], a[48:51], -4.0
    v_exp_f32 v69, v69
    v_mfma_f32_16x16x32_bf16 v[72:75], a[116:119], a[52:55], v[72:75]
    v_cvt_pk_bf16_f32 v58, v68, v69
    v_add_f32 v28, v40, v41
    v_mfma_f32_16x16x32_bf16 v[72:75], a[120:123], a[56:59], v[72:75]
    v_exp_f32 v70, v70
    v_mfma_f32_16x16x32_bf16 v[72:75], a[124:127], a[60:63], v[72:75]
    v_exp_f32 v71, v71
    v_mfma_f32_16x16x32_bf16 v[76:79], a[140:143], a[60:63], -4.0
    v_cvt_pk_bf16_f32 v59, v70, v71
    v_mov_b64 v[40:41], 0
    v_mfma_f32_16x16x32_bf16 v[76:79], a[136:139], a[56:59], v[76:79]
    v_rcp_f32 v12, v28
    v_mfma_f32_16x16x32_bf16 v[76:79], a[132:135], a[52:55], v[76:79]
    v_mul_f32_e64 v30, -v32, v12
    v_subrev_u32 v28, s30, v28
    v_mfma_f32_16x16x32_bf16 v[76:79], a[128:131], a[48:51], v[76:79]
    s_waitcnt lgkmcnt(0)
    v_exp_f32 v72, v72
    v_mfma_f32_16x16x32_bf16 v[176:179], a[192:195], v[52:55], v[176:179]
    v_fma_f32 v160, v160, v12, v30
    v_fma_f32 v161, v161, v12, v30
    v_mfma_f32_16x16x32_bf16 v[176:179], a[160:163], v[48:51], v[176:179]
    v_exp_f32 v73, v73
    v_mfma_f32_16x16x32_bf16 v[180:183], a[164:167], v[48:51], v[180:183]
    v_fma_f32 v162, v162, v12, v30
    v_cvt_pk_bf16_f32 v60, v72, v73
    v_mfma_f32_16x16x32_bf16 v[180:183], a[196:199], v[52:55], v[180:183]
    v_exp_f32 v74, v74
    v_mfma_f32_16x16x32_bf16 v[184:187], a[200:203], v[52:55], v[184:187]
    v_fma_f32 v163, v163, v12, v30
    v_fma_f32 v164, v164, v12, v30
    v_mfma_f32_16x16x32_bf16 v[184:187], a[168:171], v[48:51], v[184:187]
    v_exp_f32 v75, v75
    v_mfma_f32_16x16x32_bf16 v[188:191], a[172:175], v[48:51], v[188:191]
    v_fma_f32 v165, v165, v12, v30
    v_cvt_pk_bf16_f32 v61, v74, v75
    v_mfma_f32_16x16x32_bf16 v[188:191], a[204:207], v[52:55], v[188:191]
    s_barrier
    v_mfma_f32_16x16x32_bf16 v[64:67], a[80:83], a[64:67], -4.0
    s_mov_b32 s35, 0x10000
    v_exp_f32 v76, v76
    v_mfma_f32_16x16x32_bf16 v[64:67], a[84:87], a[68:71], v[64:67]
    v_fma_f32 v166, v166, v12, v30
    v_fma_f32 v167, v167, v12, v30
    v_mfma_f32_16x16x32_bf16 v[64:67], a[88:91], a[72:75], v[64:67]
    s_mov_b32 m0, s48
    v_exp_f32 v77, v77
    v_mfma_f32_16x16x32_bf16 v[64:67], a[92:95], a[76:79], v[64:67]
    v_exp_f32 v78, v78
    v_mfma_f32_16x16x32_bf16 v[68:71], a[108:111], a[76:79], -4.0
    v_exp_f32 v79, v79
    v_mfma_f32_16x16x32_bf16 v[68:71], a[104:107], a[72:75], v[68:71]
    buffer_load_dwordx4 v2, s[16:19], s35 offen offset:0 lds
    v_mfma_f32_16x16x32_bf16 v[68:71], a[100:103], a[68:71], v[68:71]
    v_cvt_pk_bf16_f32 v62, v76, v77
    v_cvt_pk_bf16_f32 v63, v78, v79
    v_mfma_f32_16x16x32_bf16 v[68:71], a[96:99], a[64:67], v[68:71]
    v_exp_f32 v64, v64
    v_smfmac_f32_16x16x64_bf16 v[42:45], v[24:27], v[56:63], v9
    v_max3_f32 v14, abs(v160), abs(v161), abs(v162)
    v_mfma_f32_16x16x32_bf16 v[192:195], a[176:179], v[60:63], v[192:195]
    buffer_load_dwordx4 v2, s[16:19], s35 offen offset:1024 lds
    v_mfma_f32_16x16x32_bf16 v[192:195], a[144:147], v[56:59], v[192:195]
    s_mov_b32 m0, s49
    v_exp_f32 v65, v65
    v_mfma_f32_16x16x32_bf16 v[196:199], a[148:151], v[56:59], v[196:199]
    s_mov_b32 s35, 0x12000
    v_fma_f32 v168, v168, v12, v30
    v_cvt_pk_bf16_f32 v48, v64, v65
    v_mfma_f32_16x16x32_bf16 v[196:199], a[180:183], v[60:63], v[196:199]
    v_exp_f32 v66, v66
    v_mfma_f32_16x16x32_bf16 v[200:203], a[184:187], v[60:63], v[200:203]
    buffer_load_dwordx4 v2, s[16:19], s35 offen offset:0 lds
    v_mfma_f32_16x16x32_bf16 v[200:203], a[152:155], v[56:59], v[200:203]
    v_exp_f32 v67, v67
    v_mfma_f32_16x16x32_bf16 v[204:207], a[156:159], v[56:59], v[204:207]
    v_fma_f32 v169, v169, v12, v30
    v_cvt_pk_bf16_f32 v49, v66, v67
    v_mfma_f32_16x16x32_bf16 v[204:207], a[188:191], v[60:63], v[204:207]
    v_exp_f32 v68, v68
    v_mfma_f32_16x16x32_bf16 v[72:75], a[112:115], a[64:67], -4.0
    buffer_load_dwordx4 v2, s[16:19], s35 offen offset:1024 lds
    v_mfma_f32_16x16x32_bf16 v[72:75], a[116:119], a[68:71], v[72:75]
    v_exp_f32 v69, v69
    v_mfma_f32_16x16x32_bf16 v[72:75], a[120:123], a[72:75], v[72:75]
    v_fma_f32 v170, v170, v12, v30
    v_cvt_pk_bf16_f32 v50, v68, v69
    v_mfma_f32_16x16x32_bf16 v[72:75], a[124:127], a[76:79], v[72:75]
    v_exp_f32 v70, v70
    v_mfma_f32_16x16x32_bf16 v[76:79], a[140:143], a[76:79], -4.0
    v_fma_f32 v171, v171, v12, v30
    v_fma_f32 v172, v172, v12, v30
    v_mfma_f32_16x16x32_bf16 v[76:79], a[136:139], a[72:75], v[76:79]
    v_exp_f32 v71, v71
    v_mfma_f32_16x16x32_bf16 v[76:79], a[132:135], a[68:71], v[76:79]
    v_fma_f32 v173, v173, v12, v30
    v_cvt_pk_bf16_f32 v51, v70, v71
    v_mfma_f32_16x16x32_bf16 v[76:79], a[128:131], a[64:67], v[76:79]
    v_exp_f32 v72, v72
    v_mfma_f32_16x16x32_bf16 v[208:211], a[192:195], v[60:63], v[208:211]
    v_fma_f32 v174, v174, v12, v30
    v_fma_f32 v175, v175, v12, v30
    v_mfma_f32_16x16x32_bf16 v[208:211], a[160:163], v[56:59], v[208:211]
    v_exp_f32 v73, v73
    v_mfma_f32_16x16x32_bf16 v[212:215], a[164:167], v[56:59], v[212:215]
    v_max3_f32 v14, v14, abs(v163), abs(v164)
    v_cvt_pk_bf16_f32 v52, v72, v73
    v_mfma_f32_16x16x32_bf16 v[212:215], a[196:199], v[60:63], v[212:215]
    v_exp_f32 v74, v74
    v_mfma_f32_16x16x32_bf16 v[216:219], a[200:203], v[60:63], v[216:219]
    v_cvt_pk_bf16_f32 v160, v160, v161
    v_cvt_pk_bf16_f32 v168, v168, v169
    v_mfma_f32_16x16x32_bf16 v[216:219], a[168:171], v[56:59], v[216:219]
    v_exp_f32 v75, v75
    v_mfma_f32_16x16x32_bf16 v[220:223], a[172:175], v[56:59], v[220:223]
    v_cvt_pk_bf16_f32 v161, v162, v163
    v_cvt_pk_bf16_f32 v53, v74, v75
    v_mfma_f32_16x16x32_bf16 v[220:223], a[204:207], v[60:63], v[220:223]
    v_exp_f32 v76, v76
    v_mfma_f32_16x16x32_bf16 v[64:67], a[80:83], a[0:3], -4.0
    v_cvt_pk_bf16_f32 v162, v164, v165
    v_cvt_pk_bf16_f32 v163, v166, v167
    v_mfma_f32_16x16x32_bf16 v[64:67], a[84:87], a[4:7], v[64:67]
    v_exp_f32 v77, v77
    v_mfma_f32_16x16x32_bf16 v[64:67], a[88:91], a[8:11], v[64:67]
    v_cvt_pk_bf16_f32 v169, v170, v171
    v_cvt_pk_bf16_f32 v54, v76, v77
    v_mfma_f32_16x16x32_bf16 v[64:67], a[92:95], a[12:15], v[64:67]
    v_exp_f32 v78, v78
    v_mfma_f32_16x16x32_bf16 v[68:71], a[108:111], a[12:15], -4.0
    v_cvt_pk_bf16_f32 v170, v172, v173
    v_cvt_pk_bf16_f32 v171, v174, v175
    v_mfma_f32_16x16x32_bf16 v[68:71], a[104:107], a[8:11], v[68:71]
    v_exp_f32 v79, v79
    v_mfma_f32_16x16x32_bf16 v[68:71], a[100:103], a[4:7], v[68:71]
    v_cndmask_b32_dpp v164, v168, v160, vcc row_ror:8 row_mask:0xf bank_mask:0xf
    v_cvt_pk_bf16_f32 v55, v78, v79
    v_mfma_f32_16x16x32_bf16 v[68:71], a[96:99], a[0:3], v[68:71]
    v_exp_f32 v64, v64
    v_smfmac_f32_16x16x64_bf16 v[44:47], v[24:27], v[48:55], v9
    v_cndmask_b32_dpp v165, v169, v161, vcc row_ror:8 row_mask:0xf bank_mask:0xf
    v_mfma_f32_16x16x32_bf16 v[224:227], a[176:179], v[52:55], v[224:227]
    v_exp_f32 v65, v65
    v_mfma_f32_16x16x32_bf16 v[224:227], a[144:147], v[48:51], v[224:227]
    v_cndmask_b32_dpp v166, v170, v162, vcc row_ror:8 row_mask:0xf bank_mask:0xf
    v_cvt_pk_bf16_f32 v56, v64, v65
    v_mfma_f32_16x16x32_bf16 v[228:231], a[148:151], v[48:51], v[228:231]
    v_exp_f32 v66, v66
    v_mfma_f32_16x16x32_bf16 v[228:231], a[180:183], v[52:55], v[228:231]
    v_fma_f32 v14, v14, s42, v30
    v_cndmask_b32_dpp v167, v171, v163, vcc row_ror:8 row_mask:0xf bank_mask:0xf
    v_mfma_f32_16x16x32_bf16 v[232:235], a[184:187], v[52:55], v[232:235]
    v_exp_f32 v67, v67
    v_mfma_f32_16x16x32_bf16 v[232:235], a[152:155], v[48:51], v[232:235]
    v_and_or_b32 v14, v14, s43, v28
    v_cvt_pk_bf16_f32 v57, v66, v67
    v_mfma_f32_16x16x32_bf16 v[236:239], a[156:159], v[48:51], v[236:239]
    v_exp_f32 v68, v68
    v_mfma_f32_16x16x32_bf16 v[236:239], a[188:191], v[52:55], v[236:239]
    v_cmp_lt_u32_e64 s[4:5], s31, v14
    v_mov_b32_dpp v168, v160 row_ror:8 row_mask:0xf bank_mask:0x3
    v_mfma_f32_16x16x32_bf16 v[72:75], a[112:115], a[0:3], -4.0
    v_exp_f32 v69, v69
    v_mfma_f32_16x16x32_bf16 v[72:75], a[116:119], a[4:7], v[72:75]
    v_mov_b32_dpp v169, v161 row_ror:8 row_mask:0xf bank_mask:0x3
    v_cvt_pk_bf16_f32 v58, v68, v69
    v_mfma_f32_16x16x32_bf16 v[72:75], a[120:123], a[8:11], v[72:75]
    v_exp_f32 v70, v70
    v_mfma_f32_16x16x32_bf16 v[72:75], a[124:127], a[12:15], v[72:75]
    v_mov_b32_dpp v170, v162 row_ror:8 row_mask:0xf bank_mask:0x3
    v_mov_b32_dpp v171, v163 row_ror:8 row_mask:0xf bank_mask:0x3
    v_mfma_f32_16x16x32_bf16 v[76:79], a[140:143], a[12:15], -4.0
    v_exp_f32 v71, v71
    v_mfma_f32_16x16x32_bf16 v[76:79], a[136:139], a[8:11], v[76:79]
    s_waitcnt vmcnt(8)
    ds_read_b128 a[32:35], v15 offset:0
    v_cvt_pk_bf16_f32 v59, v70, v71
    v_mfma_f32_16x16x32_bf16 v[76:79], a[132:135], a[4:7], v[76:79]
    v_exp_f32 v72, v72
    v_mfma_f32_16x16x32_bf16 v[76:79], a[128:131], a[0:3], v[76:79]
    ds_read_b128 a[36:39], v15 offset:256
    v_fma_f32 v176, v176, v12, v30
    v_mfma_f32_16x16x32_bf16 v[240:243], a[192:195], v[52:55], v[240:243]
    v_exp_f32 v73, v73
    v_mfma_f32_16x16x32_bf16 v[240:243], a[160:163], v[48:51], v[240:243]
    v_fma_f32 v177, v177, v12, v30
    v_cvt_pk_bf16_f32 v60, v72, v73
    v_mfma_f32_16x16x32_bf16 v[244:247], a[164:167], v[48:51], v[244:247]
    v_exp_f32 v74, v74
    v_mfma_f32_16x16x32_bf16 v[244:247], a[196:199], v[52:55], v[244:247]
    ds_read_b128 a[40:43], v15 offset:512
    v_fma_f32 v178, v178, v12, v30
    v_mfma_f32_16x16x32_bf16 v[248:251], a[200:203], v[52:55], v[248:251]
    v_exp_f32 v75, v75
    v_mfma_f32_16x16x32_bf16 v[248:251], a[168:171], v[48:51], v[248:251]
    ds_read_b128 a[44:47], v15 offset:768
    v_cvt_pk_bf16_f32 v61, v74, v75
    v_mfma_f32_16x16x32_bf16 v[252:255], a[172:175], v[48:51], v[252:255]
    v_exp_f32 v76, v76
    v_mfma_f32_16x16x32_bf16 v[252:255], a[204:207], v[52:55], v[252:255]
    v_fma_f32 v179, v179, v12, v30
    v_fma_f32 v180, v180, v12, v30
    v_mfma_f32_16x16x32_bf16 v[64:67], a[80:83], a[16:19], -4.0
    v_exp_f32 v77, v77
    v_mfma_f32_16x16x32_bf16 v[64:67], a[84:87], a[20:23], v[64:67]
    ds_read_b128 a[80:83], v3 offset:49152
    v_cvt_pk_bf16_f32 v62, v76, v77
    v_mfma_f32_16x16x32_bf16 v[64:67], a[88:91], a[24:27], v[64:67]
    v_exp_f32 v78, v78
    v_mfma_f32_16x16x32_bf16 v[64:67], a[92:95], a[28:31], v[64:67]
    ds_read_b128 a[84:87], v3 offset:50176
    v_fma_f32 v181, v181, v12, v30
    v_mfma_f32_16x16x32_bf16 v[68:71], a[108:111], a[28:31], -4.0
    v_exp_f32 v79, v79
    v_mfma_f32_16x16x32_bf16 v[68:71], a[104:107], a[24:27], v[68:71]
    ds_read_b128 a[88:91], v3 offset:51200
    v_cvt_pk_bf16_f32 v63, v78, v79
    v_mfma_f32_16x16x32_bf16 v[68:71], a[100:103], a[20:23], v[68:71]
    v_exp_f32 v64, v64
    v_mfma_f32_16x16x32_bf16 v[68:71], a[96:99], a[16:19], v[68:71]
    v_fma_f32 v182, v182, v12, v30
    v_fma_f32 v183, v183, v12, v30
    v_smfmac_f32_16x16x64_bf16 v[36:39], v[24:27], v[56:63], v9
    s_mov_b32 m0, s26
    ds_read_b128 a[92:95], v3 offset:52224
    v_fma_f32 v184, v184, v12, v30
    v_mfma_f32_16x16x32_bf16 v[96:99], a[176:179], v[60:63], v[96:99]
    v_exp_f32 v65, v65
    v_mfma_f32_16x16x32_bf16 v[96:99], a[144:147], v[56:59], v[96:99]
    v_fma_f32 v185, v185, v12, v30
    v_cvt_pk_bf16_f32 v48, v64, v65
    v_mfma_f32_16x16x32_bf16 v[100:103], a[148:151], v[56:59], v[100:103]
    s_waitcnt lgkmcnt(2)
    buffer_load_dwordx4 v2, s[8:11], s33 offen offset:0 nt lds
    v_mfma_f32_16x16x32_bf16 v[100:103], a[180:183], v[60:63], v[100:103]
    v_exp_f32 v66, v66
    v_mfma_f32_16x16x32_bf16 v[104:107], a[184:187], v[60:63], v[104:107]
    ds_read_b128 a[108:111], v3 offset:56320
    v_fma_f32 v186, v186, v12, v30
    v_mfma_f32_16x16x32_bf16 v[104:107], a[152:155], v[56:59], v[104:107]
    v_exp_f32 v67, v67
    v_mfma_f32_16x16x32_bf16 v[108:111], a[156:159], v[56:59], v[108:111]
    buffer_load_dwordx4 v2, s[8:11], s33 offen offset:1024 nt lds
    v_mfma_f32_16x16x32_bf16 v[108:111], a[188:191], v[60:63], v[108:111]
    v_exp_f32 v68, v68
    v_mfma_f32_16x16x32_bf16 v[72:75], a[112:115], a[16:19], -4.0
    ds_read_b128 a[104:107], v3 offset:55296
    v_cvt_pk_bf16_f32 v49, v66, v67
    v_mfma_f32_16x16x32_bf16 v[72:75], a[116:119], a[20:23], v[72:75]
    v_exp_f32 v69, v69
    v_mfma_f32_16x16x32_bf16 v[72:75], a[120:123], a[24:27], v[72:75]
    buffer_load_dwordx4 v2, s[8:11], s33 offen offset:2048 nt lds
    v_mfma_f32_16x16x32_bf16 v[72:75], a[124:127], a[28:31], v[72:75]
    v_exp_f32 v70, v70
    v_mfma_f32_16x16x32_bf16 v[76:79], a[140:143], a[28:31], -4.0
    ds_read_b128 a[100:103], v3 offset:54272
    v_cvt_pk_bf16_f32 v50, v68, v69
    v_mfma_f32_16x16x32_bf16 v[76:79], a[136:139], a[24:27], v[76:79]
    v_exp_f32 v71, v71
    v_mfma_f32_16x16x32_bf16 v[76:79], a[132:135], a[20:23], v[76:79]
    buffer_load_dwordx4 v2, s[8:11], s33 offen offset:3072 nt lds
    v_mfma_f32_16x16x32_bf16 v[76:79], a[128:131], a[16:19], v[76:79]
    s_add_u32 s33, s33, s38
    v_exp_f32 v72, v72
    v_mfma_f32_16x16x32_bf16 v[112:115], a[192:195], v[60:63], v[112:115]
    ds_read_b128 a[96:99], v3 offset:53248
    v_cvt_pk_bf16_f32 v51, v70, v71
    v_mfma_f32_16x16x32_bf16 v[112:115], a[160:163], v[56:59], v[112:115]
    v_exp_f32 v73, v73
    v_mfma_f32_16x16x32_bf16 v[116:119], a[164:167], v[56:59], v[116:119]
    ds_read_b128 a[112:115], v3 offset:57344
    v_cvt_pk_bf16_f32 v52, v72, v73
    v_mfma_f32_16x16x32_bf16 v[116:119], a[196:199], v[60:63], v[116:119]
    v_exp_f32 v74, v74
    v_mfma_f32_16x16x32_bf16 v[120:123], a[200:203], v[60:63], v[120:123]
    ds_read_b128 a[116:119], v3 offset:58368
    ds_read_b128 a[120:123], v3 offset:59392
    v_mfma_f32_16x16x32_bf16 v[120:123], a[168:171], v[56:59], v[120:123]
    v_exp_f32 v75, v75
    v_mfma_f32_16x16x32_bf16 v[124:127], a[172:175], v[56:59], v[124:127]
    ds_read_b128 a[124:127], v3 offset:60416
    v_cvt_pk_bf16_f32 v53, v74, v75
    v_mfma_f32_16x16x32_bf16 v[124:127], a[204:207], v[60:63], v[124:127]
    v_exp_f32 v76, v76
    v_mfma_f32_16x16x32_bf16 v[64:67], a[80:83], a[48:51], -4.0
    ds_read_b128 a[140:143], v3 offset:64512
    ds_read_b128 a[136:139], v3 offset:63488
    v_mfma_f32_16x16x32_bf16 v[64:67], a[84:87], a[52:55], v[64:67]
    s_waitcnt lgkmcnt(6)
    v_exp_f32 v77, v77
    v_mfma_f32_16x16x32_bf16 v[64:67], a[88:91], a[56:59], v[64:67]
    ds_read_b128 a[132:135], v3 offset:62464
    v_cvt_pk_bf16_f32 v54, v76, v77
    v_mfma_f32_16x16x32_bf16 v[64:67], a[92:95], a[60:63], v[64:67]
    v_exp_f32 v78, v78
    v_mfma_f32_16x16x32_bf16 v[68:71], a[108:111], a[60:63], -4.0
    ds_read_b128 a[128:131], v3 offset:61440
    v_fma_f32 v187, v187, v12, v30
    v_mfma_f32_16x16x32_bf16 v[68:71], a[104:107], a[56:59], v[68:71]
    v_exp_f32 v79, v79
    v_mfma_f32_16x16x32_bf16 v[68:71], a[100:103], a[52:55], v[68:71]
    v_fma_f32 v188, v188, v12, v30
    v_cvt_pk_bf16_f32 v55, v78, v79
    v_mfma_f32_16x16x32_bf16 v[68:71], a[96:99], a[48:51], v[68:71]
    v_exp_f32 v64, v64
    v_smfmac_f32_16x16x64_bf16 v[38:41], v[24:27], v[48:55], v9
    s_barrier
    v_mfma_f32_16x16x32_bf16 v[128:131], a[176:179], v[52:55], v[128:131]
    v_exp_f32 v65, v65
    v_mfma_f32_16x16x32_bf16 v[128:131], a[144:147], v[48:51], v[128:131]
    ds_read_b64_tr_b16 a[176:177], v5 offset:24576
    v_cvt_pk_bf16_f32 v56, v64, v65
    v_mfma_f32_16x16x32_bf16 v[132:135], a[148:151], v[48:51], v[132:135]
    v_exp_f32 v66, v66
    v_mfma_f32_16x16x32_bf16 v[132:135], a[180:183], v[52:55], v[132:135]
    ds_read_b64_tr_b16 a[178:179], v5 offset:28672
    v_fma_f32 v189, v189, v12, v30
    v_mfma_f32_16x16x32_bf16 v[136:139], a[184:187], v[52:55], v[136:139]
    v_exp_f32 v67, v67
    v_mfma_f32_16x16x32_bf16 v[136:139], a[152:155], v[48:51], v[136:139]
    ds_read_b64_tr_b16 a[144:145], v5 offset:16384
    v_cvt_pk_bf16_f32 v57, v66, v67
    v_mfma_f32_16x16x32_bf16 v[140:143], a[156:159], v[48:51], v[140:143]
    v_exp_f32 v68, v68
    v_mfma_f32_16x16x32_bf16 v[140:143], a[188:191], v[52:55], v[140:143]
    s_waitcnt lgkmcnt(3)
    ds_read_b64_tr_b16 a[146:147], v5 offset:20480
    v_fma_f32 v190, v190, v12, v30
    v_mfma_f32_16x16x32_bf16 v[72:75], a[112:115], a[48:51], -4.0
    v_exp_f32 v69, v69
    v_mfma_f32_16x16x32_bf16 v[72:75], a[116:119], a[52:55], v[72:75]
    ds_read_b64_tr_b16 a[148:149], v5 offset:16392
    v_cvt_pk_bf16_f32 v58, v68, v69
    v_mfma_f32_16x16x32_bf16 v[72:75], a[120:123], a[56:59], v[72:75]
    v_exp_f32 v70, v70
    v_mfma_f32_16x16x32_bf16 v[72:75], a[124:127], a[60:63], v[72:75]
    ds_read_b64_tr_b16 a[150:151], v5 offset:20488
    v_fma_f32 v191, v191, v12, v30
    v_mfma_f32_16x16x32_bf16 v[76:79], a[140:143], a[60:63], -4.0
    v_exp_f32 v71, v71
    v_mfma_f32_16x16x32_bf16 v[76:79], a[136:139], a[56:59], v[76:79]
    ds_read_b64_tr_b16 a[180:181], v5 offset:24584
    v_cvt_pk_bf16_f32 v59, v70, v71
    v_mfma_f32_16x16x32_bf16 v[76:79], a[132:135], a[52:55], v[76:79]
    v_exp_f32 v72, v72
    v_mfma_f32_16x16x32_bf16 v[76:79], a[128:131], a[48:51], v[76:79]
    ds_read_b64_tr_b16 a[182:183], v5 offset:28680
    ds_read_b64_tr_b16 a[184:185], v5 offset:24832
    v_mfma_f32_16x16x32_bf16 v[144:147], a[192:195], v[52:55], v[144:147]
    v_exp_f32 v73, v73
    v_mfma_f32_16x16x32_bf16 v[144:147], a[160:163], v[48:51], v[144:147]
    ds_read_b64_tr_b16 a[186:187], v5 offset:28928
    v_cvt_pk_bf16_f32 v60, v72, v73
    v_mfma_f32_16x16x32_bf16 v[148:151], a[164:167], v[48:51], v[148:151]
    v_exp_f32 v74, v74
    v_mfma_f32_16x16x32_bf16 v[148:151], a[196:199], v[52:55], v[148:151]
    ds_read_b64_tr_b16 a[152:153], v5 offset:16640
    ds_read_b64_tr_b16 a[154:155], v5 offset:20736
    v_mfma_f32_16x16x32_bf16 v[152:155], a[200:203], v[52:55], v[152:155]
    v_exp_f32 v75, v75
    v_mfma_f32_16x16x32_bf16 v[152:155], a[168:171], v[48:51], v[152:155]
    ds_read_b64_tr_b16 a[156:157], v5 offset:16648
    v_cvt_pk_bf16_f32 v61, v74, v75
    v_mfma_f32_16x16x32_bf16 v[156:159], a[172:175], v[48:51], v[156:159]
    v_exp_f32 v76, v76
    v_mfma_f32_16x16x32_bf16 v[156:159], a[204:207], v[52:55], v[156:159]
    ds_read_b64_tr_b16 a[158:159], v5 offset:20744
    ds_read_b64_tr_b16 a[188:189], v5 offset:24840
    v_mfma_f32_16x16x32_bf16 v[64:67], a[80:83], a[64:67], -4.0
    v_exp_f32 v77, v77
    v_mfma_f32_16x16x32_bf16 v[64:67], a[84:87], a[68:71], v[64:67]
    ds_read_b64_tr_b16 a[190:191], v5 offset:28936
    v_cvt_pk_bf16_f32 v62, v76, v77
    v_mfma_f32_16x16x32_bf16 v[64:67], a[88:91], a[72:75], v[64:67]
    v_exp_f32 v78, v78
    v_mfma_f32_16x16x32_bf16 v[64:67], a[92:95], a[76:79], v[64:67]
    ds_read_b64_tr_b16 a[192:193], v5 offset:25088
    ds_read_b64_tr_b16 a[194:195], v5 offset:29184
    v_mfma_f32_16x16x32_bf16 v[68:71], a[108:111], a[76:79], -4.0
    v_exp_f32 v79, v79
    v_mfma_f32_16x16x32_bf16 v[68:71], a[104:107], a[72:75], v[68:71]
    ds_read_b64_tr_b16 a[160:161], v5 offset:16896
    v_cvt_pk_bf16_f32 v63, v78, v79
    v_mfma_f32_16x16x32_bf16 v[68:71], a[100:103], a[68:71], v[68:71]
    v_exp_f32 v64, v64
    v_mfma_f32_16x16x32_bf16 v[68:71], a[96:99], a[64:67], v[68:71]
    ds_read_b64_tr_b16 a[162:163], v5 offset:20992
    ds_read_b64_tr_b16 a[164:165], v5 offset:16904
    v_smfmac_f32_16x16x64_bf16 v[42:45], v[24:27], v[56:63], v9
    s_waitcnt lgkmcnt(6)
    ds_read_b64_tr_b16 a[166:167], v5 offset:21000
    ds_read_b64_tr_b16 a[196:197], v5 offset:25096
    v_mfma_f32_16x16x32_bf16 v[192:195], a[176:179], v[60:63], v[192:195]
    v_exp_f32 v65, v65
    v_mfma_f32_16x16x32_bf16 v[192:195], a[144:147], v[56:59], v[192:195]
    ds_read_b64_tr_b16 a[198:199], v5 offset:29192
    ds_read_b64_tr_b16 a[200:201], v5 offset:25344
    v_mfma_f32_16x16x32_bf16 v[196:199], a[148:151], v[56:59], v[196:199]
    v_exp_f32 v66, v66
    v_mfma_f32_16x16x32_bf16 v[196:199], a[180:183], v[60:63], v[196:199]
    ds_read_b64_tr_b16 a[202:203], v5 offset:29440
    ds_read_b64_tr_b16 a[168:169], v5 offset:17152
    v_mfma_f32_16x16x32_bf16 v[200:203], a[184:187], v[60:63], v[200:203]
    v_exp_f32 v67, v67
    v_mfma_f32_16x16x32_bf16 v[200:203], a[152:155], v[56:59], v[200:203]
    ds_read_b64_tr_b16 a[170:171], v5 offset:21248
    ds_read_b64_tr_b16 a[172:173], v5 offset:17160
    v_mfma_f32_16x16x32_bf16 v[204:207], a[156:159], v[56:59], v[204:207]
    s_waitcnt lgkmcnt(8)
    v_exp_f32 v68, v68
    v_mfma_f32_16x16x32_bf16 v[204:207], a[188:191], v[60:63], v[204:207]
    ds_read_b64_tr_b16 a[174:175], v5 offset:21256
    ds_read_b64_tr_b16 a[204:205], v5 offset:25352
    v_mfma_f32_16x16x32_bf16 v[72:75], a[112:115], a[64:67], -4.0
    v_exp_f32 v69, v69
    v_mfma_f32_16x16x32_bf16 v[72:75], a[116:119], a[68:71], v[72:75]
    ds_read_b64_tr_b16 a[206:207], v5 offset:29448
    v_cvt_pk_bf16_f32 v48, v64, v65
    v_mfma_f32_16x16x32_bf16 v[72:75], a[120:123], a[72:75], v[72:75]
    v_exp_f32 v70, v70
    v_mfma_f32_16x16x32_bf16 v[72:75], a[124:127], a[76:79], v[72:75]
    v_cvt_pk_bf16_f32 v49, v66, v67
    v_cvt_pk_bf16_f32 v50, v68, v69
    v_mfma_f32_16x16x32_bf16 v[76:79], a[140:143], a[76:79], -4.0
    v_exp_f32 v71, v71
    v_mfma_f32_16x16x32_bf16 v[76:79], a[136:139], a[72:75], v[76:79]
    v_cvt_pk_bf16_f32 v176, v176, v177
    v_cvt_pk_bf16_f32 v51, v70, v71
    v_mfma_f32_16x16x32_bf16 v[76:79], a[132:135], a[68:71], v[76:79]
    v_exp_f32 v72, v72
    v_mfma_f32_16x16x32_bf16 v[76:79], a[128:131], a[64:67], v[76:79]
    v_cvt_pk_bf16_f32 v177, v178, v179
    v_cvt_pk_bf16_f32 v184, v184, v185
    v_mfma_f32_16x16x32_bf16 v[208:211], a[192:195], v[60:63], v[208:211]
    v_exp_f32 v73, v73
    v_mfma_f32_16x16x32_bf16 v[208:211], a[160:163], v[56:59], v[208:211]
    s_waitcnt lgkmcnt(0)
    v_cvt_pk_bf16_f32 v178, v180, v181
    v_cvt_pk_bf16_f32 v52, v72, v73
    v_mfma_f32_16x16x32_bf16 v[212:215], a[164:167], v[56:59], v[212:215]
    v_exp_f32 v74, v74
    v_mfma_f32_16x16x32_bf16 v[212:215], a[196:199], v[60:63], v[212:215]
    v_cvt_pk_bf16_f32 v179, v182, v183
    v_cvt_pk_bf16_f32 v185, v186, v187
    v_mfma_f32_16x16x32_bf16 v[216:219], a[200:203], v[60:63], v[216:219]
    v_exp_f32 v75, v75
    v_mfma_f32_16x16x32_bf16 v[216:219], a[168:171], v[56:59], v[216:219]
    v_cvt_pk_bf16_f32 v186, v188, v189
    v_cvt_pk_bf16_f32 v53, v74, v75
    v_mfma_f32_16x16x32_bf16 v[220:223], a[172:175], v[56:59], v[220:223]
    v_exp_f32 v76, v76
    v_mfma_f32_16x16x32_bf16 v[220:223], a[204:207], v[60:63], v[220:223]
    s_barrier
    v_mfma_f32_16x16x32_bf16 v[64:67], a[80:83], a[0:3], -4.0
    s_mov_b32 s35, 0x14000
    v_exp_f32 v77, v77
    v_mfma_f32_16x16x32_bf16 v[64:67], a[84:87], a[4:7], v[64:67]
    v_cvt_pk_bf16_f32 v187, v190, v191
    v_cvt_pk_bf16_f32 v54, v76, v77
    v_mfma_f32_16x16x32_bf16 v[64:67], a[88:91], a[8:11], v[64:67]
    s_mov_b32 m0, s50
    v_exp_f32 v78, v78
    v_mfma_f32_16x16x32_bf16 v[64:67], a[92:95], a[12:15], v[64:67]
    v_cndmask_b32_dpp v180, v184, v176, vcc row_ror:8 row_mask:0xf bank_mask:0xf
    v_cndmask_b32_dpp v181, v185, v177, vcc row_ror:8 row_mask:0xf bank_mask:0xf
    v_mfma_f32_16x16x32_bf16 v[68:71], a[108:111], a[12:15], -4.0
    v_exp_f32 v79, v79
    v_mfma_f32_16x16x32_bf16 v[68:71], a[104:107], a[8:11], v[68:71]
    buffer_load_dwordx4 v2, s[16:19], s35 offen offset:0 lds
    v_mfma_f32_16x16x32_bf16 v[68:71], a[100:103], a[4:7], v[68:71]
    v_cndmask_b32_dpp v182, v186, v178, vcc row_ror:8 row_mask:0xf bank_mask:0xf
    v_cvt_pk_bf16_f32 v55, v78, v79
    v_mfma_f32_16x16x32_bf16 v[68:71], a[96:99], a[0:3], v[68:71]
    v_exp_f32 v64, v64
    v_smfmac_f32_16x16x64_bf16 v[44:47], v[24:27], v[48:55], v9
    v_cndmask_b32_dpp v183, v187, v179, vcc row_ror:8 row_mask:0xf bank_mask:0xf
    v_mfma_f32_16x16x32_bf16 v[224:227], a[176:179], v[52:55], v[224:227]
    buffer_load_dwordx4 v2, s[16:19], s35 offen offset:1024 lds
    v_mfma_f32_16x16x32_bf16 v[224:227], a[144:147], v[48:51], v[224:227]
    s_mov_b32 m0, s51
    v_exp_f32 v65, v65
    v_mfma_f32_16x16x32_bf16 v[228:231], a[148:151], v[48:51], v[228:231]
    s_mov_b32 s35, 0x16000
    v_mov_b32_dpp v184, v176 row_ror:8 row_mask:0xf bank_mask:0x3
    v_cvt_pk_bf16_f32 v56, v64, v65
    v_mfma_f32_16x16x32_bf16 v[228:231], a[180:183], v[52:55], v[228:231]
    v_exp_f32 v66, v66
    v_mfma_f32_16x16x32_bf16 v[232:235], a[184:187], v[52:55], v[232:235]
    buffer_load_dwordx4 v2, s[16:19], s35 offen offset:0 lds
    v_mfma_f32_16x16x32_bf16 v[232:235], a[152:155], v[48:51], v[232:235]
    v_exp_f32 v67, v67
    v_mfma_f32_16x16x32_bf16 v[236:239], a[156:159], v[48:51], v[236:239]
    v_mov_b32_dpp v185, v177 row_ror:8 row_mask:0xf bank_mask:0x3
    v_cvt_pk_bf16_f32 v57, v66, v67
    v_mfma_f32_16x16x32_bf16 v[236:239], a[188:191], v[52:55], v[236:239]
    v_exp_f32 v68, v68
    v_mfma_f32_16x16x32_bf16 v[72:75], a[112:115], a[0:3], -4.0
    buffer_load_dwordx4 v2, s[16:19], s35 offen offset:1024 lds
    v_mfma_f32_16x16x32_bf16 v[72:75], a[116:119], a[4:7], v[72:75]
    v_exp_f32 v69, v69
    v_mfma_f32_16x16x32_bf16 v[72:75], a[120:123], a[8:11], v[72:75]
    v_mov_b32_dpp v186, v178 row_ror:8 row_mask:0xf bank_mask:0x3
    v_cvt_pk_bf16_f32 v58, v68, v69
    v_mfma_f32_16x16x32_bf16 v[72:75], a[124:127], a[12:15], v[72:75]
    v_exp_f32 v70, v70
    v_mfma_f32_16x16x32_bf16 v[76:79], a[140:143], a[12:15], -4.0
    v_exp_f32 v71, v71
    v_mfma_f32_16x16x32_bf16 v[76:79], a[136:139], a[8:11], v[76:79]
    v_mov_b32_dpp v187, v179 row_ror:8 row_mask:0xf bank_mask:0x3
    v_cvt_pk_bf16_f32 v59, v70, v71
    v_mfma_f32_16x16x32_bf16 v[76:79], a[132:135], a[4:7], v[76:79]
L_st6:
    s_cbranch_execz L_st7
    v_exp_f32 v72, v72
    v_mfma_f32_16x16x32_bf16 v[76:79], a[128:131], a[0:3], v[76:79]
    v_exp_f32 v73, v73
    v_mfma_f32_16x16x32_bf16 v[240:243], a[192:195], v[52:55], v[240:243]
    v_exp_f32 v74, v74
    v_mfma_f32_16x16x32_bf16 v[240:243], a[160:163], v[48:51], v[240:243]
    v_exp_f32 v75, v75
    v_mfma_f32_16x16x32_bf16 v[244:247], a[164:167], v[48:51], v[244:247]
    v_cvt_pk_bf16_f32 v60, v72, v73
    v_cvt_pk_bf16_f32 v61, v74, v75
    v_mfma_f32_16x16x32_bf16 v[244:247], a[196:199], v[52:55], v[244:247]
    v_exp_f32 v76, v76
    v_mfma_f32_16x16x32_bf16 v[248:251], a[200:203], v[52:55], v[248:251]
    buffer_store_dwordx4 v[164:167], v8, s[20:23], s34 offen offset:0 sc1
    v_mfma_f32_16x16x32_bf16 v[248:251], a[168:171], v[48:51], v[248:251]
    v_exp_f32 v77, v77
    v_mfma_f32_16x16x32_bf16 v[252:255], a[172:175], v[48:51], v[252:255]
    s_cmp_lg_u64 s[4:5], 0
    v_exp_f32 v78, v78
    v_mfma_f32_16x16x32_bf16 v[252:255], a[204:207], v[52:55], v[252:255]
    s_addc_u32 s32, s32, s32
    v_exp_f32 v79, v79
    v_mfma_f32_16x16x32_bf16 v[64:67], a[80:83], a[16:19], -4.0
    v_cvt_pk_bf16_f32 v62, v76, v77
    v_cvt_pk_bf16_f32 v63, v78, v79
    v_mfma_f32_16x16x32_bf16 v[64:67], a[84:87], a[20:23], v[64:67]
    v_mfma_f32_16x16x32_bf16 v[64:67], a[88:91], a[24:27], v[64:67]
    v_mfma_f32_16x16x32_bf16 v[64:67], a[92:95], a[28:31], v[64:67]
    v_mfma_f32_16x16x32_bf16 v[68:71], a[108:111], a[28:31], -4.0
    v_mfma_f32_16x16x32_bf16 v[68:71], a[104:107], a[24:27], v[68:71]
    v_mfma_f32_16x16x32_bf16 v[68:71], a[100:103], a[20:23], v[68:71]
    v_exp_f32 v64, v64
    v_mfma_f32_16x16x32_bf16 v[68:71], a[96:99], a[16:19], v[68:71]
    v_exp_f32 v65, v65
    v_smfmac_f32_16x16x64_bf16 v[36:39], v[24:27], v[56:63], v9
    v_cvt_pk_bf16_f32 v48, v64, v65
    v_mfma_f32_16x16x32_bf16 v[96:99], a[176:179], v[60:63], v[96:99]
    v_exp_f32 v66, v66
    v_mfma_f32_16x16x32_bf16 v[96:99], a[144:147], v[56:59], v[96:99]
    v_exp_f32 v67, v67
    v_mfma_f32_16x16x32_bf16 v[100:103], a[148:151], v[56:59], v[100:103]
    v_exp_f32 v68, v68
    v_mfma_f32_16x16x32_bf16 v[100:103], a[180:183], v[60:63], v[100:103]
    buffer_store_dwordx4 v[168:171], v8, s[20:23], s34 offen offset:2048 sc1
    v_mfma_f32_16x16x32_bf16 v[104:107], a[184:187], v[60:63], v[104:107]
    v_exp_f32 v69, v69
    v_mfma_f32_16x16x32_bf16 v[104:107], a[152:155], v[56:59], v[104:107]
    v_cvt_pk_bf16_f32 v49, v66, v67
    v_cvt_pk_bf16_f32 v50, v68, v69
    v_mfma_f32_16x16x32_bf16 v[108:111], a[156:159], v[56:59], v[108:111]
    v_exp_f32 v70, v70
    v_mfma_f32_16x16x32_bf16 v[108:111], a[188:191], v[60:63], v[108:111]
    v_exp_f32 v71, v71
    v_mfma_f32_16x16x32_bf16 v[72:75], a[112:115], a[16:19], -4.0
    v_cvt_pk_bf16_f32 v51, v70, v71
    v_mfma_f32_16x16x32_bf16 v[72:75], a[116:119], a[20:23], v[72:75]
    v_mfma_f32_16x16x32_bf16 v[72:75], a[120:123], a[24:27], v[72:75]
    v_mfma_f32_16x16x32_bf16 v[72:75], a[124:127], a[28:31], v[72:75]
    v_mfma_f32_16x16x32_bf16 v[76:79], a[140:143], a[28:31], -4.0
    v_mfma_f32_16x16x32_bf16 v[76:79], a[136:139], a[24:27], v[76:79]
    v_mfma_f32_16x16x32_bf16 v[76:79], a[132:135], a[20:23], v[76:79]
    v_exp_f32 v72, v72
    v_mfma_f32_16x16x32_bf16 v[76:79], a[128:131], a[16:19], v[76:79]
    v_exp_f32 v73, v73
    v_mfma_f32_16x16x32_bf16 v[112:115], a[192:195], v[60:63], v[112:115]
    v_exp_f32 v74, v74
    v_mfma_f32_16x16x32_bf16 v[112:115], a[160:163], v[56:59], v[112:115]
    v_exp_f32 v75, v75
    v_mfma_f32_16x16x32_bf16 v[116:119], a[164:167], v[56:59], v[116:119]
    v_cvt_pk_bf16_f32 v52, v72, v73
    v_cvt_pk_bf16_f32 v53, v74, v75
    v_mfma_f32_16x16x32_bf16 v[116:119], a[196:199], v[60:63], v[116:119]
    buffer_store_dwordx4 v[180:183], v8, s[20:23], s34 offen offset:128 sc1
    v_mfma_f32_16x16x32_bf16 v[120:123], a[200:203], v[60:63], v[120:123]
    v_exp_f32 v76, v76
    v_mfma_f32_16x16x32_bf16 v[120:123], a[168:171], v[56:59], v[120:123]
    v_exp_f32 v77, v77
    v_mfma_f32_16x16x32_bf16 v[124:127], a[172:175], v[56:59], v[124:127]
    v_exp_f32 v78, v78
    v_mfma_f32_16x16x32_bf16 v[124:127], a[204:207], v[60:63], v[124:127]
    v_exp_f32 v79, v79
    v_mfma_f32_16x16x32_bf16 v[64:67], a[80:83], a[32:35], -4.0
    v_cvt_pk_bf16_f32 v54, v76, v77
    v_cvt_pk_bf16_f32 v55, v78, v79
    v_mfma_f32_16x16x32_bf16 v[64:67], a[84:87], a[36:39], v[64:67]
    ds_read_b128 a[80:83], v4 offset:0
    v_mfma_f32_16x16x32_bf16 v[64:67], a[88:91], a[40:43], v[64:67]
    ds_read_b128 a[84:87], v4 offset:1024
    v_mfma_f32_16x16x32_bf16 v[64:67], a[92:95], a[44:47], v[64:67]
    v_mfma_f32_16x16x32_bf16 v[68:71], a[108:111], a[44:47], -4.0
    v_mfma_f32_16x16x32_bf16 v[68:71], a[104:107], a[40:43], v[68:71]
    ds_read_b128 a[88:91], v4 offset:2048
    v_mfma_f32_16x16x32_bf16 v[68:71], a[100:103], a[36:39], v[68:71]
    v_exp_f32 v64, v64
    v_mfma_f32_16x16x32_bf16 v[68:71], a[96:99], a[32:35], v[68:71]
    v_exp_f32 v65, v65
    v_smfmac_f32_16x16x64_bf16 v[38:41], v[24:27], v[48:55], v9
    ds_read_b128 a[92:95], v4 offset:3072
    v_cvt_pk_bf16_f32 v56, v64, v65
    v_mfma_f32_16x16x32_bf16 v[128:131], a[176:179], v[52:55], v[128:131]
    v_exp_f32 v66, v66
    v_mfma_f32_16x16x32_bf16 v[128:131], a[144:147], v[48:51], v[128:131]
    v_exp_f32 v67, v67
    v_mfma_f32_16x16x32_bf16 v[132:135], a[148:151], v[48:51], v[132:135]
    buffer_store_dwordx4 v[184:187], v8, s[20:23], s34 offen offset:2176 sc1
    v_mfma_f32_16x16x32_bf16 v[132:135], a[180:183], v[52:55], v[132:135]
    s_add_u32 s34, s34, s38
    ds_read_b128 a[108:111], v4 offset:7168
    v_cvt_pk_bf16_f32 v57, v66, v67
    v_mfma_f32_16x16x32_bf16 v[136:139], a[184:187], v[52:55], v[136:139]
    v_exp_f32 v68, v68
    v_mfma_f32_16x16x32_bf16 v[136:139], a[152:155], v[48:51], v[136:139]
    v_exp_f32 v69, v69
    v_mfma_f32_16x16x32_bf16 v[140:143], a[156:159], v[48:51], v[140:143]
    ds_read_b128 a[104:107], v4 offset:6144
    v_cvt_pk_bf16_f32 v58, v68, v69
    v_mfma_f32_16x16x32_bf16 v[140:143], a[188:191], v[52:55], v[140:143]
    v_exp_f32 v70, v70
    v_mfma_f32_16x16x32_bf16 v[72:75], a[112:115], a[32:35], -4.0
    v_exp_f32 v71, v71
    v_mfma_f32_16x16x32_bf16 v[72:75], a[116:119], a[36:39], v[72:75]
    ds_read_b128 a[100:103], v4 offset:5120
    v_cvt_pk_bf16_f32 v59, v70, v71
    v_mfma_f32_16x16x32_bf16 v[72:75], a[120:123], a[40:43], v[72:75]
    ds_read_b128 a[112:115], v4 offset:8192
    v_mfma_f32_16x16x32_bf16 v[72:75], a[124:127], a[44:47], v[72:75]
    ds_read_b128 a[96:99], v4 offset:4096
    v_mfma_f32_16x16x32_bf16 v[76:79], a[140:143], a[44:47], -4.0
    ds_read_b128 a[116:119], v4 offset:9216
    v_mfma_f32_16x16x32_bf16 v[76:79], a[136:139], a[40:43], v[76:79]
    ds_read_b128 a[120:123], v4 offset:10240
    v_mfma_f32_16x16x32_bf16 v[76:79], a[132:135], a[36:39], v[76:79]
    v_exp_f32 v72, v72
    v_mfma_f32_16x16x32_bf16 v[76:79], a[128:131], a[32:35], v[76:79]
    v_exp_f32 v73, v73
    v_mfma_f32_16x16x32_bf16 v[144:147], a[192:195], v[52:55], v[144:147]
    ds_read_b128 a[124:127], v4 offset:11264
    v_cvt_pk_bf16_f32 v60, v72, v73
    v_mfma_f32_16x16x32_bf16 v[144:147], a[160:163], v[48:51], v[144:147]
    v_exp_f32 v74, v74
    v_mfma_f32_16x16x32_bf16 v[148:151], a[164:167], v[48:51], v[148:151]
    v_exp_f32 v75, v75
    v_mfma_f32_16x16x32_bf16 v[148:151], a[196:199], v[52:55], v[148:151]
    ds_read_b128 a[140:143], v4 offset:15360
    v_cvt_pk_bf16_f32 v61, v74, v75
    v_mfma_f32_16x16x32_bf16 v[152:155], a[200:203], v[52:55], v[152:155]
    v_exp_f32 v76, v76
    v_mfma_f32_16x16x32_bf16 v[152:155], a[168:171], v[48:51], v[152:155]
    v_exp_f32 v77, v77
    v_mfma_f32_16x16x32_bf16 v[156:159], a[172:175], v[48:51], v[156:159]
    ds_read_b128 a[136:139], v4 offset:14336
    v_cvt_pk_bf16_f32 v62, v76, v77
    v_mfma_f32_16x16x32_bf16 v[156:159], a[204:207], v[52:55], v[156:159]
    s_waitcnt lgkmcnt(3)
    v_exp_f32 v78, v78
    v_mfma_f32_16x16x32_bf16 v[64:67], a[80:83], a[48:51], -4.0
    v_exp_f32 v79, v79
    v_mfma_f32_16x16x32_bf16 v[64:67], a[84:87], a[52:55], v[64:67]
    ds_read_b128 a[132:135], v4 offset:13312
    v_cvt_pk_bf16_f32 v63, v78, v79
    v_mfma_f32_16x16x32_bf16 v[64:67], a[88:91], a[56:59], v[64:67]
    v_mfma_f32_16x16x32_bf16 v[64:67], a[92:95], a[60:63], v[64:67]
    v_mfma_f32_16x16x32_bf16 v[68:71], a[108:111], a[60:63], -4.0
    ds_read_b128 a[128:131], v4 offset:12288
    v_mfma_f32_16x16x32_bf16 v[68:71], a[104:107], a[56:59], v[68:71]
    v_mfma_f32_16x16x32_bf16 v[68:71], a[100:103], a[52:55], v[68:71]
    v_exp_f32 v64, v64
    v_mfma_f32_16x16x32_bf16 v[68:71], a[96:99], a[48:51], v[68:71]
    s_waitcnt vmcnt(12)
    v_exp_f32 v65, v65
    v_smfmac_f32_16x16x64_bf16 v[40:43], v[24:27], v[56:63], v9
    s_barrier
    v_mfma_f32_16x16x32_bf16 v[160:163], a[176:179], v[60:63], v[32:35]
    v_exp_f32 v66, v66
    v_mfma_f32_16x16x32_bf16 v[160:163], a[144:147], v[56:59], v[160:163]
    ds_read_b64_tr_b16 a[176:177], v5 offset:8192
    v_cvt_pk_bf16_f32 v48, v64, v65
    v_mfma_f32_16x16x32_bf16 v[164:167], a[148:151], v[56:59], v[32:35]
    v_exp_f32 v67, v67
    v_mfma_f32_16x16x32_bf16 v[164:167], a[180:183], v[60:63], v[164:167]
    ds_read_b64_tr_b16 a[178:179], v5 offset:12288
    v_cvt_pk_bf16_f32 v49, v66, v67
    v_mfma_f32_16x16x32_bf16 v[168:171], a[184:187], v[60:63], v[32:35]
    v_exp_f32 v68, v68
    v_mfma_f32_16x16x32_bf16 v[168:171], a[152:155], v[56:59], v[168:171]
    v_exp_f32 v69, v69
    v_mfma_f32_16x16x32_bf16 v[172:175], a[156:159], v[56:59], v[32:35]
    ds_read_b64_tr_b16 a[144:145], v5 offset:0
    v_cvt_pk_bf16_f32 v50, v68, v69
    v_mfma_f32_16x16x32_bf16 v[172:175], a[188:191], v[60:63], v[172:175]
    v_exp_f32 v70, v70
    v_mfma_f32_16x16x32_bf16 v[72:75], a[112:115], a[48:51], -4.0
    v_exp_f32 v71, v71
    v_mfma_f32_16x16x32_bf16 v[72:75], a[116:119], a[52:55], v[72:75]
    ds_read_b64_tr_b16 a[146:147], v5 offset:4096
    v_cvt_pk_bf16_f32 v51, v70, v71
    v_mfma_f32_16x16x32_bf16 v[72:75], a[120:123], a[56:59], v[72:75]
    s_waitcnt lgkmcnt(3)
    ds_read_b64_tr_b16 a[148:149], v5 offset:8
    v_mfma_f32_16x16x32_bf16 v[72:75], a[124:127], a[60:63], v[72:75]
    ds_read_b64_tr_b16 a[150:151], v5 offset:4104
    v_mfma_f32_16x16x32_bf16 v[76:79], a[140:143], a[60:63], -4.0
    ds_read_b64_tr_b16 a[180:181], v5 offset:8200
    ds_read_b64_tr_b16 a[182:183], v5 offset:12296
    v_mfma_f32_16x16x32_bf16 v[76:79], a[136:139], a[56:59], v[76:79]
    ds_read_b64_tr_b16 a[184:185], v5 offset:8448
    ds_read_b64_tr_b16 a[186:187], v5 offset:12544
    v_mfma_f32_16x16x32_bf16 v[76:79], a[132:135], a[52:55], v[76:79]
    v_exp_f32 v72, v72
    v_mfma_f32_16x16x32_bf16 v[76:79], a[128:131], a[48:51], v[76:79]
    ds_read_b64_tr_b16 a[152:153], v5 offset:256
    ds_read_b64_tr_b16 a[154:155], v5 offset:4352
    v_mfma_f32_16x16x32_bf16 v[176:179], a[192:195], v[60:63], v[32:35]
    v_exp_f32 v73, v73
    v_mfma_f32_16x16x32_bf16 v[176:179], a[160:163], v[56:59], v[176:179]
    ds_read_b64_tr_b16 a[156:157], v5 offset:264
    v_cvt_pk_bf16_f32 v52, v72, v73
    v_mfma_f32_16x16x32_bf16 v[180:183], a[164:167], v[56:59], v[32:35]
    v_exp_f32 v74, v74
    v_mfma_f32_16x16x32_bf16 v[180:183], a[196:199], v[60:63], v[180:183]
    ds_read_b64_tr_b16 a[158:159], v5 offset:4360
    ds_read_b64_tr_b16 a[188:189], v5 offset:8456
    v_mfma_f32_16x16x32_bf16 v[184:187], a[200:203], v[60:63], v[32:35]
    v_exp_f32 v75, v75
    v_mfma_f32_16x16x32_bf16 v[184:187], a[168:171], v[56:59], v[184:187]
    ds_read_b64_tr_b16 a[190:191], v5 offset:12552
    v_cvt_pk_bf16_f32 v53, v74, v75
    v_mfma_f32_16x16x32_bf16 v[188:191], a[172:175], v[56:59], v[32:35]
    v_exp_f32 v76, v76
    v_mfma_f32_16x16x32_bf16 v[188:191], a[204:207], v[60:63], v[188:191]
    v_exp_f32 v77, v77
    v_mfma_f32_16x16x32_bf16 v[64:67], a[80:83], a[64:67], -4.0
    ds_read_b64_tr_b16 a[192:193], v5 offset:8704
    v_cvt_pk_bf16_f32 v54, v76, v77
    v_mfma_f32_16x16x32_bf16 v[64:67], a[84:87], a[68:71], v[64:67]
    v_exp_f32 v78, v78
    v_mfma_f32_16x16x32_bf16 v[64:67], a[88:91], a[72:75], v[64:67]
    ds_read_b64_tr_b16 a[194:195], v5 offset:12800
    ds_read_b64_tr_b16 a[160:161], v5 offset:512
    v_mfma_f32_16x16x32_bf16 v[64:67], a[92:95], a[76:79], v[64:67]
    v_exp_f32 v79, v79
    v_mfma_f32_16x16x32_bf16 v[68:71], a[108:111], a[76:79], -4.0
    ds_read_b64_tr_b16 a[162:163], v5 offset:4608
    v_cvt_pk_bf16_f32 v55, v78, v79
    v_mfma_f32_16x16x32_bf16 v[68:71], a[104:107], a[72:75], v[68:71]
    ds_read_b64_tr_b16 a[164:165], v5 offset:520
    ds_read_b64_tr_b16 a[166:167], v5 offset:4616
    v_mfma_f32_16x16x32_bf16 v[68:71], a[100:103], a[68:71], v[68:71]
    v_exp_f32 v64, v64
    v_mfma_f32_16x16x32_bf16 v[68:71], a[96:99], a[64:67], v[68:71]
    ds_read_b64_tr_b16 a[196:197], v5 offset:8712
    ds_read_b64_tr_b16 a[198:199], v5 offset:12808
    v_smfmac_f32_16x16x64_bf16 v[42:45], v[24:27], v[48:55], v9
    s_waitcnt lgkmcnt(7)
    ds_read_b64_tr_b16 a[200:201], v5 offset:8960
    ds_read_b64_tr_b16 a[202:203], v5 offset:13056
    v_mfma_f32_16x16x32_bf16 v[192:195], a[176:179], v[52:55], v[192:195]
    v_exp_f32 v65, v65
    v_mfma_f32_16x16x32_bf16 v[192:195], a[144:147], v[48:51], v[192:195]
    ds_read_b64_tr_b16 a[168:169], v5 offset:768
    ds_read_b64_tr_b16 a[170:171], v5 offset:4864
    v_mfma_f32_16x16x32_bf16 v[196:199], a[148:151], v[48:51], v[196:199]
    v_exp_f32 v66, v66
    v_mfma_f32_16x16x32_bf16 v[196:199], a[180:183], v[52:55], v[196:199]
    ds_read_b64_tr_b16 a[172:173], v5 offset:776
    ds_read_b64_tr_b16 a[174:175], v5 offset:4872
    v_mfma_f32_16x16x32_bf16 v[200:203], a[184:187], v[52:55], v[200:203]
    v_exp_f32 v67, v67
    v_mfma_f32_16x16x32_bf16 v[200:203], a[152:155], v[48:51], v[200:203]
    ds_read_b64_tr_b16 a[204:205], v5 offset:8968
    ds_read_b64_tr_b16 a[206:207], v5 offset:13064
    v_mfma_f32_16x16x32_bf16 v[204:207], a[156:159], v[48:51], v[204:207]
    v_exp_f32 v68, v68
    v_mfma_f32_16x16x32_bf16 v[204:207], a[188:191], v[52:55], v[204:207]
    v_cvt_pk_bf16_f32 v56, v64, v65
    v_cvt_pk_bf16_f32 v57, v66, v67
    v_mfma_f32_16x16x32_bf16 v[72:75], a[112:115], a[64:67], -4.0
    v_exp_f32 v69, v69
    v_mfma_f32_16x16x32_bf16 v[72:75], a[116:119], a[68:71], v[72:75]
    v_cvt_pk_bf16_f32 v58, v68, v69
    v_add_f32 v28, v42, v43
    v_mfma_f32_16x16x32_bf16 v[72:75], a[120:123], a[72:75], v[72:75]
    v_exp_f32 v70, v70
    v_mfma_f32_16x16x32_bf16 v[72:75], a[124:127], a[76:79], v[72:75]
    v_exp_f32 v71, v71
    v_mfma_f32_16x16x32_bf16 v[76:79], a[140:143], a[76:79], -4.0
    v_cvt_pk_bf16_f32 v59, v70, v71
    v_mov_b64 v[42:43], 0
    v_mfma_f32_16x16x32_bf16 v[76:79], a[136:139], a[72:75], v[76:79]
    v_rcp_f32 v12, v28
    v_mfma_f32_16x16x32_bf16 v[76:79], a[132:135], a[68:71], v[76:79]
    v_mul_f32_e64 v30, -v32, v12
    v_subrev_u32 v28, s30, v28
    v_mfma_f32_16x16x32_bf16 v[76:79], a[128:131], a[64:67], v[76:79]
    s_waitcnt lgkmcnt(0)
    v_exp_f32 v72, v72
    v_mfma_f32_16x16x32_bf16 v[208:211], a[192:195], v[52:55], v[208:211]
    v_fma_f32 v192, v192, v12, v30
    v_fma_f32 v193, v193, v12, v30
    v_mfma_f32_16x16x32_bf16 v[208:211], a[160:163], v[48:51], v[208:211]
    v_exp_f32 v73, v73
    v_mfma_f32_16x16x32_bf16 v[212:215], a[164:167], v[48:51], v[212:215]
    v_fma_f32 v194, v194, v12, v30
    v_cvt_pk_bf16_f32 v60, v72, v73
    v_mfma_f32_16x16x32_bf16 v[212:215], a[196:199], v[52:55], v[212:215]
    v_exp_f32 v74, v74
    v_mfma_f32_16x16x32_bf16 v[216:219], a[200:203], v[52:55], v[216:219]
    v_fma_f32 v195, v195, v12, v30
    v_fma_f32 v196, v196, v12, v30
    v_mfma_f32_16x16x32_bf16 v[216:219], a[168:171], v[48:51], v[216:219]
    v_exp_f32 v75, v75
    v_mfma_f32_16x16x32_bf16 v[220:223], a[172:175], v[48:51], v[220:223]
    v_fma_f32 v197, v197, v12, v30
    v_cvt_pk_bf16_f32 v61, v74, v75
    v_mfma_f32_16x16x32_bf16 v[220:223], a[204:207], v[52:55], v[220:223]
    s_barrier
    v_mfma_f32_16x16x32_bf16 v[64:67], a[80:83], a[0:3], -4.0
    s_mov_b32 s35, 0x18000
    v_exp_f32 v76, v76
    v_mfma_f32_16x16x32_bf16 v[64:67], a[84:87], a[4:7], v[64:67]
    s_waitcnt vmcnt(8)
    ds_read_b128 a[48:51], v15 offset:0
    v_fma_f32 v198, v198, v12, v30
    v_mfma_f32_16x16x32_bf16 v[64:67], a[88:91], a[8:11], v[64:67]
    s_mov_b32 m0, s48
    v_exp_f32 v77, v77
    v_mfma_f32_16x16x32_bf16 v[64:67], a[92:95], a[12:15], v[64:67]
    v_exp_f32 v78, v78
    v_mfma_f32_16x16x32_bf16 v[68:71], a[108:111], a[12:15], -4.0
    v_exp_f32 v79, v79
    v_mfma_f32_16x16x32_bf16 v[68:71], a[104:107], a[8:11], v[68:71]
    buffer_load_dwordx4 v2, s[16:19], s35 offen offset:0 lds
    v_mfma_f32_16x16x32_bf16 v[68:71], a[100:103], a[4:7], v[68:71]
    v_cvt_pk_bf16_f32 v62, v76, v77
    v_cvt_pk_bf16_f32 v63, v78, v79
    v_mfma_f32_16x16x32_bf16 v[68:71], a[96:99], a[0:3], v[68:71]
    ds_read_b128 a[52:55], v15 offset:256
    ds_read_b128 a[56:59], v15 offset:512
    v_smfmac_f32_16x16x64_bf16 v[44:47], v[24:27], v[56:63], v9
    v_fma_f32 v199, v199, v12, v30
    v_mfma_f32_16x16x32_bf16 v[224:227], a[176:179], v[60:63], v[224:227]
    buffer_load_dwordx4 v2, s[16:19], s35 offen offset:1024 lds
    v_mfma_f32_16x16x32_bf16 v[224:227], a[144:147], v[56:59], v[224:227]
    s_mov_b32 m0, s49
    v_exp_f32 v64, v64
    v_mfma_f32_16x16x32_bf16 v[228:231], a[148:151], v[56:59], v[228:231]
    s_mov_b32 s35, 0x1a000
    ds_read_b128 a[60:63], v15 offset:768
    v_max3_f32 v14, abs(v192), abs(v193), abs(v194)
    v_mfma_f32_16x16x32_bf16 v[228:231], a[180:183], v[60:63], v[228:231]
    v_exp_f32 v65, v65
    v_mfma_f32_16x16x32_bf16 v[232:235], a[184:187], v[60:63], v[232:235]
    buffer_load_dwordx4 v2, s[16:19], s35 offen offset:0 lds
    v_mfma_f32_16x16x32_bf16 v[232:235], a[152:155], v[56:59], v[232:235]
    v_exp_f32 v66, v66
    v_mfma_f32_16x16x32_bf16 v[236:239], a[156:159], v[56:59], v[236:239]
    v_fma_f32 v200, v200, v12, v30
    v_cvt_pk_bf16_f32 v48, v64, v65
    v_mfma_f32_16x16x32_bf16 v[236:239], a[188:191], v[60:63], v[236:239]
    v_exp_f32 v67, v67
    v_mfma_f32_16x16x32_bf16 v[72:75], a[112:115], a[0:3], -4.0
    buffer_load_dwordx4 v2, s[16:19], s35 offen offset:1024 lds
    v_mfma_f32_16x16x32_bf16 v[72:75], a[116:119], a[4:7], v[72:75]
    v_exp_f32 v68, v68
    v_mfma_f32_16x16x32_bf16 v[72:75], a[120:123], a[8:11], v[72:75]
    v_fma_f32 v201, v201, v12, v30
    v_cvt_pk_bf16_f32 v49, v66, v67
    v_mfma_f32_16x16x32_bf16 v[72:75], a[124:127], a[12:15], v[72:75]
    s_mov_b32 m0, s26
    v_exp_f32 v69, v69
    v_mfma_f32_16x16x32_bf16 v[76:79], a[140:143], a[12:15], -4.0
    v_fma_f32 v202, v202, v12, v30
    v_cvt_pk_bf16_f32 v50, v68, v69
    v_mfma_f32_16x16x32_bf16 v[76:79], a[136:139], a[8:11], v[76:79]
    v_exp_f32 v70, v70
    v_mfma_f32_16x16x32_bf16 v[76:79], a[132:135], a[4:7], v[76:79]
    s_waitcnt lgkmcnt(0)
    buffer_load_dwordx4 v2, s[8:11], s33 offen offset:0 nt lds
    v_mfma_f32_16x16x32_bf16 v[76:79], a[128:131], a[0:3], v[76:79]
    v_exp_f32 v71, v71
    v_mfma_f32_16x16x32_bf16 v[240:243], a[192:195], v[60:63], v[240:243]
    v_fma_f32 v203, v203, v12, v30
    v_cvt_pk_bf16_f32 v51, v70, v71
    v_mfma_f32_16x16x32_bf16 v[240:243], a[160:163], v[56:59], v[240:243]
    v_exp_f32 v72, v72
    v_mfma_f32_16x16x32_bf16 v[244:247], a[164:167], v[56:59], v[244:247]
    buffer_load_dwordx4 v2, s[8:11], s33 offen offset:1024 nt lds
    v_mfma_f32_16x16x32_bf16 v[244:247], a[196:199], v[60:63], v[244:247]
    v_exp_f32 v73, v73
    v_mfma_f32_16x16x32_bf16 v[248:251], a[200:203], v[60:63], v[248:251]
    v_fma_f32 v204, v204, v12, v30
    v_cvt_pk_bf16_f32 v52, v72, v73
    v_mfma_f32_16x16x32_bf16 v[248:251], a[168:171], v[56:59], v[248:251]
    v_exp_f32 v74, v74
    v_mfma_f32_16x16x32_bf16 v[252:255], a[172:175], v[56:59], v[252:255]
    buffer_load_dwordx4 v2, s[8:11], s33 offen offset:2048 nt lds
    v_mfma_f32_16x16x32_bf16 v[252:255], a[204:207], v[60:63], v[252:255]
    v_exp_f32 v75, v75
    v_mfma_f32_16x16x32_bf16 v[64:67], a[80:83], a[16:19], -4.0
    v_fma_f32 v205, v205, v12, v30
    v_cvt_pk_bf16_f32 v53, v74, v75
    v_mfma_f32_16x16x32_bf16 v[64:67], a[84:87], a[20:23], v[64:67]
    v_exp_f32 v76, v76
    v_mfma_f32_16x16x32_bf16 v[64:67], a[88:91], a[24:27], v[64:67]
    buffer_load_dwordx4 v2, s[8:11], s33 offen offset:3072 nt lds
    v_mfma_f32_16x16x32_bf16 v[64:67], a[92:95], a[28:31], v[64:67]
    s_add_u32 s33, s33, s38
    v_exp_f32 v77, v77
    v_mfma_f32_16x16x32_bf16 v[68:71], a[108:111], a[28:31], -4.0
    v_exp_f32 v78, v78
    v_mfma_f32_16x16x32_bf16 v[68:71], a[104:107], a[24:27], v[68:71]
    v_exp_f32 v79, v79
    v_mfma_f32_16x16x32_bf16 v[68:71], a[100:103], a[20:23], v[68:71]
    v_cvt_pk_bf16_f32 v54, v76, v77
    v_cvt_pk_bf16_f32 v55, v78, v79
    v_mfma_f32_16x16x32_bf16 v[68:71], a[96:99], a[16:19], v[68:71]
    v_exp_f32 v64, v64
    v_smfmac_f32_16x16x64_bf16 v[36:39], v[24:27], v[48:55], v9
    v_fma_f32 v206, v206, v12, v30
    v_mfma_f32_16x16x32_bf16 v[96:99], a[176:179], v[52:55], v[96:99]
    v_exp_f32 v65, v65
    v_mfma_f32_16x16x32_bf16 v[96:99], a[144:147], v[48:51], v[96:99]
    v_fma_f32 v207, v207, v12, v30
    v_cvt_pk_bf16_f32 v56, v64, v65
    v_mfma_f32_16x16x32_bf16 v[100:103], a[148:151], v[48:51], v[100:103]
    v_exp_f32 v66, v66
    v_mfma_f32_16x16x32_bf16 v[100:103], a[180:183], v[52:55], v[100:103]
    v_max3_f32 v14, v14, abs(v195), abs(v196)
    v_cvt_pk_bf16_f32 v192, v192, v193
    v_mfma_f32_16x16x32_bf16 v[104:107], a[184:187], v[52:55], v[104:107]
    v_exp_f32 v67, v67
    v_mfma_f32_16x16x32_bf16 v[104:107], a[152:155], v[48:51], v[104:107]
    v_cvt_pk_bf16_f32 v193, v194, v195
    v_cvt_pk_bf16_f32 v57, v66, v67
    v_mfma_f32_16x16x32_bf16 v[108:111], a[156:159], v[48:51], v[108:111]
    v_exp_f32 v68, v68
    v_mfma_f32_16x16x32_bf16 v[108:111], a[188:191], v[52:55], v[108:111]
    v_cvt_pk_bf16_f32 v194, v196, v197
    v_cvt_pk_bf16_f32 v195, v198, v199
    v_mfma_f32_16x16x32_bf16 v[72:75], a[112:115], a[16:19], -4.0
    v_exp_f32 v69, v69
    v_mfma_f32_16x16x32_bf16 v[72:75], a[116:119], a[20:23], v[72:75]
    v_cvt_pk_bf16_f32 v200, v200, v201
    v_cvt_pk_bf16_f32 v58, v68, v69
    v_mfma_f32_16x16x32_bf16 v[72:75], a[120:123], a[24:27], v[72:75]
    v_exp_f32 v70, v70
    v_mfma_f32_16x16x32_bf16 v[72:75], a[124:127], a[28:31], v[72:75]
    v_cvt_pk_bf16_f32 v201, v202, v203
    v_cndmask_b32_dpp v196, v200, v192, vcc row_ror:8 row_mask:0xf bank_mask:0xf
    v_mfma_f32_16x16x32_bf16 v[76:79], a[140:143], a[28:31], -4.0
    v_exp_f32 v71, v71
    v_mfma_f32_16x16x32_bf16 v[76:79], a[136:139], a[24:27], v[76:79]
    v_cvt_pk_bf16_f32 v202, v204, v205
    v_cvt_pk_bf16_f32 v59, v70, v71
    v_mfma_f32_16x16x32_bf16 v[76:79], a[132:135], a[20:23], v[76:79]
    v_exp_f32 v72, v72
    v_mfma_f32_16x16x32_bf16 v[76:79], a[128:131], a[16:19], v[76:79]
    v_cvt_pk_bf16_f32 v203, v206, v207
    v_cndmask_b32_dpp v197, v201, v193, vcc row_ror:8 row_mask:0xf bank_mask:0xf
    v_mfma_f32_16x16x32_bf16 v[112:115], a[192:195], v[52:55], v[112:115]
    v_exp_f32 v73, v73
    v_mfma_f32_16x16x32_bf16 v[112:115], a[160:163], v[48:51], v[112:115]
    v_cndmask_b32_dpp v198, v202, v194, vcc row_ror:8 row_mask:0xf bank_mask:0xf
    v_cvt_pk_bf16_f32 v60, v72, v73
    v_mfma_f32_16x16x32_bf16 v[116:119], a[164:167], v[48:51], v[116:119]
    v_exp_f32 v74, v74
    v_mfma_f32_16x16x32_bf16 v[116:119], a[196:199], v[52:55], v[116:119]
    v_fma_f32 v14, v14, s42, v30
    v_cndmask_b32_dpp v199, v203, v195, vcc row_ror:8 row_mask:0xf bank_mask:0xf
    v_mfma_f32_16x16x32_bf16 v[120:123], a[200:203], v[52:55], v[120:123]
    v_exp_f32 v75, v75
    v_mfma_f32_16x16x32_bf16 v[120:123], a[168:171], v[48:51], v[120:123]
    v_and_or_b32 v14, v14, s43, v28
    v_cvt_pk_bf16_f32 v61, v74, v75
    v_mfma_f32_16x16x32_bf16 v[124:127], a[172:175], v[48:51], v[124:127]
    v_exp_f32 v76, v76
    v_mfma_f32_16x16x32_bf16 v[124:127], a[204:207], v[52:55], v[124:127]
    v_cmp_lt_u32_e64 s[4:5], s31, v14
    v_mov_b32_dpp v200, v192 row_ror:8 row_mask:0xf bank_mask:0x3
    v_mfma_f32_16x16x32_bf16 v[64:67], a[80:83], a[32:35], -4.0
    v_exp_f32 v77, v77
    v_mfma_f32_16x16x32_bf16 v[64:67], a[84:87], a[36:39], v[64:67]
    ds_read_b128 a[80:83], v4 offset:16384
    v_cvt_pk_bf16_f32 v62, v76, v77
    v_mfma_f32_16x16x32_bf16 v[64:67], a[88:91], a[40:43], v[64:67]
    v_exp_f32 v78, v78
    v_mfma_f32_16x16x32_bf16 v[64:67], a[92:95], a[44:47], v[64:67]
    ds_read_b128 a[84:87], v4 offset:17408
    v_mov_b32_dpp v201, v193 row_ror:8 row_mask:0xf bank_mask:0x3
    v_mfma_f32_16x16x32_bf16 v[68:71], a[108:111], a[44:47], -4.0
    v_exp_f32 v79, v79
    v_mfma_f32_16x16x32_bf16 v[68:71], a[104:107], a[40:43], v[68:71]
    ds_read_b128 a[88:91], v4 offset:18432
    v_cvt_pk_bf16_f32 v63, v78, v79
    v_mfma_f32_16x16x32_bf16 v[68:71], a[100:103], a[36:39], v[68:71]
    v_exp_f32 v64, v64
    v_mfma_f32_16x16x32_bf16 v[68:71], a[96:99], a[32:35], v[68:71]
    v_mov_b32_dpp v202, v194 row_ror:8 row_mask:0xf bank_mask:0x3
    v_mov_b32_dpp v203, v195 row_ror:8 row_mask:0xf bank_mask:0x3
    v_smfmac_f32_16x16x64_bf16 v[38:41], v[24:27], v[56:63], v9
    ds_read_b128 a[92:95], v4 offset:19456
    v_fma_f32 v208, v208, v12, v30
    v_mfma_f32_16x16x32_bf16 v[128:131], a[176:179], v[60:63], v[128:131]
    v_exp_f32 v65, v65
    v_mfma_f32_16x16x32_bf16 v[128:131], a[144:147], v[56:59], v[128:131]
    v_fma_f32 v209, v209, v12, v30
    v_cvt_pk_bf16_f32 v48, v64, v65
    v_mfma_f32_16x16x32_bf16 v[132:135], a[148:151], v[56:59], v[132:135]
    v_exp_f32 v66, v66
    v_mfma_f32_16x16x32_bf16 v[132:135], a[180:183], v[60:63], v[132:135]
    ds_read_b128 a[108:111], v4 offset:23552
    v_fma_f32 v210, v210, v12, v30
    v_mfma_f32_16x16x32_bf16 v[136:139], a[184:187], v[60:63], v[136:139]
    v_exp_f32 v67, v67
    v_mfma_f32_16x16x32_bf16 v[136:139], a[152:155], v[56:59], v[136:139]
    ds_read_b128 a[104:107], v4 offset:22528
    v_cvt_pk_bf16_f32 v49, v66, v67
    v_mfma_f32_16x16x32_bf16 v[140:143], a[156:159], v[56:59], v[140:143]
    v_exp_f32 v68, v68
    v_mfma_f32_16x16x32_bf16 v[140:143], a[188:191], v[60:63], v[140:143]
    v_fma_f32 v211, v211, v12, v30
    v_fma_f32 v212, v212, v12, v30
    v_mfma_f32_16x16x32_bf16 v[72:75], a[112:115], a[32:35], -4.0
    v_exp_f32 v69, v69
    v_mfma_f32_16x16x32_bf16 v[72:75], a[116:119], a[36:39], v[72:75]
    ds_read_b128 a[100:103], v4 offset:21504
    v_cvt_pk_bf16_f32 v50, v68, v69
    v_mfma_f32_16x16x32_bf16 v[72:75], a[120:123], a[40:43], v[72:75]
    v_exp_f32 v70, v70
    v_mfma_f32_16x16x32_bf16 v[72:75], a[124:127], a[44:47], v[72:75]
    ds_read_b128 a[96:99], v4 offset:20480
    v_fma_f32 v213, v213, v12, v30
    v_mfma_f32_16x16x32_bf16 v[76:79], a[140:143], a[44:47], -4.0
    v_exp_f32 v71, v71
    v_mfma_f32_16x16x32_bf16 v[76:79], a[136:139], a[40:43], v[76:79]
    ds_read_b128 a[112:115], v4 offset:24576
    v_cvt_pk_bf16_f32 v51, v70, v71
    v_mfma_f32_16x16x32_bf16 v[76:79], a[132:135], a[36:39], v[76:79]
    v_exp_f32 v72, v72
    v_mfma_f32_16x16x32_bf16 v[76:79], a[128:131], a[32:35], v[76:79]
    ds_read_b128 a[116:119], v4 offset:25600
    v_fma_f32 v214, v214, v12, v30
    v_mfma_f32_16x16x32_bf16 v[144:147], a[192:195], v[60:63], v[144:147]
    v_exp_f32 v73, v73
    v_mfma_f32_16x16x32_bf16 v[144:147], a[160:163], v[56:59], v[144:147]
    ds_read_b128 a[120:123], v4 offset:26624
    v_cvt_pk_bf16_f32 v52, v72, v73
    v_mfma_f32_16x16x32_bf16 v[148:151], a[164:167], v[56:59], v[148:151]
    v_exp_f32 v74, v74
    v_mfma_f32_16x16x32_bf16 v[148:151], a[196:199], v[60:63], v[148:151]
    ds_read_b128 a[124:127], v4 offset:27648
    v_fma_f32 v215, v215, v12, v30
    v_mfma_f32_16x16x32_bf16 v[152:155], a[200:203], v[60:63], v[152:155]
    v_exp_f32 v75, v75
    v_mfma_f32_16x16x32_bf16 v[152:155], a[168:171], v[56:59], v[152:155]
    ds_read_b128 a[140:143], v4 offset:31744
    v_cvt_pk_bf16_f32 v53, v74, v75
    v_mfma_f32_16x16x32_bf16 v[156:159], a[172:175], v[56:59], v[156:159]
    v_exp_f32 v76, v76
    v_mfma_f32_16x16x32_bf16 v[156:159], a[204:207], v[60:63], v[156:159]
    s_waitcnt lgkmcnt(3)
    ds_read_b128 a[136:139], v4 offset:30720
    v_fma_f32 v216, v216, v12, v30
    v_mfma_f32_16x16x32_bf16 v[64:67], a[80:83], a[64:67], -4.0
    v_exp_f32 v77, v77
    v_mfma_f32_16x16x32_bf16 v[64:67], a[84:87], a[68:71], v[64:67]
    ds_read_b128 a[132:135], v4 offset:29696
    v_cvt_pk_bf16_f32 v54, v76, v77
    v_mfma_f32_16x16x32_bf16 v[64:67], a[88:91], a[72:75], v[64:67]
    v_exp_f32 v78, v78
    v_mfma_f32_16x16x32_bf16 v[64:67], a[92:95], a[76:79], v[64:67]
    v_fma_f32 v217, v217, v12, v30
    v_fma_f32 v218, v218, v12, v30
    v_mfma_f32_16x16x32_bf16 v[68:71], a[108:111], a[76:79], -4.0
    v_exp_f32 v79, v79
    v_mfma_f32_16x16x32_bf16 v[68:71], a[104:107], a[72:75], v[68:71]
    ds_read_b128 a[128:131], v4 offset:28672
    v_cvt_pk_bf16_f32 v55, v78, v79
    v_mfma_f32_16x16x32_bf16 v[68:71], a[100:103], a[68:71], v[68:71]
    v_exp_f32 v64, v64
    v_mfma_f32_16x16x32_bf16 v[68:71], a[96:99], a[64:67], v[68:71]
    s_waitcnt vmcnt(12)
    v_fma_f32 v219, v219, v12, v30
    v_fma_f32 v220, v220, v12, v30
    v_smfmac_f32_16x16x64_bf16 v[40:43], v[24:27], v[48:55], v9
    s_barrier
    v_mfma_f32_16x16x32_bf16 v[160:163], a[176:179], v[52:55], v[160:163]
L_st7:
    s_cbranch_execz L_st8
    v_exp_f32 v65, v65
    v_mfma_f32_16x16x32_bf16 v[160:163], a[144:147], v[48:51], v[160:163]
    ds_read_b64_tr_b16 a[176:177], v5 offset:24576
    v_cvt_pk_bf16_f32 v56, v64, v65
    v_mfma_f32_16x16x32_bf16 v[164:167], a[148:151], v[48:51], v[164:167]
    v_exp_f32 v66, v66
    v_mfma_f32_16x16x32_bf16 v[164:167], a[180:183], v[52:55], v[164:167]
    ds_read_b64_tr_b16 a[178:179], v5 offset:28672
    v_fma_f32 v221, v221, v12, v30
    v_mfma_f32_16x16x32_bf16 v[168:171], a[184:187], v[52:55], v[168:171]
    v_exp_f32 v67, v67
    v_mfma_f32_16x16x32_bf16 v[168:171], a[152:155], v[48:51], v[168:171]
    ds_read_b64_tr_b16 a[144:145], v5 offset:16384
    v_cvt_pk_bf16_f32 v57, v66, v67
    v_mfma_f32_16x16x32_bf16 v[172:175], a[156:159], v[48:51], v[172:175]
    v_exp_f32 v68, v68
    v_mfma_f32_16x16x32_bf16 v[172:175], a[188:191], v[52:55], v[172:175]
    ds_read_b64_tr_b16 a[146:147], v5 offset:20480
    v_fma_f32 v222, v222, v12, v30
    v_mfma_f32_16x16x32_bf16 v[72:75], a[112:115], a[64:67], -4.0
    v_exp_f32 v69, v69
    v_mfma_f32_16x16x32_bf16 v[72:75], a[116:119], a[68:71], v[72:75]
    s_waitcnt lgkmcnt(3)
    ds_read_b64_tr_b16 a[148:149], v5 offset:16392
    v_cvt_pk_bf16_f32 v58, v68, v69
    v_mfma_f32_16x16x32_bf16 v[72:75], a[120:123], a[72:75], v[72:75]
    v_exp_f32 v70, v70
    v_mfma_f32_16x16x32_bf16 v[72:75], a[124:127], a[76:79], v[72:75]
    ds_read_b64_tr_b16 a[150:151], v5 offset:20488
    v_fma_f32 v223, v223, v12, v30
    v_mfma_f32_16x16x32_bf16 v[76:79], a[140:143], a[76:79], -4.0
    v_exp_f32 v71, v71
    v_mfma_f32_16x16x32_bf16 v[76:79], a[136:139], a[72:75], v[76:79]
    ds_read_b64_tr_b16 a[180:181], v5 offset:24584
    v_cvt_pk_bf16_f32 v59, v70, v71
    v_mfma_f32_16x16x32_bf16 v[76:79], a[132:135], a[68:71], v[76:79]
    v_exp_f32 v72, v72
    v_mfma_f32_16x16x32_bf16 v[76:79], a[128:131], a[64:67], v[76:79]
    ds_read_b64_tr_b16 a[182:183], v5 offset:28680
    ds_read_b64_tr_b16 a[184:185], v5 offset:24832
    v_mfma_f32_16x16x32_bf16 v[176:179], a[192:195], v[52:55], v[176:179]
    v_exp_f32 v73, v73
    v_mfma_f32_16x16x32_bf16 v[176:179], a[160:163], v[48:51], v[176:179]
    ds_read_b64_tr_b16 a[186:187], v5 offset:28928
    v_cvt_pk_bf16_f32 v60, v72, v73
    v_mfma_f32_16x16x32_bf16 v[180:183], a[164:167], v[48:51], v[180:183]
    v_exp_f32 v74, v74
    v_mfma_f32_16x16x32_bf16 v[180:183], a[196:199], v[52:55], v[180:183]
    ds_read_b64_tr_b16 a[152:153], v5 offset:16640
    ds_read_b64_tr_b16 a[154:155], v5 offset:20736
    v_mfma_f32_16x16x32_bf16 v[184:187], a[200:203], v[52:55], v[184:187]
    v_exp_f32 v75, v75
    v_mfma_f32_16x16x32_bf16 v[184:187], a[168:171], v[48:51], v[184:187]
    ds_read_b64_tr_b16 a[156:157], v5 offset:16648
    v_cvt_pk_bf16_f32 v61, v74, v75
    v_mfma_f32_16x16x32_bf16 v[188:191], a[172:175], v[48:51], v[188:191]
    v_exp_f32 v76, v76
    v_mfma_f32_16x16x32_bf16 v[188:191], a[204:207], v[52:55], v[188:191]
    ds_read_b64_tr_b16 a[158:159], v5 offset:20744
    ds_read_b64_tr_b16 a[188:189], v5 offset:24840
    v_mfma_f32_16x16x32_bf16 v[64:67], a[80:83], a[0:3], -4.0
    v_exp_f32 v77, v77
    v_mfma_f32_16x16x32_bf16 v[64:67], a[84:87], a[4:7], v[64:67]
    ds_read_b64_tr_b16 a[190:191], v5 offset:28936
    v_cvt_pk_bf16_f32 v62, v76, v77
    v_mfma_f32_16x16x32_bf16 v[64:67], a[88:91], a[8:11], v[64:67]
    v_exp_f32 v78, v78
    v_mfma_f32_16x16x32_bf16 v[64:67], a[92:95], a[12:15], v[64:67]
    ds_read_b64_tr_b16 a[192:193], v5 offset:25088
    ds_read_b64_tr_b16 a[194:195], v5 offset:29184
    v_mfma_f32_16x16x32_bf16 v[68:71], a[108:111], a[12:15], -4.0
    v_exp_f32 v79, v79
    v_mfma_f32_16x16x32_bf16 v[68:71], a[104:107], a[8:11], v[68:71]
    ds_read_b64_tr_b16 a[160:161], v5 offset:16896
    v_cvt_pk_bf16_f32 v63, v78, v79
    v_mfma_f32_16x16x32_bf16 v[68:71], a[100:103], a[4:7], v[68:71]
    v_exp_f32 v64, v64
    v_mfma_f32_16x16x32_bf16 v[68:71], a[96:99], a[0:3], v[68:71]
    ds_read_b64_tr_b16 a[162:163], v5 offset:20992
    ds_read_b64_tr_b16 a[164:165], v5 offset:16904
    v_smfmac_f32_16x16x64_bf16 v[44:47], v[24:27], v[56:63], v9
    s_waitcnt lgkmcnt(6)
    ds_read_b64_tr_b16 a[166:167], v5 offset:21000
    ds_read_b64_tr_b16 a[196:197], v5 offset:25096
    v_mfma_f32_16x16x32_bf16 v[224:227], a[176:179], v[60:63], v[224:227]
    v_exp_f32 v65, v65
    v_mfma_f32_16x16x32_bf16 v[224:227], a[144:147], v[56:59], v[224:227]
    ds_read_b64_tr_b16 a[198:199], v5 offset:29192
    ds_read_b64_tr_b16 a[200:201], v5 offset:25344
    v_mfma_f32_16x16x32_bf16 v[228:231], a[148:151], v[56:59], v[228:231]
    v_exp_f32 v66, v66
    v_mfma_f32_16x16x32_bf16 v[228:231], a[180:183], v[60:63], v[228:231]
    ds_read_b64_tr_b16 a[202:203], v5 offset:29440
    ds_read_b64_tr_b16 a[168:169], v5 offset:17152
    v_mfma_f32_16x16x32_bf16 v[232:235], a[184:187], v[60:63], v[232:235]
    v_exp_f32 v67, v67
    v_mfma_f32_16x16x32_bf16 v[232:235], a[152:155], v[56:59], v[232:235]
    ds_read_b64_tr_b16 a[170:171], v5 offset:21248
    ds_read_b64_tr_b16 a[172:173], v5 offset:17160
    v_mfma_f32_16x16x32_bf16 v[236:239], a[156:159], v[56:59], v[236:239]
    s_waitcnt lgkmcnt(8)
    v_exp_f32 v68, v68
    v_mfma_f32_16x16x32_bf16 v[236:239], a[188:191], v[60:63], v[236:239]
    ds_read_b64_tr_b16 a[174:175], v5 offset:21256
    ds_read_b64_tr_b16 a[204:205], v5 offset:25352
    v_mfma_f32_16x16x32_bf16 v[72:75], a[112:115], a[0:3], -4.0
    v_exp_f32 v69, v69
    v_mfma_f32_16x16x32_bf16 v[72:75], a[116:119], a[4:7], v[72:75]
    ds_read_b64_tr_b16 a[206:207], v5 offset:29448
    v_cvt_pk_bf16_f32 v48, v64, v65
    v_mfma_f32_16x16x32_bf16 v[72:75], a[120:123], a[8:11], v[72:75]
    v_exp_f32 v70, v70
    v_mfma_f32_16x16x32_bf16 v[72:75], a[124:127], a[12:15], v[72:75]
    v_cvt_pk_bf16_f32 v49, v66, v67
    v_cvt_pk_bf16_f32 v50, v68, v69
    v_mfma_f32_16x16x32_bf16 v[76:79], a[140:143], a[12:15], -4.0
    v_exp_f32 v71, v71
    v_mfma_f32_16x16x32_bf16 v[76:79], a[136:139], a[8:11], v[76:79]
    v_cvt_pk_bf16_f32 v208, v208, v209
    v_cvt_pk_bf16_f32 v51, v70, v71
    v_mfma_f32_16x16x32_bf16 v[76:79], a[132:135], a[4:7], v[76:79]
    v_exp_f32 v72, v72
    v_mfma_f32_16x16x32_bf16 v[76:79], a[128:131], a[0:3], v[76:79]
    v_cvt_pk_bf16_f32 v209, v210, v211
    v_cvt_pk_bf16_f32 v216, v216, v217
    v_mfma_f32_16x16x32_bf16 v[240:243], a[192:195], v[60:63], v[240:243]
    v_exp_f32 v73, v73
    v_mfma_f32_16x16x32_bf16 v[240:243], a[160:163], v[56:59], v[240:243]
    s_waitcnt lgkmcnt(0)
    v_cvt_pk_bf16_f32 v210, v212, v213
    v_cvt_pk_bf16_f32 v52, v72, v73
    v_mfma_f32_16x16x32_bf16 v[244:247], a[164:167], v[56:59], v[244:247]
    v_exp_f32 v74, v74
    v_mfma_f32_16x16x32_bf16 v[244:247], a[196:199], v[60:63], v[244:247]
    v_cvt_pk_bf16_f32 v211, v214, v215
    v_cvt_pk_bf16_f32 v217, v218, v219
    v_mfma_f32_16x16x32_bf16 v[248:251], a[200:203], v[60:63], v[248:251]
    v_exp_f32 v75, v75
    v_mfma_f32_16x16x32_bf16 v[248:251], a[168:171], v[56:59], v[248:251]
    v_cvt_pk_bf16_f32 v218, v220, v221
    v_cvt_pk_bf16_f32 v53, v74, v75
    v_mfma_f32_16x16x32_bf16 v[252:255], a[172:175], v[56:59], v[252:255]
    v_exp_f32 v76, v76
    v_mfma_f32_16x16x32_bf16 v[252:255], a[204:207], v[60:63], v[252:255]
    s_barrier
    v_mfma_f32_16x16x32_bf16 v[64:67], a[80:83], a[16:19], -4.0
    s_mov_b32 s35, 0x1c000
    v_exp_f32 v77, v77
    v_mfma_f32_16x16x32_bf16 v[64:67], a[84:87], a[20:23], v[64:67]
    v_cvt_pk_bf16_f32 v219, v222, v223
    v_cvt_pk_bf16_f32 v54, v76, v77
    v_mfma_f32_16x16x32_bf16 v[64:67], a[88:91], a[24:27], v[64:67]
    s_mov_b32 m0, s50
    v_exp_f32 v78, v78
    v_mfma_f32_16x16x32_bf16 v[64:67], a[92:95], a[28:31], v[64:67]
    v_cndmask_b32_dpp v212, v216, v208, vcc row_ror:8 row_mask:0xf bank_mask:0xf
    v_cndmask_b32_dpp v213, v217, v209, vcc row_ror:8 row_mask:0xf bank_mask:0xf
    v_mfma_f32_16x16x32_bf16 v[68:71], a[108:111], a[28:31], -4.0
    v_exp_f32 v79, v79
    v_mfma_f32_16x16x32_bf16 v[68:71], a[104:107], a[24:27], v[68:71]
    buffer_load_dwordx4 v2, s[16:19], s35 offen offset:0 lds
    v_mfma_f32_16x16x32_bf16 v[68:71], a[100:103], a[20:23], v[68:71]
    v_cndmask_b32_dpp v214, v218, v210, vcc row_ror:8 row_mask:0xf bank_mask:0xf
    v_cvt_pk_bf16_f32 v55, v78, v79
    v_mfma_f32_16x16x32_bf16 v[68:71], a[96:99], a[16:19], v[68:71]
    v_exp_f32 v64, v64
    v_smfmac_f32_16x16x64_bf16 v[36:39], v[24:27], v[48:55], v9
    v_cndmask_b32_dpp v215, v219, v211, vcc row_ror:8 row_mask:0xf bank_mask:0xf
    v_mfma_f32_16x16x32_bf16 v[96:99], a[176:179], v[52:55], v[96:99]
    buffer_load_dwordx4 v2, s[16:19], s35 offen offset:1024 lds
    v_mfma_f32_16x16x32_bf16 v[96:99], a[144:147], v[48:51], v[96:99]
    s_mov_b32 m0, s51
    v_exp_f32 v65, v65
    v_mfma_f32_16x16x32_bf16 v[100:103], a[148:151], v[48:51], v[100:103]
    s_mov_b32 s35, 0x1e000
    v_mov_b32_dpp v216, v208 row_ror:8 row_mask:0xf bank_mask:0x3
    v_cvt_pk_bf16_f32 v56, v64, v65
    v_mfma_f32_16x16x32_bf16 v[100:103], a[180:183], v[52:55], v[100:103]
    v_exp_f32 v66, v66
    v_mfma_f32_16x16x32_bf16 v[104:107], a[184:187], v[52:55], v[104:107]
    buffer_load_dwordx4 v2, s[16:19], s35 offen offset:0 lds
    v_mfma_f32_16x16x32_bf16 v[104:107], a[152:155], v[48:51], v[104:107]
    v_exp_f32 v67, v67
    v_mfma_f32_16x16x32_bf16 v[108:111], a[156:159], v[48:51], v[108:111]
    v_mov_b32_dpp v217, v209 row_ror:8 row_mask:0xf bank_mask:0x3
    v_cvt_pk_bf16_f32 v57, v66, v67
    v_mfma_f32_16x16x32_bf16 v[108:111], a[188:191], v[52:55], v[108:111]
    v_exp_f32 v68, v68
    v_mfma_f32_16x16x32_bf16 v[72:75], a[112:115], a[16:19], -4.0
    buffer_load_dwordx4 v2, s[16:19], s35 offen offset:1024 lds
    v_mfma_f32_16x16x32_bf16 v[72:75], a[116:119], a[20:23], v[72:75]
    v_exp_f32 v69, v69
    v_mfma_f32_16x16x32_bf16 v[72:75], a[120:123], a[24:27], v[72:75]
    v_mov_b32_dpp v218, v210 row_ror:8 row_mask:0xf bank_mask:0x3
    v_cvt_pk_bf16_f32 v58, v68, v69
    v_mfma_f32_16x16x32_bf16 v[72:75], a[124:127], a[28:31], v[72:75]
    v_exp_f32 v70, v70
    v_mfma_f32_16x16x32_bf16 v[76:79], a[140:143], a[28:31], -4.0
    v_exp_f32 v71, v71
    v_mfma_f32_16x16x32_bf16 v[76:79], a[136:139], a[24:27], v[76:79]
    v_mov_b32_dpp v219, v211 row_ror:8 row_mask:0xf bank_mask:0x3
    v_cvt_pk_bf16_f32 v59, v70, v71
    v_mfma_f32_16x16x32_bf16 v[76:79], a[132:135], a[20:23], v[76:79]
    v_exp_f32 v72, v72
    v_mfma_f32_16x16x32_bf16 v[76:79], a[128:131], a[16:19], v[76:79]
    v_exp_f32 v73, v73
    v_mfma_f32_16x16x32_bf16 v[112:115], a[192:195], v[52:55], v[112:115]
    v_exp_f32 v74, v74
    v_mfma_f32_16x16x32_bf16 v[112:115], a[160:163], v[48:51], v[112:115]
    v_exp_f32 v75, v75
    v_mfma_f32_16x16x32_bf16 v[116:119], a[164:167], v[48:51], v[116:119]
    v_cvt_pk_bf16_f32 v60, v72, v73
    v_cvt_pk_bf16_f32 v61, v74, v75
    v_mfma_f32_16x16x32_bf16 v[116:119], a[196:199], v[52:55], v[116:119]
    v_exp_f32 v76, v76
    v_mfma_f32_16x16x32_bf16 v[120:123], a[200:203], v[52:55], v[120:123]
    buffer_store_dwordx4 v[196:199], v8, s[20:23], s34 offen offset:0 sc1
    v_mfma_f32_16x16x32_bf16 v[120:123], a[168:171], v[48:51], v[120:123]
    v_exp_f32 v77, v77
    v_mfma_f32_16x16x32_bf16 v[124:127], a[172:175], v[48:51], v[124:127]
    s_cmp_lg_u64 s[4:5], 0
    v_exp_f32 v78, v78
    v_mfma_f32_16x16x32_bf16 v[124:127], a[204:207], v[52:55], v[124:127]
    s_addc_u32 s32, s32, s32
    v_exp_f32 v79, v79
    v_mfma_f32_16x16x32_bf16 v[64:67], a[80:83], a[32:35], -4.0
    v_cvt_pk_bf16_f32 v62, v76, v77
    v_cvt_pk_bf16_f32 v63, v78, v79
    v_mfma_f32_16x16x32_bf16 v[64:67], a[84:87], a[36:39], v[64:67]
    v_mfma_f32_16x16x32_bf16 v[64:67], a[88:91], a[40:43], v[64:67]
    v_mfma_f32_16x16x32_bf16 v[64:67], a[92:95], a[44:47], v[64:67]
    v_mfma_f32_16x16x32_bf16 v[68:71], a[108:111], a[44:47], -4.0
    v_mfma_f32_16x16x32_bf16 v[68:71], a[104:107], a[40:43], v[68:71]
    v_mfma_f32_16x16x32_bf16 v[68:71], a[100:103], a[36:39], v[68:71]
    v_exp_f32 v64, v64
    v_mfma_f32_16x16x32_bf16 v[68:71], a[96:99], a[32:35], v[68:71]
    v_exp_f32 v65, v65
    v_smfmac_f32_16x16x64_bf16 v[38:41], v[24:27], v[56:63], v9
    v_cvt_pk_bf16_f32 v48, v64, v65
    v_mfma_f32_16x16x32_bf16 v[128:131], a[176:179], v[60:63], v[128:131]
    v_exp_f32 v66, v66
    v_mfma_f32_16x16x32_bf16 v[128:131], a[144:147], v[56:59], v[128:131]
    v_exp_f32 v67, v67
    v_mfma_f32_16x16x32_bf16 v[132:135], a[148:151], v[56:59], v[132:135]
    v_exp_f32 v68, v68
    v_mfma_f32_16x16x32_bf16 v[132:135], a[180:183], v[60:63], v[132:135]
    buffer_store_dwordx4 v[200:203], v8, s[20:23], s34 offen offset:2048 sc1
    v_mfma_f32_16x16x32_bf16 v[136:139], a[184:187], v[60:63], v[136:139]
    v_exp_f32 v69, v69
    v_mfma_f32_16x16x32_bf16 v[136:139], a[152:155], v[56:59], v[136:139]
    v_cvt_pk_bf16_f32 v49, v66, v67
    v_cvt_pk_bf16_f32 v50, v68, v69
    v_mfma_f32_16x16x32_bf16 v[140:143], a[156:159], v[56:59], v[140:143]
    v_exp_f32 v70, v70
    v_mfma_f32_16x16x32_bf16 v[140:143], a[188:191], v[60:63], v[140:143]
    v_exp_f32 v71, v71
    v_mfma_f32_16x16x32_bf16 v[72:75], a[112:115], a[32:35], -4.0
    v_cvt_pk_bf16_f32 v51, v70, v71
    v_mfma_f32_16x16x32_bf16 v[72:75], a[116:119], a[36:39], v[72:75]
    v_mfma_f32_16x16x32_bf16 v[72:75], a[120:123], a[40:43], v[72:75]
    v_mfma_f32_16x16x32_bf16 v[72:75], a[124:127], a[44:47], v[72:75]
    v_mfma_f32_16x16x32_bf16 v[76:79], a[140:143], a[44:47], -4.0
    v_mfma_f32_16x16x32_bf16 v[76:79], a[136:139], a[40:43], v[76:79]
    v_mfma_f32_16x16x32_bf16 v[76:79], a[132:135], a[36:39], v[76:79]
    v_exp_f32 v72, v72
    v_mfma_f32_16x16x32_bf16 v[76:79], a[128:131], a[32:35], v[76:79]
    v_exp_f32 v73, v73
    v_mfma_f32_16x16x32_bf16 v[144:147], a[192:195], v[60:63], v[144:147]
    v_exp_f32 v74, v74
    v_mfma_f32_16x16x32_bf16 v[144:147], a[160:163], v[56:59], v[144:147]
    v_exp_f32 v75, v75
    v_mfma_f32_16x16x32_bf16 v[148:151], a[164:167], v[56:59], v[148:151]
    v_cvt_pk_bf16_f32 v52, v72, v73
    v_cvt_pk_bf16_f32 v53, v74, v75
    v_mfma_f32_16x16x32_bf16 v[148:151], a[196:199], v[60:63], v[148:151]
    buffer_store_dwordx4 v[212:215], v8, s[20:23], s34 offen offset:128 sc1
    v_mfma_f32_16x16x32_bf16 v[152:155], a[200:203], v[60:63], v[152:155]
    v_exp_f32 v76, v76
    v_mfma_f32_16x16x32_bf16 v[152:155], a[168:171], v[56:59], v[152:155]
    v_exp_f32 v77, v77
    v_mfma_f32_16x16x32_bf16 v[156:159], a[172:175], v[56:59], v[156:159]
    v_exp_f32 v78, v78
    v_mfma_f32_16x16x32_bf16 v[156:159], a[204:207], v[60:63], v[156:159]
    v_exp_f32 v79, v79
    v_mfma_f32_16x16x32_bf16 v[64:67], a[80:83], a[48:51], -4.0
    v_cvt_pk_bf16_f32 v54, v76, v77
    v_cvt_pk_bf16_f32 v55, v78, v79
    v_mfma_f32_16x16x32_bf16 v[64:67], a[84:87], a[52:55], v[64:67]
    ds_read_b128 a[80:83], v4 offset:32768
    v_mfma_f32_16x16x32_bf16 v[64:67], a[88:91], a[56:59], v[64:67]
    ds_read_b128 a[84:87], v4 offset:33792
    v_mfma_f32_16x16x32_bf16 v[64:67], a[92:95], a[60:63], v[64:67]
    v_mfma_f32_16x16x32_bf16 v[68:71], a[108:111], a[60:63], -4.0
    v_mfma_f32_16x16x32_bf16 v[68:71], a[104:107], a[56:59], v[68:71]
    ds_read_b128 a[88:91], v4 offset:34816
    v_mfma_f32_16x16x32_bf16 v[68:71], a[100:103], a[52:55], v[68:71]
    v_exp_f32 v64, v64
    v_mfma_f32_16x16x32_bf16 v[68:71], a[96:99], a[48:51], v[68:71]
    v_exp_f32 v65, v65
    v_smfmac_f32_16x16x64_bf16 v[40:43], v[24:27], v[48:55], v9
    ds_read_b128 a[92:95], v4 offset:35840
    v_cvt_pk_bf16_f32 v56, v64, v65
    v_mfma_f32_16x16x32_bf16 v[160:163], a[176:179], v[52:55], v[160:163]
    v_exp_f32 v66, v66
    v_mfma_f32_16x16x32_bf16 v[160:163], a[144:147], v[48:51], v[160:163]
    v_exp_f32 v67, v67
    v_mfma_f32_16x16x32_bf16 v[164:167], a[148:151], v[48:51], v[164:167]
    buffer_store_dwordx4 v[216:219], v8, s[20:23], s34 offen offset:2176 sc1
    v_mfma_f32_16x16x32_bf16 v[164:167], a[180:183], v[52:55], v[164:167]
    s_add_u32 s34, s34, s38
    ds_read_b128 a[108:111], v4 offset:39936
    v_cvt_pk_bf16_f32 v57, v66, v67
    v_mfma_f32_16x16x32_bf16 v[168:171], a[184:187], v[52:55], v[168:171]
    v_exp_f32 v68, v68
    v_mfma_f32_16x16x32_bf16 v[168:171], a[152:155], v[48:51], v[168:171]
    v_exp_f32 v69, v69
    v_mfma_f32_16x16x32_bf16 v[172:175], a[156:159], v[48:51], v[172:175]
    ds_read_b128 a[104:107], v4 offset:38912
    v_cvt_pk_bf16_f32 v58, v68, v69
    v_mfma_f32_16x16x32_bf16 v[172:175], a[188:191], v[52:55], v[172:175]
    v_exp_f32 v70, v70
    v_mfma_f32_16x16x32_bf16 v[72:75], a[112:115], a[48:51], -4.0
    v_exp_f32 v71, v71
    v_mfma_f32_16x16x32_bf16 v[72:75], a[116:119], a[52:55], v[72:75]
    ds_read_b128 a[100:103], v4 offset:37888
    v_cvt_pk_bf16_f32 v59, v70, v71
    v_mfma_f32_16x16x32_bf16 v[72:75], a[120:123], a[56:59], v[72:75]
    ds_read_b128 a[112:115], v4 offset:40960
    v_mfma_f32_16x16x32_bf16 v[72:75], a[124:127], a[60:63], v[72:75]
    ds_read_b128 a[96:99], v4 offset:36864
    v_mfma_f32_16x16x32_bf16 v[76:79], a[140:143], a[60:63], -4.0
    ds_read_b128 a[116:119], v4 offset:41984
    v_mfma_f32_16x16x32_bf16 v[76:79], a[136:139], a[56:59], v[76:79]
    ds_read_b128 a[120:123], v4 offset:43008
    v_mfma_f32_16x16x32_bf16 v[76:79], a[132:135], a[52:55], v[76:79]
    v_exp_f32 v72, v72
    v_mfma_f32_16x16x32_bf16 v[76:79], a[128:131], a[48:51], v[76:79]
    v_exp_f32 v73, v73
    v_mfma_f32_16x16x32_bf16 v[176:179], a[192:195], v[52:55], v[176:179]
    ds_read_b128 a[124:127], v4 offset:44032
    v_cvt_pk_bf16_f32 v60, v72, v73
    v_mfma_f32_16x16x32_bf16 v[176:179], a[160:163], v[48:51], v[176:179]
    v_exp_f32 v74, v74
    v_mfma_f32_16x16x32_bf16 v[180:183], a[164:167], v[48:51], v[180:183]
    v_exp_f32 v75, v75
    v_mfma_f32_16x16x32_bf16 v[180:183], a[196:199], v[52:55], v[180:183]
    ds_read_b128 a[140:143], v4 offset:48128
    v_cvt_pk_bf16_f32 v61, v74, v75
    v_mfma_f32_16x16x32_bf16 v[184:187], a[200:203], v[52:55], v[184:187]
    v_exp_f32 v76, v76
    v_mfma_f32_16x16x32_bf16 v[184:187], a[168:171], v[48:51], v[184:187]
    v_exp_f32 v77, v77
    v_mfma_f32_16x16x32_bf16 v[188:191], a[172:175], v[48:51], v[188:191]
    ds_read_b128 a[136:139], v4 offset:47104
    v_cvt_pk_bf16_f32 v62, v76, v77
    v_mfma_f32_16x16x32_bf16 v[188:191], a[204:207], v[52:55], v[188:191]
    s_waitcnt lgkmcnt(3)
    v_exp_f32 v78, v78
    v_mfma_f32_16x16x32_bf16 v[64:67], a[80:83], a[64:67], -4.0
    v_exp_f32 v79, v79
    v_mfma_f32_16x16x32_bf16 v[64:67], a[84:87], a[68:71], v[64:67]
    ds_read_b128 a[132:135], v4 offset:46080
    v_cvt_pk_bf16_f32 v63, v78, v79
    v_mfma_f32_16x16x32_bf16 v[64:67], a[88:91], a[72:75], v[64:67]
    v_mfma_f32_16x16x32_bf16 v[64:67], a[92:95], a[76:79], v[64:67]
    v_mfma_f32_16x16x32_bf16 v[68:71], a[108:111], a[76:79], -4.0
    ds_read_b128 a[128:131], v4 offset:45056
    v_mfma_f32_16x16x32_bf16 v[68:71], a[104:107], a[72:75], v[68:71]
    v_mfma_f32_16x16x32_bf16 v[68:71], a[100:103], a[68:71], v[68:71]
    v_exp_f32 v64, v64
    v_mfma_f32_16x16x32_bf16 v[68:71], a[96:99], a[64:67], v[68:71]
    s_waitcnt vmcnt(12)
    v_exp_f32 v65, v65
    v_smfmac_f32_16x16x64_bf16 v[42:45], v[24:27], v[56:63], v9
    s_barrier
    v_mfma_f32_16x16x32_bf16 v[192:195], a[176:179], v[60:63], v[32:35]
    v_exp_f32 v66, v66
    v_mfma_f32_16x16x32_bf16 v[192:195], a[144:147], v[56:59], v[192:195]
    ds_read_b64_tr_b16 a[176:177], v5 offset:8192
    v_cvt_pk_bf16_f32 v48, v64, v65
    v_mfma_f32_16x16x32_bf16 v[196:199], a[148:151], v[56:59], v[32:35]
    v_exp_f32 v67, v67
    v_mfma_f32_16x16x32_bf16 v[196:199], a[180:183], v[60:63], v[196:199]
    ds_read_b64_tr_b16 a[178:179], v5 offset:12288
    v_cvt_pk_bf16_f32 v49, v66, v67
    v_mfma_f32_16x16x32_bf16 v[200:203], a[184:187], v[60:63], v[32:35]
    v_exp_f32 v68, v68
    v_mfma_f32_16x16x32_bf16 v[200:203], a[152:155], v[56:59], v[200:203]
    v_exp_f32 v69, v69
    v_mfma_f32_16x16x32_bf16 v[204:207], a[156:159], v[56:59], v[32:35]
    ds_read_b64_tr_b16 a[144:145], v5 offset:0
    v_cvt_pk_bf16_f32 v50, v68, v69
    v_mfma_f32_16x16x32_bf16 v[204:207], a[188:191], v[60:63], v[204:207]
    v_exp_f32 v70, v70
    v_mfma_f32_16x16x32_bf16 v[72:75], a[112:115], a[64:67], -4.0
    v_exp_f32 v71, v71
    v_mfma_f32_16x16x32_bf16 v[72:75], a[116:119], a[68:71], v[72:75]
    ds_read_b64_tr_b16 a[146:147], v5 offset:4096
    v_cvt_pk_bf16_f32 v51, v70, v71
    v_mfma_f32_16x16x32_bf16 v[72:75], a[120:123], a[72:75], v[72:75]
    s_waitcnt lgkmcnt(3)
    ds_read_b64_tr_b16 a[148:149], v5 offset:8
    v_mfma_f32_16x16x32_bf16 v[72:75], a[124:127], a[76:79], v[72:75]
    ds_read_b64_tr_b16 a[150:151], v5 offset:4104
    v_mfma_f32_16x16x32_bf16 v[76:79], a[140:143], a[76:79], -4.0
    ds_read_b64_tr_b16 a[180:181], v5 offset:8200
    ds_read_b64_tr_b16 a[182:183], v5 offset:12296
    v_mfma_f32_16x16x32_bf16 v[76:79], a[136:139], a[72:75], v[76:79]
    ds_read_b64_tr_b16 a[184:185], v5 offset:8448
    ds_read_b64_tr_b16 a[186:187], v5 offset:12544
    v_mfma_f32_16x16x32_bf16 v[76:79], a[132:135], a[68:71], v[76:79]
    v_exp_f32 v72, v72
    v_mfma_f32_16x16x32_bf16 v[76:79], a[128:131], a[64:67], v[76:79]
    ds_read_b64_tr_b16 a[152:153], v5 offset:256
    ds_read_b64_tr_b16 a[154:155], v5 offset:4352
    v_mfma_f32_16x16x32_bf16 v[208:211], a[192:195], v[60:63], v[32:35]
    v_exp_f32 v73, v73
    v_mfma_f32_16x16x32_bf16 v[208:211], a[160:163], v[56:59], v[208:211]
    ds_read_b64_tr_b16 a[156:157], v5 offset:264
    v_cvt_pk_bf16_f32 v52, v72, v73
    v_mfma_f32_16x16x32_bf16 v[212:215], a[164:167], v[56:59], v[32:35]
    v_exp_f32 v74, v74
    v_mfma_f32_16x16x32_bf16 v[212:215], a[196:199], v[60:63], v[212:215]
    ds_read_b64_tr_b16 a[158:159], v5 offset:4360
    ds_read_b64_tr_b16 a[188:189], v5 offset:8456
    v_mfma_f32_16x16x32_bf16 v[216:219], a[200:203], v[60:63], v[32:35]
    v_exp_f32 v75, v75
    v_mfma_f32_16x16x32_bf16 v[216:219], a[168:171], v[56:59], v[216:219]
    ds_read_b64_tr_b16 a[190:191], v5 offset:12552
    v_cvt_pk_bf16_f32 v53, v74, v75
    v_mfma_f32_16x16x32_bf16 v[220:223], a[172:175], v[56:59], v[32:35]
    v_exp_f32 v76, v76
    v_mfma_f32_16x16x32_bf16 v[220:223], a[204:207], v[60:63], v[220:223]
    v_exp_f32 v77, v77
    v_mfma_f32_16x16x32_bf16 v[64:67], a[80:83], a[0:3], -4.0
    ds_read_b64_tr_b16 a[192:193], v5 offset:8704
    v_cvt_pk_bf16_f32 v54, v76, v77
    v_mfma_f32_16x16x32_bf16 v[64:67], a[84:87], a[4:7], v[64:67]
    v_exp_f32 v78, v78
    v_mfma_f32_16x16x32_bf16 v[64:67], a[88:91], a[8:11], v[64:67]
    ds_read_b64_tr_b16 a[194:195], v5 offset:12800
    ds_read_b64_tr_b16 a[160:161], v5 offset:512
    v_mfma_f32_16x16x32_bf16 v[64:67], a[92:95], a[12:15], v[64:67]
    v_exp_f32 v79, v79
    v_mfma_f32_16x16x32_bf16 v[68:71], a[108:111], a[12:15], -4.0
    ds_read_b64_tr_b16 a[162:163], v5 offset:4608
    v_cvt_pk_bf16_f32 v55, v78, v79
    v_mfma_f32_16x16x32_bf16 v[68:71], a[104:107], a[8:11], v[68:71]
    ds_read_b64_tr_b16 a[164:165], v5 offset:520
    ds_read_b64_tr_b16 a[166:167], v5 offset:4616
    v_mfma_f32_16x16x32_bf16 v[68:71], a[100:103], a[4:7], v[68:71]
    v_exp_f32 v64, v64
    v_mfma_f32_16x16x32_bf16 v[68:71], a[96:99], a[0:3], v[68:71]
    ds_read_b64_tr_b16 a[196:197], v5 offset:8712
    ds_read_b64_tr_b16 a[198:199], v5 offset:12808
    v_smfmac_f32_16x16x64_bf16 v[44:47], v[24:27], v[48:55], v9
    s_waitcnt lgkmcnt(7)
    ds_read_b64_tr_b16 a[200:201], v5 offset:8960
    ds_read_b64_tr_b16 a[202:203], v5 offset:13056
    v_mfma_f32_16x16x32_bf16 v[224:227], a[176:179], v[52:55], v[224:227]
    v_exp_f32 v65, v65
    v_mfma_f32_16x16x32_bf16 v[224:227], a[144:147], v[48:51], v[224:227]
    ds_read_b64_tr_b16 a[168:169], v5 offset:768
    ds_read_b64_tr_b16 a[170:171], v5 offset:4864
    v_mfma_f32_16x16x32_bf16 v[228:231], a[148:151], v[48:51], v[228:231]
    v_exp_f32 v66, v66
    v_mfma_f32_16x16x32_bf16 v[228:231], a[180:183], v[52:55], v[228:231]
    ds_read_b64_tr_b16 a[172:173], v5 offset:776
    ds_read_b64_tr_b16 a[174:175], v5 offset:4872
    v_mfma_f32_16x16x32_bf16 v[232:235], a[184:187], v[52:55], v[232:235]
    v_exp_f32 v67, v67
    v_mfma_f32_16x16x32_bf16 v[232:235], a[152:155], v[48:51], v[232:235]
    ds_read_b64_tr_b16 a[204:205], v5 offset:8968
    ds_read_b64_tr_b16 a[206:207], v5 offset:13064
    v_mfma_f32_16x16x32_bf16 v[236:239], a[156:159], v[48:51], v[236:239]
    v_exp_f32 v68, v68
    v_mfma_f32_16x16x32_bf16 v[236:239], a[188:191], v[52:55], v[236:239]
    v_cvt_pk_bf16_f32 v56, v64, v65
    v_cvt_pk_bf16_f32 v57, v66, v67
    v_mfma_f32_16x16x32_bf16 v[72:75], a[112:115], a[0:3], -4.0
    v_exp_f32 v69, v69
    v_mfma_f32_16x16x32_bf16 v[72:75], a[116:119], a[4:7], v[72:75]
    v_cvt_pk_bf16_f32 v58, v68, v69
    v_add_f32 v29, v44, v45
    v_mfma_f32_16x16x32_bf16 v[72:75], a[120:123], a[8:11], v[72:75]
    v_exp_f32 v70, v70
    v_mfma_f32_16x16x32_bf16 v[72:75], a[124:127], a[12:15], v[72:75]
    v_exp_f32 v71, v71
    v_mfma_f32_16x16x32_bf16 v[76:79], a[140:143], a[12:15], -4.0
    v_cvt_pk_bf16_f32 v59, v70, v71
    v_mov_b64 v[44:45], 0
    v_mfma_f32_16x16x32_bf16 v[76:79], a[136:139], a[8:11], v[76:79]
    v_rcp_f32 v13, v29
    v_mfma_f32_16x16x32_bf16 v[76:79], a[132:135], a[4:7], v[76:79]
    v_mul_f32_e64 v31, -v32, v13
    v_subrev_u32 v29, s30, v29
    v_mfma_f32_16x16x32_bf16 v[76:79], a[128:131], a[0:3], v[76:79]
    s_waitcnt lgkmcnt(0)
    v_exp_f32 v72, v72
    v_mfma_f32_16x16x32_bf16 v[240:243], a[192:195], v[52:55], v[240:243]
    v_fma_f32 v224, v224, v13, v31
    v_fma_f32 v225, v225, v13, v31
    v_mfma_f32_16x16x32_bf16 v[240:243], a[160:163], v[48:51], v[240:243]
    v_exp_f32 v73, v73
    v_mfma_f32_16x16x32_bf16 v[244:247], a[164:167], v[48:51], v[244:247]
    v_fma_f32 v226, v226, v13, v31
    v_cvt_pk_bf16_f32 v60, v72, v73
    v_mfma_f32_16x16x32_bf16 v[244:247], a[196:199], v[52:55], v[244:247]
    v_exp_f32 v74, v74
    v_mfma_f32_16x16x32_bf16 v[248:251], a[200:203], v[52:55], v[248:251]
    v_fma_f32 v227, v227, v13, v31
    v_fma_f32 v228, v228, v13, v31
    v_mfma_f32_16x16x32_bf16 v[248:251], a[168:171], v[48:51], v[248:251]
    v_exp_f32 v75, v75
    v_mfma_f32_16x16x32_bf16 v[252:255], a[172:175], v[48:51], v[252:255]
    v_fma_f32 v229, v229, v13, v31
    v_cvt_pk_bf16_f32 v61, v74, v75
    v_mfma_f32_16x16x32_bf16 v[252:255], a[204:207], v[52:55], v[252:255]
    s_barrier
    v_mfma_f32_16x16x32_bf16 v[64:67], a[80:83], a[16:19], -4.0
    s_movk_i32 s35, 0x0
    v_exp_f32 v76, v76
    v_mfma_f32_16x16x32_bf16 v[64:67], a[84:87], a[20:23], v[64:67]
    s_waitcnt vmcnt(8)
    ds_read_b128 a[64:67], v15 offset:0
    v_fma_f32 v230, v230, v13, v31
    v_mfma_f32_16x16x32_bf16 v[64:67], a[88:91], a[24:27], v[64:67]
    s_mov_b32 m0, s48
    v_exp_f32 v77, v77
    v_mfma_f32_16x16x32_bf16 v[64:67], a[92:95], a[28:31], v[64:67]
    v_exp_f32 v78, v78
    v_mfma_f32_16x16x32_bf16 v[68:71], a[108:111], a[28:31], -4.0
    v_exp_f32 v79, v79
    v_mfma_f32_16x16x32_bf16 v[68:71], a[104:107], a[24:27], v[68:71]
    buffer_load_dwordx4 v2, s[16:19], s35 offen offset:0 lds
    v_mfma_f32_16x16x32_bf16 v[68:71], a[100:103], a[20:23], v[68:71]
    v_cvt_pk_bf16_f32 v62, v76, v77
    v_cvt_pk_bf16_f32 v63, v78, v79
    v_mfma_f32_16x16x32_bf16 v[68:71], a[96:99], a[16:19], v[68:71]
    ds_read_b128 a[68:71], v15 offset:256
    ds_read_b128 a[72:75], v15 offset:512
    v_smfmac_f32_16x16x64_bf16 v[36:39], v[24:27], v[56:63], v9
    v_fma_f32 v231, v231, v13, v31
    v_mfma_f32_16x16x32_bf16 v[96:99], a[176:179], v[60:63], v[96:99]
    buffer_load_dwordx4 v2, s[16:19], s35 offen offset:1024 lds
    v_mfma_f32_16x16x32_bf16 v[96:99], a[144:147], v[56:59], v[96:99]
    s_mov_b32 m0, s49
    v_exp_f32 v64, v64
    v_mfma_f32_16x16x32_bf16 v[100:103], a[148:151], v[56:59], v[100:103]
    s_movk_i32 s35, 0x2000
    ds_read_b128 a[76:79], v15 offset:768
    v_max3_f32 v14, abs(v224), abs(v225), abs(v226)
    v_mfma_f32_16x16x32_bf16 v[100:103], a[180:183], v[60:63], v[100:103]
    v_exp_f32 v65, v65
    v_mfma_f32_16x16x32_bf16 v[104:107], a[184:187], v[60:63], v[104:107]
    buffer_load_dwordx4 v2, s[16:19], s35 offen offset:0 lds
    v_mfma_f32_16x16x32_bf16 v[104:107], a[152:155], v[56:59], v[104:107]
    v_exp_f32 v66, v66
    v_mfma_f32_16x16x32_bf16 v[108:111], a[156:159], v[56:59], v[108:111]
    v_fma_f32 v232, v232, v13, v31
    v_cvt_pk_bf16_f32 v48, v64, v65
    v_mfma_f32_16x16x32_bf16 v[108:111], a[188:191], v[60:63], v[108:111]
    v_exp_f32 v67, v67
    v_mfma_f32_16x16x32_bf16 v[72:75], a[112:115], a[16:19], -4.0
    buffer_load_dwordx4 v2, s[16:19], s35 offen offset:1024 lds
    v_mfma_f32_16x16x32_bf16 v[72:75], a[116:119], a[20:23], v[72:75]
    v_exp_f32 v68, v68
    v_mfma_f32_16x16x32_bf16 v[72:75], a[120:123], a[24:27], v[72:75]
    v_fma_f32 v233, v233, v13, v31
    v_cvt_pk_bf16_f32 v49, v66, v67
    v_mfma_f32_16x16x32_bf16 v[72:75], a[124:127], a[28:31], v[72:75]
    s_mov_b32 m0, s26
    v_exp_f32 v69, v69
    v_mfma_f32_16x16x32_bf16 v[76:79], a[140:143], a[28:31], -4.0
    v_fma_f32 v234, v234, v13, v31
    v_cvt_pk_bf16_f32 v50, v68, v69
    v_mfma_f32_16x16x32_bf16 v[76:79], a[136:139], a[24:27], v[76:79]
    v_exp_f32 v70, v70
    v_mfma_f32_16x16x32_bf16 v[76:79], a[132:135], a[20:23], v[76:79]
    s_waitcnt lgkmcnt(0)
    buffer_load_dwordx4 v2, s[8:11], s33 offen offset:0 nt lds
    v_mfma_f32_16x16x32_bf16 v[76:79], a[128:131], a[16:19], v[76:79]
L_st8:
    s_cbranch_execz L_wret
    v_exp_f32 v71, v71
    v_mfma_f32_16x16x32_bf16 v[112:115], a[192:195], v[60:63], v[112:115]
    v_fma_f32 v235, v235, v13, v31
    v_cvt_pk_bf16_f32 v51, v70, v71
    v_mfma_f32_16x16x32_bf16 v[112:115], a[160:163], v[56:59], v[112:115]
    v_exp_f32 v72, v72
    v_mfma_f32_16x16x32_bf16 v[116:119], a[164:167], v[56:59], v[116:119]
    buffer_load_dwordx4 v2, s[8:11], s33 offen offset:1024 nt lds
    v_mfma_f32_16x16x32_bf16 v[116:119], a[196:199], v[60:63], v[116:119]
    v_exp_f32 v73, v73
    v_mfma_f32_16x16x32_bf16 v[120:123], a[200:203], v[60:63], v[120:123]
    v_fma_f32 v236, v236, v13, v31
    v_cvt_pk_bf16_f32 v52, v72, v73
    v_mfma_f32_16x16x32_bf16 v[120:123], a[168:171], v[56:59], v[120:123]
    v_exp_f32 v74, v74
    v_mfma_f32_16x16x32_bf16 v[124:127], a[172:175], v[56:59], v[124:127]
    buffer_load_dwordx4 v2, s[8:11], s33 offen offset:2048 nt lds
    v_mfma_f32_16x16x32_bf16 v[124:127], a[204:207], v[60:63], v[124:127]
    v_exp_f32 v75, v75
    v_mfma_f32_16x16x32_bf16 v[64:67], a[80:83], a[32:35], -4.0
    v_fma_f32 v237, v237, v13, v31
    v_cvt_pk_bf16_f32 v53, v74, v75
    v_mfma_f32_16x16x32_bf16 v[64:67], a[84:87], a[36:39], v[64:67]
    v_exp_f32 v76, v76
    v_mfma_f32_16x16x32_bf16 v[64:67], a[88:91], a[40:43], v[64:67]
    buffer_load_dwordx4 v2, s[8:11], s33 offen offset:3072 nt lds
    v_mfma_f32_16x16x32_bf16 v[64:67], a[92:95], a[44:47], v[64:67]
    s_add_u32 s33, s33, s38
    v_exp_f32 v77, v77
    v_mfma_f32_16x16x32_bf16 v[68:71], a[108:111], a[44:47], -4.0
    v_exp_f32 v78, v78
    v_mfma_f32_16x16x32_bf16 v[68:71], a[104:107], a[40:43], v[68:71]
    v_exp_f32 v79, v79
    v_mfma_f32_16x16x32_bf16 v[68:71], a[100:103], a[36:39], v[68:71]
    v_cvt_pk_bf16_f32 v54, v76, v77
    v_cvt_pk_bf16_f32 v55, v78, v79
    v_mfma_f32_16x16x32_bf16 v[68:71], a[96:99], a[32:35], v[68:71]
    v_exp_f32 v64, v64
    v_smfmac_f32_16x16x64_bf16 v[38:41], v[24:27], v[48:55], v9
    v_fma_f32 v238, v238, v13, v31
    v_mfma_f32_16x16x32_bf16 v[128:131], a[176:179], v[52:55], v[128:131]
    v_exp_f32 v65, v65
    v_mfma_f32_16x16x32_bf16 v[128:131], a[144:147], v[48:51], v[128:131]
    v_fma_f32 v239, v239, v13, v31
    v_cvt_pk_bf16_f32 v56, v64, v65
    v_mfma_f32_16x16x32_bf16 v[132:135], a[148:151], v[48:51], v[132:135]
    v_exp_f32 v66, v66
    v_mfma_f32_16x16x32_bf16 v[132:135], a[180:183], v[52:55], v[132:135]
    v_max3_f32 v14, v14, abs(v227), abs(v228)
    v_cvt_pk_bf16_f32 v224, v224, v225
    v_mfma_f32_16x16x32_bf16 v[136:139], a[184:187], v[52:55], v[136:139]
    v_exp_f32 v67, v67
    v_mfma_f32_16x16x32_bf16 v[136:139], a[152:155], v[48:51], v[136:139]
    v_cvt_pk_bf16_f32 v225, v226, v227
    v_cvt_pk_bf16_f32 v57, v66, v67
    v_mfma_f32_16x16x32_bf16 v[140:143], a[156:159], v[48:51], v[140:143]
    v_exp_f32 v68, v68
    v_mfma_f32_16x16x32_bf16 v[140:143], a[188:191], v[52:55], v[140:143]
    v_cvt_pk_bf16_f32 v226, v228, v229
    v_cvt_pk_bf16_f32 v227, v230, v231
    v_mfma_f32_16x16x32_bf16 v[72:75], a[112:115], a[32:35], -4.0
    v_exp_f32 v69, v69
    v_mfma_f32_16x16x32_bf16 v[72:75], a[116:119], a[36:39], v[72:75]
    v_cvt_pk_bf16_f32 v232, v232, v233
    v_cvt_pk_bf16_f32 v58, v68, v69
    v_mfma_f32_16x16x32_bf16 v[72:75], a[120:123], a[40:43], v[72:75]
    v_exp_f32 v70, v70
    v_mfma_f32_16x16x32_bf16 v[72:75], a[124:127], a[44:47], v[72:75]
    v_cvt_pk_bf16_f32 v233, v234, v235
    v_cndmask_b32_dpp v228, v232, v224, vcc row_ror:8 row_mask:0xf bank_mask:0xf
    v_mfma_f32_16x16x32_bf16 v[76:79], a[140:143], a[44:47], -4.0
    v_exp_f32 v71, v71
    v_mfma_f32_16x16x32_bf16 v[76:79], a[136:139], a[40:43], v[76:79]
    v_cvt_pk_bf16_f32 v234, v236, v237
    v_cvt_pk_bf16_f32 v59, v70, v71
    v_mfma_f32_16x16x32_bf16 v[76:79], a[132:135], a[36:39], v[76:79]
    v_exp_f32 v72, v72
    v_mfma_f32_16x16x32_bf16 v[76:79], a[128:131], a[32:35], v[76:79]
    v_cvt_pk_bf16_f32 v235, v238, v239
    v_cndmask_b32_dpp v229, v233, v225, vcc row_ror:8 row_mask:0xf bank_mask:0xf
    v_mfma_f32_16x16x32_bf16 v[144:147], a[192:195], v[52:55], v[144:147]
    v_exp_f32 v73, v73
    v_mfma_f32_16x16x32_bf16 v[144:147], a[160:163], v[48:51], v[144:147]
    v_cndmask_b32_dpp v230, v234, v226, vcc row_ror:8 row_mask:0xf bank_mask:0xf
    v_cvt_pk_bf16_f32 v60, v72, v73
    v_mfma_f32_16x16x32_bf16 v[148:151], a[164:167], v[48:51], v[148:151]
    v_exp_f32 v74, v74
    v_mfma_f32_16x16x32_bf16 v[148:151], a[196:199], v[52:55], v[148:151]
    v_fma_f32 v14, v14, s42, v31
    v_cndmask_b32_dpp v231, v235, v227, vcc row_ror:8 row_mask:0xf bank_mask:0xf
    v_mfma_f32_16x16x32_bf16 v[152:155], a[200:203], v[52:55], v[152:155]
    v_exp_f32 v75, v75
    v_mfma_f32_16x16x32_bf16 v[152:155], a[168:171], v[48:51], v[152:155]
    v_and_or_b32 v14, v14, s43, v29
    v_cvt_pk_bf16_f32 v61, v74, v75
    v_mfma_f32_16x16x32_bf16 v[156:159], a[172:175], v[48:51], v[156:159]
    v_exp_f32 v76, v76
    v_mfma_f32_16x16x32_bf16 v[156:159], a[204:207], v[52:55], v[156:159]
    v_cmp_lt_u32_e64 s[4:5], s31, v14
    v_mov_b32_dpp v232, v224 row_ror:8 row_mask:0xf bank_mask:0x3
    v_mfma_f32_16x16x32_bf16 v[64:67], a[80:83], a[48:51], -4.0
    v_exp_f32 v77, v77
    v_mfma_f32_16x16x32_bf16 v[64:67], a[84:87], a[52:55], v[64:67]
    ds_read_b128 a[80:83], v4 offset:49152
    v_cvt_pk_bf16_f32 v62, v76, v77
    v_mfma_f32_16x16x32_bf16 v[64:67], a[88:91], a[56:59], v[64:67]
    v_exp_f32 v78, v78
    v_mfma_f32_16x16x32_bf16 v[64:67], a[92:95], a[60:63], v[64:67]
    ds_read_b128 a[84:87], v4 offset:50176
    v_mov_b32_dpp v233, v225 row_ror:8 row_mask:0xf bank_mask:0x3
    v_mfma_f32_16x16x32_bf16 v[68:71], a[108:111], a[60:63], -4.0
    v_exp_f32 v79, v79
    v_mfma_f32_16x16x32_bf16 v[68:71], a[104:107], a[56:59], v[68:71]
    ds_read_b128 a[88:91], v4 offset:51200
    v_cvt_pk_bf16_f32 v63, v78, v79
    v_mfma_f32_16x16x32_bf16 v[68:71], a[100:103], a[52:55], v[68:71]
    v_exp_f32 v64, v64
    v_mfma_f32_16x16x32_bf16 v[68:71], a[96:99], a[48:51], v[68:71]
    v_mov_b32_dpp v234, v226 row_ror:8 row_mask:0xf bank_mask:0x3
    v_mov_b32_dpp v235, v227 row_ror:8 row_mask:0xf bank_mask:0x3
    v_smfmac_f32_16x16x64_bf16 v[40:43], v[24:27], v[56:63], v9
    ds_read_b128 a[92:95], v4 offset:52224
    v_fma_f32 v240, v240, v13, v31
    v_mfma_f32_16x16x32_bf16 v[160:163], a[176:179], v[60:63], v[160:163]
    v_exp_f32 v65, v65
    v_mfma_f32_16x16x32_bf16 v[160:163], a[144:147], v[56:59], v[160:163]
    v_fma_f32 v241, v241, v13, v31
    v_cvt_pk_bf16_f32 v48, v64, v65
    v_mfma_f32_16x16x32_bf16 v[164:167], a[148:151], v[56:59], v[164:167]
    v_exp_f32 v66, v66
    v_mfma_f32_16x16x32_bf16 v[164:167], a[180:183], v[60:63], v[164:167]
    ds_read_b128 a[108:111], v4 offset:56320
    v_fma_f32 v242, v242, v13, v31
    v_mfma_f32_16x16x32_bf16 v[168:171], a[184:187], v[60:63], v[168:171]
    v_exp_f32 v67, v67
    v_mfma_f32_16x16x32_bf16 v[168:171], a[152:155], v[56:59], v[168:171]
    ds_read_b128 a[104:107], v4 offset:55296
    v_cvt_pk_bf16_f32 v49, v66, v67
    v_mfma_f32_16x16x32_bf16 v[172:175], a[156:159], v[56:59], v[172:175]
    v_exp_f32 v68, v68
    v_mfma_f32_16x16x32_bf16 v[172:175], a[188:191], v[60:63], v[172:175]
    v_fma_f32 v243, v243, v13, v31
    v_fma_f32 v244, v244, v13, v31
    v_mfma_f32_16x16x32_bf16 v[72:75], a[112:115], a[48:51], -4.0
    v_exp_f32 v69, v69
    v_mfma_f32_16x16x32_bf16 v[72:75], a[116:119], a[52:55], v[72:75]
    ds_read_b128 a[100:103], v4 offset:54272
    v_cvt_pk_bf16_f32 v50, v68, v69
    v_mfma_f32_16x16x32_bf16 v[72:75], a[120:123], a[56:59], v[72:75]
    v_exp_f32 v70, v70
    v_mfma_f32_16x16x32_bf16 v[72:75], a[124:127], a[60:63], v[72:75]
    ds_read_b128 a[96:99], v4 offset:53248
    v_fma_f32 v245, v245, v13, v31
    v_mfma_f32_16x16x32_bf16 v[76:79], a[140:143], a[60:63], -4.0
    v_exp_f32 v71, v71
    v_mfma_f32_16x16x32_bf16 v[76:79], a[136:139], a[56:59], v[76:79]
    ds_read_b128 a[112:115], v4 offset:57344
    v_cvt_pk_bf16_f32 v51, v70, v71
    v_mfma_f32_16x16x32_bf16 v[76:79], a[132:135], a[52:55], v[76:79]
    v_exp_f32 v72, v72
    v_mfma_f32_16x16x32_bf16 v[76:79], a[128:131], a[48:51], v[76:79]
    ds_read_b128 a[116:119], v4 offset:58368
    v_fma_f32 v246, v246, v13, v31
    v_mfma_f32_16x16x32_bf16 v[176:179], a[192:195], v[60:63], v[176:179]
    v_exp_f32 v73, v73
    v_mfma_f32_16x16x32_bf16 v[176:179], a[160:163], v[56:59], v[176:179]
    ds_read_b128 a[120:123], v4 offset:59392
    v_cvt_pk_bf16_f32 v52, v72, v73
    v_mfma_f32_16x16x32_bf16 v[180:183], a[164:167], v[56:59], v[180:183]
    v_exp_f32 v74, v74
    v_mfma_f32_16x16x32_bf16 v[180:183], a[196:199], v[60:63], v[180:183]
    ds_read_b128 a[124:127], v4 offset:60416
    v_fma_f32 v247, v247, v13, v31
    v_mfma_f32_16x16x32_bf16 v[184:187], a[200:203], v[60:63], v[184:187]
    v_exp_f32 v75, v75
    v_mfma_f32_16x16x32_bf16 v[184:187], a[168:171], v[56:59], v[184:187]
    ds_read_b128 a[140:143], v4 offset:64512
    v_cvt_pk_bf16_f32 v53, v74, v75
    v_mfma_f32_16x16x32_bf16 v[188:191], a[172:175], v[56:59], v[188:191]
    v_exp_f32 v76, v76
    v_mfma_f32_16x16x32_bf16 v[188:191], a[204:207], v[60:63], v[188:191]
    s_waitcnt lgkmcnt(3)
    ds_read_b128 a[136:139], v4 offset:63488
    v_fma_f32 v248, v248, v13, v31
    v_mfma_f32_16x16x32_bf16 v[64:67], a[80:83], a[0:3], -4.0
    v_exp_f32 v77, v77
    v_mfma_f32_16x16x32_bf16 v[64:67], a[84:87], a[4:7], v[64:67]
    ds_read_b128 a[132:135], v4 offset:62464
    v_cvt_pk_bf16_f32 v54, v76, v77
    v_mfma_f32_16x16x32_bf16 v[64:67], a[88:91], a[8:11], v[64:67]
    v_exp_f32 v78, v78
    v_mfma_f32_16x16x32_bf16 v[64:67], a[92:95], a[12:15], v[64:67]
    v_fma_f32 v249, v249, v13, v31
    v_fma_f32 v250, v250, v13, v31
    v_mfma_f32_16x16x32_bf16 v[68:71], a[108:111], a[12:15], -4.0
    v_exp_f32 v79, v79
    v_mfma_f32_16x16x32_bf16 v[68:71], a[104:107], a[8:11], v[68:71]
    ds_read_b128 a[128:131], v4 offset:61440
    v_cvt_pk_bf16_f32 v55, v78, v79
    v_mfma_f32_16x16x32_bf16 v[68:71], a[100:103], a[4:7], v[68:71]
    v_exp_f32 v64, v64
    v_mfma_f32_16x16x32_bf16 v[68:71], a[96:99], a[0:3], v[68:71]
    s_waitcnt vmcnt(12)
    v_fma_f32 v251, v251, v13, v31
    v_fma_f32 v252, v252, v13, v31
    v_smfmac_f32_16x16x64_bf16 v[42:45], v[24:27], v[48:55], v9
    s_barrier
    v_mfma_f32_16x16x32_bf16 v[192:195], a[176:179], v[52:55], v[192:195]
    v_exp_f32 v65, v65
    v_mfma_f32_16x16x32_bf16 v[192:195], a[144:147], v[48:51], v[192:195]
    ds_read_b64_tr_b16 a[176:177], v5 offset:24576
    v_cvt_pk_bf16_f32 v56, v64, v65
    v_mfma_f32_16x16x32_bf16 v[196:199], a[148:151], v[48:51], v[196:199]
    v_exp_f32 v66, v66
    v_mfma_f32_16x16x32_bf16 v[196:199], a[180:183], v[52:55], v[196:199]
    ds_read_b64_tr_b16 a[178:179], v5 offset:28672
    v_fma_f32 v253, v253, v13, v31
    v_mfma_f32_16x16x32_bf16 v[200:203], a[184:187], v[52:55], v[200:203]
    v_exp_f32 v67, v67
    v_mfma_f32_16x16x32_bf16 v[200:203], a[152:155], v[48:51], v[200:203]
    ds_read_b64_tr_b16 a[144:145], v5 offset:16384
    v_cvt_pk_bf16_f32 v57, v66, v67
    v_mfma_f32_16x16x32_bf16 v[204:207], a[156:159], v[48:51], v[204:207]
    v_exp_f32 v68, v68
    v_mfma_f32_16x16x32_bf16 v[204:207], a[188:191], v[52:55], v[204:207]
    ds_read_b64_tr_b16 a[146:147], v5 offset:20480
    v_fma_f32 v254, v254, v13, v31
    v_mfma_f32_16x16x32_bf16 v[72:75], a[112:115], a[0:3], -4.0
    v_exp_f32 v69, v69
    v_mfma_f32_16x16x32_bf16 v[72:75], a[116:119], a[4:7], v[72:75]
    s_waitcnt lgkmcnt(3)
    ds_read_b64_tr_b16 a[148:149], v5 offset:16392
    v_cvt_pk_bf16_f32 v58, v68, v69
    v_mfma_f32_16x16x32_bf16 v[72:75], a[120:123], a[8:11], v[72:75]
    v_exp_f32 v70, v70
    v_mfma_f32_16x16x32_bf16 v[72:75], a[124:127], a[12:15], v[72:75]
    ds_read_b64_tr_b16 a[150:151], v5 offset:20488
    v_fma_f32 v255, v255, v13, v31
    v_mfma_f32_16x16x32_bf16 v[76:79], a[140:143], a[12:15], -4.0
    v_exp_f32 v71, v71
    v_mfma_f32_16x16x32_bf16 v[76:79], a[136:139], a[8:11], v[76:79]
    ds_read_b64_tr_b16 a[180:181], v5 offset:24584
    v_cvt_pk_bf16_f32 v59, v70, v71
    v_mfma_f32_16x16x32_bf16 v[76:79], a[132:135], a[4:7], v[76:79]
    v_exp_f32 v72, v72
    v_mfma_f32_16x16x32_bf16 v[76:79], a[128:131], a[0:3], v[76:79]
    ds_read_b64_tr_b16 a[182:183], v5 offset:28680
    ds_read_b64_tr_b16 a[184:185], v5 offset:24832
    v_mfma_f32_16x16x32_bf16 v[208:211], a[192:195], v[52:55], v[208:211]
    v_exp_f32 v73, v73
    v_mfma_f32_16x16x32_bf16 v[208:211], a[160:163], v[48:51], v[208:211]
    ds_read_b64_tr_b16 a[186:187], v5 offset:28928
    v_cvt_pk_bf16_f32 v60, v72, v73
    v_mfma_f32_16x16x32_bf16 v[212:215], a[164:167], v[48:51], v[212:215]
    v_exp_f32 v74, v74
    v_mfma_f32_16x16x32_bf16 v[212:215], a[196:199], v[52:55], v[212:215]
    ds_read_b64_tr_b16 a[152:153], v5 offset:16640
    ds_read_b64_tr_b16 a[154:155], v5 offset:20736
    v_mfma_f32_16x16x32_bf16 v[216:219], a[200:203], v[52:55], v[216:219]
    v_exp_f32 v75, v75
    v_mfma_f32_16x16x32_bf16 v[216:219], a[168:171], v[48:51], v[216:219]
    ds_read_b64_tr_b16 a[156:157], v5 offset:16648
    v_cvt_pk_bf16_f32 v61, v74, v75
    v_mfma_f32_16x16x32_bf16 v[220:223], a[172:175], v[48:51], v[220:223]
    v_exp_f32 v76, v76
    v_mfma_f32_16x16x32_bf16 v[220:223], a[204:207], v[52:55], v[220:223]
    ds_read_b64_tr_b16 a[158:159], v5 offset:20744
    ds_read_b64_tr_b16 a[188:189], v5 offset:24840
    v_mfma_f32_16x16x32_bf16 v[64:67], a[80:83], a[16:19], -4.0
    v_exp_f32 v77, v77
    v_mfma_f32_16x16x32_bf16 v[64:67], a[84:87], a[20:23], v[64:67]
    ds_read_b64_tr_b16 a[190:191], v5 offset:28936
    v_cvt_pk_bf16_f32 v62, v76, v77
    v_mfma_f32_16x16x32_bf16 v[64:67], a[88:91], a[24:27], v[64:67]
    v_exp_f32 v78, v78
    v_mfma_f32_16x16x32_bf16 v[64:67], a[92:95], a[28:31], v[64:67]
    ds_read_b64_tr_b16 a[192:193], v5 offset:25088
    ds_read_b64_tr_b16 a[194:195], v5 offset:29184
    v_mfma_f32_16x16x32_bf16 v[68:71], a[108:111], a[28:31], -4.0
    v_exp_f32 v79, v79
    v_mfma_f32_16x16x32_bf16 v[68:71], a[104:107], a[24:27], v[68:71]
    ds_read_b64_tr_b16 a[160:161], v5 offset:16896
    v_cvt_pk_bf16_f32 v63, v78, v79
    v_mfma_f32_16x16x32_bf16 v[68:71], a[100:103], a[20:23], v[68:71]
    v_exp_f32 v64, v64
    v_mfma_f32_16x16x32_bf16 v[68:71], a[96:99], a[16:19], v[68:71]
    ds_read_b64_tr_b16 a[162:163], v5 offset:20992
    ds_read_b64_tr_b16 a[164:165], v5 offset:16904
    v_smfmac_f32_16x16x64_bf16 v[36:39], v[24:27], v[56:63], v9
    s_waitcnt lgkmcnt(6)
    ds_read_b64_tr_b16 a[166:167], v5 offset:21000
    ds_read_b64_tr_b16 a[196:197], v5 offset:25096
    v_mfma_f32_16x16x32_bf16 v[96:99], a[176:179], v[60:63], v[96:99]
    v_exp_f32 v65, v65
    v_mfma_f32_16x16x32_bf16 v[96:99], a[144:147], v[56:59], v[96:99]
    ds_read_b64_tr_b16 a[198:199], v5 offset:29192
    ds_read_b64_tr_b16 a[200:201], v5 offset:25344
    v_mfma_f32_16x16x32_bf16 v[100:103], a[148:151], v[56:59], v[100:103]
    v_exp_f32 v66, v66
    v_mfma_f32_16x16x32_bf16 v[100:103], a[180:183], v[60:63], v[100:103]
    ds_read_b64_tr_b16 a[202:203], v5 offset:29440
    ds_read_b64_tr_b16 a[168:169], v5 offset:17152
    v_mfma_f32_16x16x32_bf16 v[104:107], a[184:187], v[60:63], v[104:107]
    v_exp_f32 v67, v67
    v_mfma_f32_16x16x32_bf16 v[104:107], a[152:155], v[56:59], v[104:107]
    ds_read_b64_tr_b16 a[170:171], v5 offset:21248
    ds_read_b64_tr_b16 a[172:173], v5 offset:17160
    v_mfma_f32_16x16x32_bf16 v[108:111], a[156:159], v[56:59], v[108:111]
    s_waitcnt lgkmcnt(8)
    v_exp_f32 v68, v68
    v_mfma_f32_16x16x32_bf16 v[108:111], a[188:191], v[60:63], v[108:111]
    ds_read_b64_tr_b16 a[174:175], v5 offset:21256
    ds_read_b64_tr_b16 a[204:205], v5 offset:25352
    v_mfma_f32_16x16x32_bf16 v[72:75], a[112:115], a[16:19], -4.0
    v_exp_f32 v69, v69
    v_mfma_f32_16x16x32_bf16 v[72:75], a[116:119], a[20:23], v[72:75]
    ds_read_b64_tr_b16 a[206:207], v5 offset:29448
    v_cvt_pk_bf16_f32 v48, v64, v65
    v_mfma_f32_16x16x32_bf16 v[72:75], a[120:123], a[24:27], v[72:75]
    v_exp_f32 v70, v70
    v_mfma_f32_16x16x32_bf16 v[72:75], a[124:127], a[28:31], v[72:75]
    v_cvt_pk_bf16_f32 v49, v66, v67
    v_cvt_pk_bf16_f32 v50, v68, v69
    v_mfma_f32_16x16x32_bf16 v[76:79], a[140:143], a[28:31], -4.0
    v_exp_f32 v71, v71
    v_mfma_f32_16x16x32_bf16 v[76:79], a[136:139], a[24:27], v[76:79]
    v_cvt_pk_bf16_f32 v51, v70, v71
    v_add_f32 v28, v36, v37
    v_mfma_f32_16x16x32_bf16 v[76:79], a[132:135], a[20:23], v[76:79]
    v_rcp_f32 v12, v28
    v_mfma_f32_16x16x32_bf16 v[76:79], a[128:131], a[16:19], v[76:79]
    v_mov_b64 v[36:37], 0
    v_mul_f32_e64 v30, -v32, v12
    v_mfma_f32_16x16x32_bf16 v[112:115], a[192:195], v[60:63], v[112:115]
    v_exp_f32 v72, v72
    v_mfma_f32_16x16x32_bf16 v[112:115], a[160:163], v[56:59], v[112:115]
    s_waitcnt lgkmcnt(0)
    v_cvt_pk_bf16_f32 v240, v240, v241
    v_cvt_pk_bf16_f32 v248, v248, v249
    v_mfma_f32_16x16x32_bf16 v[116:119], a[164:167], v[56:59], v[116:119]
    v_exp_f32 v73, v73
    v_mfma_f32_16x16x32_bf16 v[116:119], a[196:199], v[60:63], v[116:119]
    v_cvt_pk_bf16_f32 v241, v242, v243
    v_cvt_pk_bf16_f32 v52, v72, v73
    v_mfma_f32_16x16x32_bf16 v[120:123], a[200:203], v[60:63], v[120:123]
    v_exp_f32 v74, v74
    v_mfma_f32_16x16x32_bf16 v[120:123], a[168:171], v[56:59], v[120:123]
    v_cvt_pk_bf16_f32 v242, v244, v245
    v_cvt_pk_bf16_f32 v243, v246, v247
    v_mfma_f32_16x16x32_bf16 v[124:127], a[172:175], v[56:59], v[124:127]
    v_exp_f32 v75, v75
    v_mfma_f32_16x16x32_bf16 v[124:127], a[204:207], v[60:63], v[124:127]
    s_barrier
    v_mfma_f32_16x16x32_bf16 v[64:67], a[80:83], a[32:35], -4.0
    s_movk_i32 s35, 0x4000
    v_exp_f32 v76, v76
    v_mfma_f32_16x16x32_bf16 v[64:67], a[84:87], a[36:39], v[64:67]
    v_cvt_pk_bf16_f32 v249, v250, v251
    v_cvt_pk_bf16_f32 v53, v74, v75
    v_mfma_f32_16x16x32_bf16 v[64:67], a[88:91], a[40:43], v[64:67]
    s_mov_b32 m0, s50
    v_exp_f32 v77, v77
    v_mfma_f32_16x16x32_bf16 v[64:67], a[92:95], a[44:47], v[64:67]
    v_exp_f32 v78, v78
    v_mfma_f32_16x16x32_bf16 v[68:71], a[108:111], a[44:47], -4.0
    v_exp_f32 v79, v79
    v_mfma_f32_16x16x32_bf16 v[68:71], a[104:107], a[40:43], v[68:71]
    buffer_load_dwordx4 v2, s[16:19], s35 offen offset:0 lds
    v_mfma_f32_16x16x32_bf16 v[68:71], a[100:103], a[36:39], v[68:71]
    v_cvt_pk_bf16_f32 v54, v76, v77
    v_cvt_pk_bf16_f32 v55, v78, v79
    v_mfma_f32_16x16x32_bf16 v[68:71], a[96:99], a[32:35], v[68:71]
    v_exp_f32 v64, v64
    v_smfmac_f32_16x16x64_bf16 v[38:41], v[24:27], v[48:55], v9
    v_cvt_pk_bf16_f32 v250, v252, v253
    v_mfma_f32_16x16x32_bf16 v[128:131], a[176:179], v[52:55], v[128:131]
    buffer_load_dwordx4 v2, s[16:19], s35 offen offset:1024 lds
    v_mfma_f32_16x16x32_bf16 v[128:131], a[144:147], v[48:51], v[128:131]
    s_mov_b32 m0, s51
    v_exp_f32 v65, v65
    v_mfma_f32_16x16x32_bf16 v[132:135], a[148:151], v[48:51], v[132:135]
    s_movk_i32 s35, 0x6000
    v_cvt_pk_bf16_f32 v251, v254, v255
    v_cvt_pk_bf16_f32 v56, v64, v65
    v_mfma_f32_16x16x32_bf16 v[132:135], a[180:183], v[52:55], v[132:135]
    v_exp_f32 v66, v66
    v_mfma_f32_16x16x32_bf16 v[136:139], a[184:187], v[52:55], v[136:139]
    buffer_load_dwordx4 v2, s[16:19], s35 offen offset:0 lds
    v_mfma_f32_16x16x32_bf16 v[136:139], a[152:155], v[48:51], v[136:139]
    v_exp_f32 v67, v67
    v_mfma_f32_16x16x32_bf16 v[140:143], a[156:159], v[48:51], v[140:143]
    v_cndmask_b32_dpp v244, v248, v240, vcc row_ror:8 row_mask:0xf bank_mask:0xf
    v_cvt_pk_bf16_f32 v57, v66, v67
    v_mfma_f32_16x16x32_bf16 v[140:143], a[188:191], v[52:55], v[140:143]
    v_exp_f32 v68, v68
    v_mfma_f32_16x16x32_bf16 v[72:75], a[112:115], a[32:35], -4.0
    buffer_load_dwordx4 v2, s[16:19], s35 offen offset:1024 lds
    v_mfma_f32_16x16x32_bf16 v[72:75], a[116:119], a[36:39], v[72:75]
    v_exp_f32 v69, v69
    v_mfma_f32_16x16x32_bf16 v[72:75], a[120:123], a[40:43], v[72:75]
    buffer_store_dwordx4 v[228:231], v8, s[20:23], s34 offen offset:0 sc1
    v_mfma_f32_16x16x32_bf16 v[72:75], a[124:127], a[44:47], v[72:75]
    v_cndmask_b32_dpp v245, v249, v241, vcc row_ror:8 row_mask:0xf bank_mask:0xf
    v_cvt_pk_bf16_f32 v58, v68, v69
    v_mfma_f32_16x16x32_bf16 v[76:79], a[140:143], a[44:47], -4.0
    s_cmp_lg_u64 s[4:5], 0
    v_exp_f32 v70, v70
    v_mfma_f32_16x16x32_bf16 v[76:79], a[136:139], a[40:43], v[76:79]
    s_addc_u32 s32, s32, s32
    v_cndmask_b32_dpp v246, v250, v242, vcc row_ror:8 row_mask:0xf bank_mask:0xf
    v_cndmask_b32_dpp v247, v251, v243, vcc row_ror:8 row_mask:0xf bank_mask:0xf
    v_mfma_f32_16x16x32_bf16 v[76:79], a[132:135], a[36:39], v[76:79]
    v_exp_f32 v71, v71
    v_mfma_f32_16x16x32_bf16 v[76:79], a[128:131], a[32:35], v[76:79]
    v_mov_b32_dpp v248, v240 row_ror:8 row_mask:0xf bank_mask:0x3
    v_cvt_pk_bf16_f32 v59, v70, v71
    v_mfma_f32_16x16x32_bf16 v[144:147], a[192:195], v[52:55], v[144:147]
    v_exp_f32 v72, v72
    v_mfma_f32_16x16x32_bf16 v[144:147], a[160:163], v[48:51], v[144:147]
    v_mov_b32_dpp v249, v241 row_ror:8 row_mask:0xf bank_mask:0x3
    v_mov_b32_dpp v250, v242 row_ror:8 row_mask:0xf bank_mask:0x3
    v_mfma_f32_16x16x32_bf16 v[148:151], a[164:167], v[48:51], v[148:151]
    v_exp_f32 v73, v73
    v_mfma_f32_16x16x32_bf16 v[148:151], a[196:199], v[52:55], v[148:151]
    v_mov_b32_dpp v251, v243 row_ror:8 row_mask:0xf bank_mask:0x3
    v_cvt_pk_bf16_f32 v60, v72, v73
    v_mfma_f32_16x16x32_bf16 v[152:155], a[200:203], v[52:55], v[152:155]
    v_exp_f32 v74, v74
    v_mfma_f32_16x16x32_bf16 v[152:155], a[168:171], v[48:51], v[152:155]
    v_fma_f32 v96, v96, v12, v30
    v_fma_f32 v97, v97, v12, v30
    v_mfma_f32_16x16x32_bf16 v[156:159], a[172:175], v[48:51], v[156:159]
    v_exp_f32 v75, v75
    v_mfma_f32_16x16x32_bf16 v[156:159], a[204:207], v[52:55], v[156:159]
    v_fma_f32 v98, v98, v12, v30
    v_cvt_pk_bf16_f32 v61, v74, v75
    v_mfma_f32_16x16x32_bf16 v[64:67], a[80:83], a[48:51], -4.0
    buffer_store_dwordx4 v[232:235], v8, s[20:23], s34 offen offset:2048 sc1
    v_mfma_f32_16x16x32_bf16 v[64:67], a[84:87], a[52:55], v[64:67]
    v_fma_f32 v99, v99, v12, v30
    v_fma_f32 v100, v100, v12, v30
    v_mfma_f32_16x16x32_bf16 v[64:67], a[88:91], a[56:59], v[64:67]
    v_exp_f32 v76, v76
    v_mfma_f32_16x16x32_bf16 v[64:67], a[92:95], a[60:63], v[64:67]
    v_exp_f32 v77, v77
    v_mfma_f32_16x16x32_bf16 v[68:71], a[108:111], a[60:63], -4.0
    v_exp_f32 v78, v78
    v_mfma_f32_16x16x32_bf16 v[68:71], a[104:107], a[56:59], v[68:71]
    v_exp_f32 v79, v79
    v_mfma_f32_16x16x32_bf16 v[68:71], a[100:103], a[52:55], v[68:71]
    v_cvt_pk_bf16_f32 v62, v76, v77
    v_cvt_pk_bf16_f32 v63, v78, v79
    v_mfma_f32_16x16x32_bf16 v[68:71], a[96:99], a[48:51], v[68:71]
    v_exp_f32 v64, v64
    v_smfmac_f32_16x16x64_bf16 v[40:43], v[24:27], v[56:63], v9
    v_max3_f32 v14, abs(v96), abs(v97), abs(v98)
    v_mfma_f32_16x16x32_bf16 v[160:163], a[176:179], v[60:63], v[160:163]
    v_exp_f32 v65, v65
    v_mfma_f32_16x16x32_bf16 v[160:163], a[144:147], v[56:59], v[160:163]
    v_fma_f32 v101, v101, v12, v30
    v_cvt_pk_bf16_f32 v48, v64, v65
    v_mfma_f32_16x16x32_bf16 v[164:167], a[148:151], v[56:59], v[164:167]
    v_exp_f32 v66, v66
    v_mfma_f32_16x16x32_bf16 v[164:167], a[180:183], v[60:63], v[164:167]
    v_fma_f32 v102, v102, v12, v30
    v_fma_f32 v103, v103, v12, v30
    v_mfma_f32_16x16x32_bf16 v[168:171], a[184:187], v[60:63], v[168:171]
    v_exp_f32 v67, v67
    v_mfma_f32_16x16x32_bf16 v[168:171], a[152:155], v[56:59], v[168:171]
    buffer_store_dwordx4 v[244:247], v8, s[20:23], s34 offen offset:128 sc1
    v_mfma_f32_16x16x32_bf16 v[172:175], a[156:159], v[56:59], v[172:175]
    v_max3_f32 v14, v14, abs(v99), abs(v100)
    v_cvt_pk_bf16_f32 v49, v66, v67
    v_mfma_f32_16x16x32_bf16 v[172:175], a[188:191], v[60:63], v[172:175]
    v_exp_f32 v68, v68
    v_mfma_f32_16x16x32_bf16 v[72:75], a[112:115], a[48:51], -4.0
    v_fma_f32 v104, v104, v12, v30
    v_fma_f32 v105, v105, v12, v30
    v_mfma_f32_16x16x32_bf16 v[72:75], a[116:119], a[52:55], v[72:75]
    v_exp_f32 v69, v69
    v_mfma_f32_16x16x32_bf16 v[72:75], a[120:123], a[56:59], v[72:75]
    v_fma_f32 v106, v106, v12, v30
    v_cvt_pk_bf16_f32 v50, v68, v69
    v_mfma_f32_16x16x32_bf16 v[72:75], a[124:127], a[60:63], v[72:75]
    v_exp_f32 v70, v70
    v_mfma_f32_16x16x32_bf16 v[76:79], a[140:143], a[60:63], -4.0
    v_fma_f32 v107, v107, v12, v30
    v_fma_f32 v108, v108, v12, v30
    v_mfma_f32_16x16x32_bf16 v[76:79], a[136:139], a[56:59], v[76:79]
    v_exp_f32 v71, v71
    v_mfma_f32_16x16x32_bf16 v[76:79], a[132:135], a[52:55], v[76:79]
    s_waitcnt vmcnt(7)
    ds_read_b128 a[0:3], v15 offset:0
    v_cvt_pk_bf16_f32 v51, v70, v71
    v_mfma_f32_16x16x32_bf16 v[76:79], a[128:131], a[48:51], v[76:79]
    v_exp_f32 v72, v72
    v_mfma_f32_16x16x32_bf16 v[176:179], a[192:195], v[60:63], v[176:179]
    ds_read_b128 a[4:7], v15 offset:256
    v_fma_f32 v109, v109, v12, v30
    v_mfma_f32_16x16x32_bf16 v[176:179], a[160:163], v[56:59], v[176:179]
    v_exp_f32 v73, v73
    v_mfma_f32_16x16x32_bf16 v[180:183], a[164:167], v[56:59], v[180:183]
    ds_read_b128 a[8:11], v15 offset:512
    v_cvt_pk_bf16_f32 v52, v72, v73
    v_mfma_f32_16x16x32_bf16 v[180:183], a[196:199], v[60:63], v[180:183]
    buffer_store_dwordx4 v[248:251], v8, s[20:23], s34 offen offset:2176 sc1
    v_mfma_f32_16x16x32_bf16 v[184:187], a[200:203], v[60:63], v[184:187]
    s_add_u32 s34, s34, s38
    v_fma_f32 v110, v110, v12, v30
    v_fma_f32 v111, v111, v12, v30
    v_mfma_f32_16x16x32_bf16 v[184:187], a[168:171], v[56:59], v[184:187]
    v_exp_f32 v74, v74
    v_mfma_f32_16x16x32_bf16 v[188:191], a[172:175], v[56:59], v[188:191]
    ds_read_b128 a[12:15], v15 offset:768
    v_subrev_u32 v28, s30, v28
    v_mfma_f32_16x16x32_bf16 v[188:191], a[204:207], v[60:63], v[188:191]
    v_exp_f32 v75, v75
    v_mfma_f32_16x16x32_bf16 v[64:67], a[80:83], a[64:67], -4.0
    v_fma_f32 v14, v14, s42, v30
    v_cvt_pk_bf16_f32 v53, v74, v75
    v_mfma_f32_16x16x32_bf16 v[64:67], a[84:87], a[68:71], v[64:67]
    v_exp_f32 v76, v76
    v_mfma_f32_16x16x32_bf16 v[64:67], a[88:91], a[72:75], v[64:67]
    v_cvt_pk_bf16_f32 v96, v96, v97
    v_cvt_pk_bf16_f32 v104, v104, v105
    v_mfma_f32_16x16x32_bf16 v[64:67], a[92:95], a[76:79], v[64:67]
    v_exp_f32 v77, v77
    v_mfma_f32_16x16x32_bf16 v[68:71], a[108:111], a[76:79], -4.0
    v_exp_f32 v78, v78
    v_mfma_f32_16x16x32_bf16 v[68:71], a[104:107], a[72:75], v[68:71]
    v_exp_f32 v79, v79
    v_mfma_f32_16x16x32_bf16 v[68:71], a[100:103], a[68:71], v[68:71]
    v_cvt_pk_bf16_f32 v54, v76, v77
    v_cvt_pk_bf16_f32 v55, v78, v79
    v_mfma_f32_16x16x32_bf16 v[68:71], a[96:99], a[64:67], v[68:71]
    v_exp_f32 v64, v64
    v_smfmac_f32_16x16x64_bf16 v[42:45], v[24:27], v[48:55], v9
    s_mov_b32 m0, s26
    v_cvt_pk_bf16_f32 v97, v98, v99
    v_mfma_f32_16x16x32_bf16 v[192:195], a[176:179], v[52:55], v[192:195]
    v_exp_f32 v65, v65
    v_mfma_f32_16x16x32_bf16 v[192:195], a[144:147], v[48:51], v[192:195]
    v_cvt_pk_bf16_f32 v98, v100, v101
    v_cvt_pk_bf16_f32 v56, v64, v65
    v_mfma_f32_16x16x32_bf16 v[196:199], a[148:151], v[48:51], v[196:199]
    s_waitcnt lgkmcnt(0)
    buffer_load_dwordx4 v2, s[8:11], s33 offen offset:0 nt lds
    v_mfma_f32_16x16x32_bf16 v[196:199], a[180:183], v[52:55], v[196:199]
    v_exp_f32 v66, v66
    v_mfma_f32_16x16x32_bf16 v[200:203], a[184:187], v[52:55], v[200:203]
    v_cvt_pk_bf16_f32 v99, v102, v103
    v_cvt_pk_bf16_f32 v105, v106, v107
    v_mfma_f32_16x16x32_bf16 v[200:203], a[152:155], v[48:51], v[200:203]
    v_exp_f32 v67, v67
    v_mfma_f32_16x16x32_bf16 v[204:207], a[156:159], v[48:51], v[204:207]
    buffer_load_dwordx4 v2, s[8:11], s33 offen offset:1024 nt lds
    v_mfma_f32_16x16x32_bf16 v[204:207], a[188:191], v[52:55], v[204:207]
    v_exp_f32 v68, v68
    v_mfma_f32_16x16x32_bf16 v[72:75], a[112:115], a[64:67], -4.0
    v_cvt_pk_bf16_f32 v106, v108, v109
    v_cvt_pk_bf16_f32 v57, v66, v67
    v_mfma_f32_16x16x32_bf16 v[72:75], a[116:119], a[68:71], v[72:75]
    v_exp_f32 v69, v69
    v_mfma_f32_16x16x32_bf16 v[72:75], a[120:123], a[72:75], v[72:75]
    buffer_load_dwordx4 v2, s[8:11], s33 offen offset:2048 nt lds
    v_mfma_f32_16x16x32_bf16 v[72:75], a[124:127], a[76:79], v[72:75]
    v_exp_f32 v70, v70
    v_mfma_f32_16x16x32_bf16 v[76:79], a[140:143], a[76:79], -4.0
    v_cvt_pk_bf16_f32 v107, v110, v111
    v_cvt_pk_bf16_f32 v58, v68, v69
    v_mfma_f32_16x16x32_bf16 v[76:79], a[136:139], a[72:75], v[76:79]
    v_exp_f32 v71, v71
    v_mfma_f32_16x16x32_bf16 v[76:79], a[132:135], a[68:71], v[76:79]
    buffer_load_dwordx4 v2, s[8:11], s33 offen offset:3072 nt lds
    v_mfma_f32_16x16x32_bf16 v[76:79], a[128:131], a[64:67], v[76:79]
    s_add_u32 s33, s33, s38
    v_exp_f32 v72, v72
    v_mfma_f32_16x16x32_bf16 v[208:211], a[192:195], v[52:55], v[208:211]
L_st9:
    s_cbranch_execz L_st10
    v_and_or_b32 v14, v14, s43, v28
    v_cvt_pk_bf16_f32 v59, v70, v71
    v_mfma_f32_16x16x32_bf16 v[208:211], a[160:163], v[48:51], v[208:211]
    v_exp_f32 v73, v73
    v_mfma_f32_16x16x32_bf16 v[212:215], a[164:167], v[48:51], v[212:215]
    v_cmp_lt_u32_e64 s[4:5], s31, v14
    v_cvt_pk_bf16_f32 v60, v72, v73
    v_mfma_f32_16x16x32_bf16 v[212:215], a[196:199], v[52:55], v[212:215]
    v_exp_f32 v74, v74
    v_mfma_f32_16x16x32_bf16 v[216:219], a[200:203], v[52:55], v[216:219]
    v_cndmask_b32_dpp v100, v104, v96, vcc row_ror:8 row_mask:0xf bank_mask:0xf
    v_cndmask_b32_dpp v101, v105, v97, vcc row_ror:8 row_mask:0xf bank_mask:0xf
    v_mfma_f32_16x16x32_bf16 v[216:219], a[168:171], v[48:51], v[216:219]
    v_exp_f32 v75, v75
    v_mfma_f32_16x16x32_bf16 v[220:223], a[172:175], v[48:51], v[220:223]
    v_cndmask_b32_dpp v102, v106, v98, vcc row_ror:8 row_mask:0xf bank_mask:0xf
    v_cvt_pk_bf16_f32 v61, v74, v75
    v_mfma_f32_16x16x32_bf16 v[220:223], a[204:207], v[52:55], v[220:223]
    v_exp_f32 v76, v76
    v_mfma_f32_16x16x32_bf16 v[64:67], a[208:211], a[16:19], -4.0
    v_cndmask_b32_dpp v103, v107, v99, vcc row_ror:8 row_mask:0xf bank_mask:0xf
    v_mov_b32_dpp v104, v96 row_ror:8 row_mask:0xf bank_mask:0x3
    v_mfma_f32_16x16x32_bf16 v[64:67], a[212:215], a[20:23], v[64:67]
    v_exp_f32 v77, v77
    v_mfma_f32_16x16x32_bf16 v[64:67], a[216:219], a[24:27], v[64:67]
    v_mov_b32_dpp v105, v97 row_ror:8 row_mask:0xf bank_mask:0x3
    v_cvt_pk_bf16_f32 v62, v76, v77
    v_mfma_f32_16x16x32_bf16 v[64:67], a[220:223], a[28:31], v[64:67]
    v_exp_f32 v78, v78
    v_mfma_f32_16x16x32_bf16 v[68:71], a[236:239], a[28:31], -4.0
    v_mov_b32_dpp v106, v98 row_ror:8 row_mask:0xf bank_mask:0x3
    v_mov_b32_dpp v107, v99 row_ror:8 row_mask:0xf bank_mask:0x3
    v_mfma_f32_16x16x32_bf16 v[68:71], a[232:235], a[24:27], v[68:71]
    v_exp_f32 v79, v79
    v_mfma_f32_16x16x32_bf16 v[68:71], a[228:231], a[20:23], v[68:71]
    v_fma_f32 v112, v112, v12, v30
    v_cvt_pk_bf16_f32 v63, v78, v79
    v_mfma_f32_16x16x32_bf16 v[68:71], a[224:227], a[16:19], v[68:71]
    v_exp_f32 v64, v64
    v_smfmac_f32_16x16x64_bf16 v[44:47], v[24:27], v[56:63], v9
    s_barrier
    v_mfma_f32_16x16x32_bf16 v[224:227], a[176:179], v[60:63], v[32:35]
    v_exp_f32 v65, v65
    v_mfma_f32_16x16x32_bf16 v[224:227], a[144:147], v[56:59], v[224:227]
    ds_read_b64_tr_b16 a[176:177], v5 offset:8192
    v_cvt_pk_bf16_f32 v48, v64, v65
    v_mfma_f32_16x16x32_bf16 v[228:231], a[148:151], v[56:59], v[32:35]
    v_exp_f32 v66, v66
    v_mfma_f32_16x16x32_bf16 v[228:231], a[180:183], v[60:63], v[228:231]
    ds_read_b64_tr_b16 a[178:179], v5 offset:12288
    v_fma_f32 v113, v113, v12, v30
    v_mfma_f32_16x16x32_bf16 v[232:235], a[184:187], v[60:63], v[32:35]
    v_exp_f32 v67, v67
    v_mfma_f32_16x16x32_bf16 v[232:235], a[152:155], v[56:59], v[232:235]
    ds_read_b64_tr_b16 a[144:145], v5 offset:0
    v_cvt_pk_bf16_f32 v49, v66, v67
    v_mfma_f32_16x16x32_bf16 v[236:239], a[156:159], v[56:59], v[32:35]
    v_exp_f32 v68, v68
    v_mfma_f32_16x16x32_bf16 v[236:239], a[188:191], v[60:63], v[236:239]
    ds_read_b64_tr_b16 a[146:147], v5 offset:4096
    v_fma_f32 v114, v114, v12, v30
    v_mfma_f32_16x16x32_bf16 v[72:75], a[240:243], a[16:19], -4.0
    v_exp_f32 v69, v69
    v_mfma_f32_16x16x32_bf16 v[72:75], a[244:247], a[20:23], v[72:75]
    ds_read_b64_tr_b16 a[148:149], v5 offset:8
    v_cvt_pk_bf16_f32 v50, v68, v69
    v_mfma_f32_16x16x32_bf16 v[72:75], a[248:251], a[24:27], v[72:75]
    v_exp_f32 v70, v70
    v_mfma_f32_16x16x32_bf16 v[72:75], a[252:255], a[28:31], v[72:75]
    ds_read_b64_tr_b16 a[150:151], v5 offset:4104
    v_fma_f32 v115, v115, v12, v30
    v_mfma_f32_16x16x32_bf16 v[76:79], v[92:95], a[28:31], -4.0
    v_exp_f32 v71, v71
    v_mfma_f32_16x16x32_bf16 v[76:79], v[88:91], a[24:27], v[76:79]
    ds_read_b64_tr_b16 a[180:181], v5 offset:8200
    v_cvt_pk_bf16_f32 v51, v70, v71
    v_mfma_f32_16x16x32_bf16 v[76:79], v[84:87], a[20:23], v[76:79]
    v_exp_f32 v72, v72
    v_mfma_f32_16x16x32_bf16 v[76:79], v[80:83], a[16:19], v[76:79]
    ds_read_b64_tr_b16 a[182:183], v5 offset:12296
    ds_read_b64_tr_b16 a[184:185], v5 offset:8448
    v_mfma_f32_16x16x32_bf16 v[240:243], a[192:195], v[60:63], v[32:35]
    v_exp_f32 v73, v73
    v_mfma_f32_16x16x32_bf16 v[240:243], a[160:163], v[56:59], v[240:243]
    ds_read_b64_tr_b16 a[186:187], v5 offset:12544
    v_cvt_pk_bf16_f32 v52, v72, v73
    v_mfma_f32_16x16x32_bf16 v[244:247], a[164:167], v[56:59], v[32:35]
    v_exp_f32 v74, v74
    v_mfma_f32_16x16x32_bf16 v[244:247], a[196:199], v[60:63], v[244:247]
    ds_read_b64_tr_b16 a[152:153], v5 offset:256
    ds_read_b64_tr_b16 a[154:155], v5 offset:4352
    v_mfma_f32_16x16x32_bf16 v[248:251], a[200:203], v[60:63], v[32:35]
    v_exp_f32 v75, v75
    v_mfma_f32_16x16x32_bf16 v[248:251], a[168:171], v[56:59], v[248:251]
    ds_read_b64_tr_b16 a[156:157], v5 offset:264
    v_cvt_pk_bf16_f32 v53, v74, v75
    v_mfma_f32_16x16x32_bf16 v[252:255], a[172:175], v[56:59], v[32:35]
    v_exp_f32 v76, v76
    v_mfma_f32_16x16x32_bf16 v[252:255], a[204:207], v[60:63], v[252:255]
    ds_read_b64_tr_b16 a[158:159], v5 offset:4360
    ds_read_b64_tr_b16 a[188:189], v5 offset:8456
    v_mfma_f32_16x16x32_bf16 v[64:67], a[208:211], a[32:35], -4.0
    v_exp_f32 v77, v77
    v_mfma_f32_16x16x32_bf16 v[64:67], a[212:215], a[36:39], v[64:67]
    ds_read_b64_tr_b16 a[190:191], v5 offset:12552
    v_cvt_pk_bf16_f32 v54, v76, v77
    v_mfma_f32_16x16x32_bf16 v[64:67], a[216:219], a[40:43], v[64:67]
    v_exp_f32 v78, v78
    v_mfma_f32_16x16x32_bf16 v[64:67], a[220:223], a[44:47], v[64:67]
    ds_read_b64_tr_b16 a[192:193], v5 offset:8704
    ds_read_b64_tr_b16 a[194:195], v5 offset:12800
    v_mfma_f32_16x16x32_bf16 v[68:71], a[236:239], a[44:47], -4.0
    s_xor_b32 s37, s37, 1
    v_exp_f32 v79, v79
    v_mfma_f32_16x16x32_bf16 v[68:71], a[232:235], a[40:43], v[68:71]
    ds_read_b64_tr_b16 a[160:161], v5 offset:512
    v_cvt_pk_bf16_f32 v55, v78, v79
    v_mfma_f32_16x16x32_bf16 v[68:71], a[228:231], a[36:39], v[68:71]
    v_exp_f32 v64, v64
    v_mfma_f32_16x16x32_bf16 v[68:71], a[224:227], a[32:35], v[68:71]
    s_cbranch_scc1 L_loop
    v_smfmac_f32_16x16x64_bf16 v[38:41], v[24:27], v[48:55], v9
    s_waitcnt lgkmcnt(4)
    ds_read_b64_tr_b16 a[162:163], v5 offset:4608
    ds_read_b64_tr_b16 a[164:165], v5 offset:520
    v_mfma_f32_16x16x32_bf16 v[128:131], a[176:179], v[52:55], v[128:131]
    v_exp_f32 v65, v65
    v_mfma_f32_16x16x32_bf16 v[128:131], a[144:147], v[48:51], v[128:131]
    ds_read_b64_tr_b16 a[166:167], v5 offset:4616
    ds_read_b64_tr_b16 a[196:197], v5 offset:8712
    v_mfma_f32_16x16x32_bf16 v[132:135], a[148:151], v[48:51], v[132:135]
    v_exp_f32 v66, v66
    v_mfma_f32_16x16x32_bf16 v[132:135], a[180:183], v[52:55], v[132:135]
    ds_read_b64_tr_b16 a[198:199], v5 offset:12808
    v_add_f32 v29, v38, v39
    v_mfma_f32_16x16x32_bf16 v[136:139], a[184:187], v[52:55], v[136:139]
    v_rcp_f32 v13, v29
    v_mfma_f32_16x16x32_bf16 v[136:139], a[152:155], v[48:51], v[136:139]
    ds_read_b64_tr_b16 a[200:201], v5 offset:8960
    ds_read_b64_tr_b16 a[202:203], v5 offset:13056
    v_mfma_f32_16x16x32_bf16 v[140:143], a[156:159], v[48:51], v[140:143]
    s_waitcnt lgkmcnt(7)
    v_exp_f32 v67, v67
    v_mfma_f32_16x16x32_bf16 v[140:143], a[188:191], v[52:55], v[140:143]
    ds_read_b64_tr_b16 a[168:169], v5 offset:768
    ds_read_b64_tr_b16 a[170:171], v5 offset:4864
    v_mfma_f32_16x16x32_bf16 v[72:75], a[240:243], a[32:35], -4.0
    v_exp_f32 v68, v68
    v_mfma_f32_16x16x32_bf16 v[72:75], a[244:247], a[36:39], v[72:75]
    ds_read_b64_tr_b16 a[172:173], v5 offset:776
    v_mul_f32_e64 v31, -v32, v13
    v_mfma_f32_16x16x32_bf16 v[72:75], a[248:251], a[40:43], v[72:75]
    v_exp_f32 v69, v69
    v_mfma_f32_16x16x32_bf16 v[72:75], a[252:255], a[44:47], v[72:75]
    ds_read_b64_tr_b16 a[174:175], v5 offset:4872
    v_fma_f32 v128, v128, v13, v31
    v_mfma_f32_16x16x32_bf16 v[76:79], v[92:95], a[44:47], -4.0
    v_exp_f32 v70, v70
    v_mfma_f32_16x16x32_bf16 v[76:79], v[88:91], a[40:43], v[76:79]
    ds_read_b64_tr_b16 a[204:205], v5 offset:8968
    ds_read_b64_tr_b16 a[206:207], v5 offset:13064
    v_mfma_f32_16x16x32_bf16 v[76:79], v[84:87], a[36:39], v[76:79]
    v_exp_f32 v71, v71
    v_mfma_f32_16x16x32_bf16 v[76:79], v[80:83], a[32:35], v[76:79]
    v_fma_f32 v129, v129, v13, v31
    v_cvt_pk_bf16_f32 v56, v64, v65
    v_mfma_f32_16x16x32_bf16 v[144:147], a[192:195], v[52:55], v[144:147]
    s_waitcnt lgkmcnt(4)
    v_exp_f32 v72, v72
    v_mfma_f32_16x16x32_bf16 v[144:147], a[160:163], v[48:51], v[144:147]
    v_cvt_pk_bf16_f32 v57, v66, v67
    v_cvt_pk_bf16_f32 v58, v68, v69
    v_mfma_f32_16x16x32_bf16 v[148:151], a[164:167], v[48:51], v[148:151]
    v_exp_f32 v73, v73
    v_mfma_f32_16x16x32_bf16 v[148:151], a[196:199], v[52:55], v[148:151]
    v_cvt_pk_bf16_f32 v59, v70, v71
    v_fma_f32 v130, v130, v13, v31
    v_mfma_f32_16x16x32_bf16 v[152:155], a[200:203], v[52:55], v[152:155]
    v_exp_f32 v74, v74
    v_mfma_f32_16x16x32_bf16 v[152:155], a[168:171], v[48:51], v[152:155]
    s_waitcnt lgkmcnt(0)
    v_cvt_pk_bf16_f32 v60, v72, v73
    v_fma_f32 v131, v131, v13, v31
    v_mfma_f32_16x16x32_bf16 v[156:159], a[172:175], v[48:51], v[156:159]
    v_exp_f32 v75, v75
    v_mfma_f32_16x16x32_bf16 v[156:159], a[204:207], v[52:55], v[156:159]
    s_barrier
    v_mfma_f32_16x16x32_bf16 v[64:67], a[208:211], a[48:51], -4.0
    s_mov_b32 s35, 0x8000
    v_exp_f32 v76, v76
    v_mfma_f32_16x16x32_bf16 v[64:67], a[212:215], a[52:55], v[64:67]
    v_cvt_pk_bf16_f32 v61, v74, v75
    v_fma_f32 v132, v132, v13, v31
    v_mfma_f32_16x16x32_bf16 v[64:67], a[216:219], a[56:59], v[64:67]
    s_mov_b32 m0, s48
    v_exp_f32 v77, v77
    v_mfma_f32_16x16x32_bf16 v[64:67], a[220:223], a[60:63], v[64:67]
    v_exp_f32 v78, v78
    v_mfma_f32_16x16x32_bf16 v[68:71], a[236:239], a[60:63], -4.0
    v_exp_f32 v79, v79
    v_mfma_f32_16x16x32_bf16 v[68:71], a[232:235], a[56:59], v[68:71]
    buffer_load_dwordx4 v2, s[16:19], s35 offen offset:0 lds
    v_mfma_f32_16x16x32_bf16 v[68:71], a[228:231], a[52:55], v[68:71]
    v_cvt_pk_bf16_f32 v62, v76, v77
    v_cvt_pk_bf16_f32 v63, v78, v79
    v_mfma_f32_16x16x32_bf16 v[68:71], a[224:227], a[48:51], v[68:71]
    v_exp_f32 v64, v64
    v_smfmac_f32_16x16x64_bf16 v[40:43], v[24:27], v[56:63], v9
    v_fma_f32 v133, v133, v13, v31
    v_mfma_f32_16x16x32_bf16 v[160:163], a[176:179], v[60:63], v[160:163]
    buffer_load_dwordx4 v2, s[16:19], s35 offen offset:1024 lds
    v_mfma_f32_16x16x32_bf16 v[160:163], a[144:147], v[56:59], v[160:163]
    s_mov_b32 m0, s49
    v_exp_f32 v65, v65
    v_mfma_f32_16x16x32_bf16 v[164:167], a[148:151], v[56:59], v[164:167]
    s_mov_b32 s35, 0xa000
    v_fma_f32 v134, v134, v13, v31
    v_fma_f32 v135, v135, v13, v31
    v_mfma_f32_16x16x32_bf16 v[164:167], a[180:183], v[60:63], v[164:167]
    v_exp_f32 v66, v66
    v_mfma_f32_16x16x32_bf16 v[168:171], a[184:187], v[60:63], v[168:171]
    buffer_load_dwordx4 v2, s[16:19], s35 offen offset:0 lds
    v_mfma_f32_16x16x32_bf16 v[168:171], a[152:155], v[56:59], v[168:171]
    v_exp_f32 v67, v67
    v_mfma_f32_16x16x32_bf16 v[172:175], a[156:159], v[56:59], v[172:175]
    v_cvt_pk_bf16_f32 v48, v64, v65
    v_cvt_pk_bf16_f32 v49, v66, v67
    v_mfma_f32_16x16x32_bf16 v[172:175], a[188:191], v[60:63], v[172:175]
    v_exp_f32 v68, v68
    v_mfma_f32_16x16x32_bf16 v[72:75], a[240:243], a[48:51], -4.0
    buffer_load_dwordx4 v2, s[16:19], s35 offen offset:1024 lds
    v_mfma_f32_16x16x32_bf16 v[72:75], a[244:247], a[52:55], v[72:75]
    v_exp_f32 v69, v69
    v_mfma_f32_16x16x32_bf16 v[72:75], a[248:251], a[56:59], v[72:75]
    v_cvt_pk_bf16_f32 v50, v68, v69
    v_max3_f32 v14, abs(v128), abs(v129), abs(v130)
    v_mfma_f32_16x16x32_bf16 v[72:75], a[252:255], a[60:63], v[72:75]
    v_exp_f32 v70, v70
    v_mfma_f32_16x16x32_bf16 v[76:79], v[92:95], a[60:63], -4.0
    v_cvt_pk_bf16_f32 v128, v128, v129
    v_max3_f32 v14, v14, abs(v131), abs(v132)
    v_mfma_f32_16x16x32_bf16 v[76:79], v[88:91], a[56:59], v[76:79]
    v_exp_f32 v71, v71
    v_mfma_f32_16x16x32_bf16 v[76:79], v[84:87], a[52:55], v[76:79]
    v_cvt_pk_bf16_f32 v51, v70, v71
    v_cvt_pk_bf16_f32 v129, v130, v131
    v_mfma_f32_16x16x32_bf16 v[76:79], v[80:83], a[48:51], v[76:79]
    v_exp_f32 v72, v72
    v_mfma_f32_16x16x32_bf16 v[176:179], a[192:195], v[60:63], v[176:179]
    v_cvt_pk_bf16_f32 v130, v132, v133
    v_cvt_pk_bf16_f32 v131, v134, v135
    v_mfma_f32_16x16x32_bf16 v[176:179], a[160:163], v[56:59], v[176:179]
    v_exp_f32 v73, v73
    v_mfma_f32_16x16x32_bf16 v[180:183], a[164:167], v[56:59], v[180:183]
    v_cvt_pk_bf16_f32 v52, v72, v73
    v_fma_f32 v136, v136, v13, v31
    v_mfma_f32_16x16x32_bf16 v[180:183], a[196:199], v[60:63], v[180:183]
    v_exp_f32 v74, v74
    v_mfma_f32_16x16x32_bf16 v[184:187], a[200:203], v[60:63], v[184:187]
    v_fma_f32 v137, v137, v13, v31
    v_fma_f32 v138, v138, v13, v31
    v_mfma_f32_16x16x32_bf16 v[184:187], a[168:171], v[56:59], v[184:187]
    v_exp_f32 v75, v75
    v_mfma_f32_16x16x32_bf16 v[188:191], a[172:175], v[56:59], v[188:191]
    v_cvt_pk_bf16_f32 v53, v74, v75
    v_fma_f32 v139, v139, v13, v31
    v_mfma_f32_16x16x32_bf16 v[188:191], a[204:207], v[60:63], v[188:191]
    v_exp_f32 v76, v76
    v_mfma_f32_16x16x32_bf16 v[64:67], a[208:211], a[64:67], -4.0
    v_fma_f32 v116, v116, v12, v30
    v_fma_f32 v117, v117, v12, v30
    v_mfma_f32_16x16x32_bf16 v[64:67], a[212:215], a[68:71], v[64:67]
    v_exp_f32 v77, v77
    v_mfma_f32_16x16x32_bf16 v[64:67], a[216:219], a[72:75], v[64:67]
    v_cvt_pk_bf16_f32 v54, v76, v77
    v_fma_f32 v118, v118, v12, v30
    v_mfma_f32_16x16x32_bf16 v[64:67], a[220:223], a[76:79], v[64:67]
    v_exp_f32 v78, v78
    v_mfma_f32_16x16x32_bf16 v[68:71], a[236:239], a[76:79], -4.0
    v_fma_f32 v119, v119, v12, v30
    v_fma_f32 v120, v120, v12, v30
    v_mfma_f32_16x16x32_bf16 v[68:71], a[232:235], a[72:75], v[68:71]
    v_exp_f32 v79, v79
    v_mfma_f32_16x16x32_bf16 v[68:71], a[228:231], a[68:71], v[68:71]
    v_cvt_pk_bf16_f32 v55, v78, v79
    v_fma_f32 v121, v121, v12, v30
    v_mfma_f32_16x16x32_bf16 v[68:71], a[224:227], a[64:67], v[68:71]
    v_exp_f32 v64, v64
    v_smfmac_f32_16x16x64_bf16 v[42:45], v[24:27], v[48:55], v9
    v_fma_f32 v122, v122, v12, v30
    v_mfma_f32_16x16x32_bf16 v[192:195], a[176:179], v[52:55], v[192:195]
    v_exp_f32 v65, v65
    v_mfma_f32_16x16x32_bf16 v[192:195], a[144:147], v[48:51], v[192:195]
    v_cvt_pk_bf16_f32 v56, v64, v65
    v_fma_f32 v123, v123, v12, v30
    v_mfma_f32_16x16x32_bf16 v[196:199], a[148:151], v[48:51], v[196:199]
    v_exp_f32 v66, v66
    v_mfma_f32_16x16x32_bf16 v[196:199], a[180:183], v[52:55], v[196:199]
    v_fma_f32 v124, v124, v12, v30
    v_fma_f32 v125, v125, v12, v30
    v_mfma_f32_16x16x32_bf16 v[200:203], a[184:187], v[52:55], v[200:203]
    v_exp_f32 v67, v67
    v_mfma_f32_16x16x32_bf16 v[200:203], a[152:155], v[48:51], v[200:203]
    v_cvt_pk_bf16_f32 v57, v66, v67
    v_fma_f32 v126, v126, v12, v30
    v_mfma_f32_16x16x32_bf16 v[204:207], a[156:159], v[48:51], v[204:207]
    v_exp_f32 v68, v68
    v_mfma_f32_16x16x32_bf16 v[204:207], a[188:191], v[52:55], v[204:207]
    buffer_store_dwordx4 v[100:103], v8, s[20:23], s34 offen offset:0 sc1
    v_mfma_f32_16x16x32_bf16 v[72:75], a[240:243], a[64:67], -4.0
    v_fma_f32 v127, v127, v12, v30
    v_cvt_pk_bf16_f32 v112, v112, v113
    v_mfma_f32_16x16x32_bf16 v[72:75], a[244:247], a[68:71], v[72:75]
    s_cmp_lg_u64 s[4:5], 0
    v_exp_f32 v69, v69
    v_mfma_f32_16x16x32_bf16 v[72:75], a[248:251], a[72:75], v[72:75]
    s_addc_u32 s32, s32, s32
    v_cvt_pk_bf16_f32 v58, v68, v69
    v_cvt_pk_bf16_f32 v113, v114, v115
    v_mfma_f32_16x16x32_bf16 v[72:75], a[252:255], a[76:79], v[72:75]
    v_exp_f32 v70, v70
    v_mfma_f32_16x16x32_bf16 v[76:79], v[92:95], a[76:79], -4.0
    v_cvt_pk_bf16_f32 v114, v116, v117
    v_cvt_pk_bf16_f32 v115, v118, v119
    v_mfma_f32_16x16x32_bf16 v[76:79], v[88:91], a[72:75], v[76:79]
    v_exp_f32 v71, v71
    v_mfma_f32_16x16x32_bf16 v[76:79], v[84:87], a[68:71], v[76:79]
    v_cvt_pk_bf16_f32 v59, v70, v71
    v_cvt_pk_bf16_f32 v120, v120, v121
    v_mfma_f32_16x16x32_bf16 v[76:79], v[80:83], a[64:67], v[76:79]
    v_exp_f32 v72, v72
    v_mfma_f32_16x16x32_bf16 v[208:211], a[192:195], v[52:55], v[208:211]
    v_cvt_pk_bf16_f32 v121, v122, v123
    v_cndmask_b32_dpp v116, v120, v112, vcc row_ror:8 row_mask:0xf bank_mask:0xf
    v_mfma_f32_16x16x32_bf16 v[208:211], a[160:163], v[48:51], v[208:211]
    v_exp_f32 v73, v73
    v_mfma_f32_16x16x32_bf16 v[212:215], a[164:167], v[48:51], v[212:215]
    v_cvt_pk_bf16_f32 v60, v72, v73
    v_cvt_pk_bf16_f32 v122, v124, v125
    v_mfma_f32_16x16x32_bf16 v[212:215], a[196:199], v[52:55], v[212:215]
    v_exp_f32 v74, v74
    v_mfma_f32_16x16x32_bf16 v[216:219], a[200:203], v[52:55], v[216:219]
    v_cvt_pk_bf16_f32 v123, v126, v127
    v_cndmask_b32_dpp v117, v121, v113, vcc row_ror:8 row_mask:0xf bank_mask:0xf
    v_mfma_f32_16x16x32_bf16 v[216:219], a[168:171], v[48:51], v[216:219]
    v_exp_f32 v75, v75
    v_mfma_f32_16x16x32_bf16 v[220:223], a[172:175], v[48:51], v[220:223]
    v_cvt_pk_bf16_f32 v61, v74, v75
    v_cndmask_b32_dpp v118, v122, v114, vcc row_ror:8 row_mask:0xf bank_mask:0xf
    v_mfma_f32_16x16x32_bf16 v[220:223], a[204:207], v[52:55], v[220:223]
    buffer_store_dwordx4 v[104:107], v8, s[20:23], s34 offen offset:2048 sc1
    v_mfma_f32_16x16x32_bf16 v[64:67], a[208:211], a[0:3], -4.0
    v_cndmask_b32_dpp v119, v123, v115, vcc row_ror:8 row_mask:0xf bank_mask:0xf
    v_fma_f32 v140, v140, v13, v31
    v_mfma_f32_16x16x32_bf16 v[64:67], a[212:215], a[4:7], v[64:67]
    v_exp_f32 v76, v76
    v_mfma_f32_16x16x32_bf16 v[64:67], a[216:219], a[8:11], v[64:67]
    ds_read_b128 a[80:83], v3 offset:16384
    v_fma_f32 v141, v141, v13, v31
    v_mfma_f32_16x16x32_bf16 v[64:67], a[220:223], a[12:15], v[64:67]
    v_exp_f32 v77, v77
    v_mfma_f32_16x16x32_bf16 v[68:71], a[236:239], a[12:15], -4.0
    v_exp_f32 v78, v78
    v_mfma_f32_16x16x32_bf16 v[68:71], a[232:235], a[8:11], v[68:71]
    v_exp_f32 v79, v79
    v_mfma_f32_16x16x32_bf16 v[68:71], a[228:231], a[4:7], v[68:71]
    v_cvt_pk_bf16_f32 v62, v76, v77
    v_cvt_pk_bf16_f32 v63, v78, v79
    v_mfma_f32_16x16x32_bf16 v[68:71], a[224:227], a[0:3], v[68:71]
    v_exp_f32 v64, v64
    v_smfmac_f32_16x16x64_bf16 v[44:47], v[24:27], v[56:63], v9
    ds_read_b128 a[84:87], v3 offset:17408
    v_fma_f32 v142, v142, v13, v31
    v_mfma_f32_16x16x32_bf16 v[224:227], a[176:179], v[60:63], v[224:227]
    v_exp_f32 v65, v65
    v_mfma_f32_16x16x32_bf16 v[224:227], a[144:147], v[56:59], v[224:227]
    ds_read_b128 a[88:91], v3 offset:18432
    v_cvt_pk_bf16_f32 v48, v64, v65
    v_mfma_f32_16x16x32_bf16 v[228:231], a[148:151], v[56:59], v[228:231]
    v_exp_f32 v66, v66
    v_mfma_f32_16x16x32_bf16 v[228:231], a[180:183], v[60:63], v[228:231]
    ds_read_b128 a[92:95], v3 offset:19456
    v_mov_b32_dpp v120, v112 row_ror:8 row_mask:0xf bank_mask:0x3
    v_mfma_f32_16x16x32_bf16 v[232:235], a[184:187], v[60:63], v[232:235]
    v_exp_f32 v67, v67
    v_mfma_f32_16x16x32_bf16 v[232:235], a[152:155], v[56:59], v[232:235]
    ds_read_b128 a[108:111], v3 offset:23552
    ds_read_b128 a[104:107], v3 offset:22528
    v_mfma_f32_16x16x32_bf16 v[236:239], a[156:159], v[56:59], v[236:239]
    v_exp_f32 v68, v68
    v_mfma_f32_16x16x32_bf16 v[236:239], a[188:191], v[60:63], v[236:239]
    ds_read_b128 a[100:103], v3 offset:21504
    v_cvt_pk_bf16_f32 v49, v66, v67
    v_mfma_f32_16x16x32_bf16 v[72:75], a[240:243], a[0:3], -4.0
    buffer_store_dwordx4 v[116:119], v8, s[20:23], s34 offen offset:128 sc1
    v_mfma_f32_16x16x32_bf16 v[72:75], a[244:247], a[4:7], v[72:75]
    v_mov_b32_dpp v121, v113 row_ror:8 row_mask:0xf bank_mask:0x3
    v_mov_b32_dpp v122, v114 row_ror:8 row_mask:0xf bank_mask:0x3
    v_mfma_f32_16x16x32_bf16 v[72:75], a[248:251], a[8:11], v[72:75]
    v_exp_f32 v69, v69
    v_mfma_f32_16x16x32_bf16 v[72:75], a[252:255], a[12:15], v[72:75]
    v_cvt_pk_bf16_f32 v50, v68, v69
    v_mov_b32_dpp v123, v115 row_ror:8 row_mask:0xf bank_mask:0x3
    v_mfma_f32_16x16x32_bf16 v[76:79], v[92:95], a[12:15], -4.0
    v_exp_f32 v70, v70
    v_mfma_f32_16x16x32_bf16 v[76:79], v[88:91], a[8:11], v[76:79]
    ds_read_b128 a[96:99], v3 offset:20480
    v_fma_f32 v143, v143, v13, v31
    v_mfma_f32_16x16x32_bf16 v[76:79], v[84:87], a[4:7], v[76:79]
    v_exp_f32 v71, v71
    v_mfma_f32_16x16x32_bf16 v[76:79], v[80:83], a[0:3], v[76:79]
    v_cvt_pk_bf16_f32 v51, v70, v71
    v_cvt_pk_bf16_f32 v136, v136, v137
    v_mfma_f32_16x16x32_bf16 v[240:243], a[192:195], v[60:63], v[240:243]
    v_exp_f32 v72, v72
    v_mfma_f32_16x16x32_bf16 v[240:243], a[160:163], v[56:59], v[240:243]
    ds_read_b128 a[112:115], v3 offset:24576
    v_cvt_pk_bf16_f32 v137, v138, v139
    v_mfma_f32_16x16x32_bf16 v[244:247], a[164:167], v[56:59], v[244:247]
    v_exp_f32 v73, v73
    v_mfma_f32_16x16x32_bf16 v[244:247], a[196:199], v[60:63], v[244:247]
    ds_read_b128 a[116:119], v3 offset:25600
    v_cvt_pk_bf16_f32 v52, v72, v73
    v_mfma_f32_16x16x32_bf16 v[248:251], a[200:203], v[60:63], v[248:251]
    v_exp_f32 v74, v74
    v_mfma_f32_16x16x32_bf16 v[248:251], a[168:171], v[56:59], v[248:251]
    ds_read_b128 a[120:123], v3 offset:26624
    ds_read_b128 a[124:127], v3 offset:27648
    v_mfma_f32_16x16x32_bf16 v[252:255], a[172:175], v[56:59], v[252:255]
    v_exp_f32 v75, v75
    v_mfma_f32_16x16x32_bf16 v[252:255], a[204:207], v[60:63], v[252:255]
    s_waitcnt lgkmcnt(4)
    ds_read_b128 a[140:143], v3 offset:31744
    v_cvt_pk_bf16_f32 v53, v74, v75
    v_mfma_f32_16x16x32_bf16 v[64:67], a[80:83], a[32:35], -4.0
    buffer_store_dwordx4 v[120:123], v8, s[20:23], s34 offen offset:2176 sc1
    v_mfma_f32_16x16x32_bf16 v[64:67], a[84:87], a[36:39], v[64:67]
    s_add_u32 s34, s34, s38
    ds_read_b128 a[136:139], v3 offset:30720
    ds_read_b128 a[132:135], v3 offset:29696
    v_mfma_f32_16x16x32_bf16 v[64:67], a[88:91], a[40:43], v[64:67]
    v_exp_f32 v76, v76
    v_mfma_f32_16x16x32_bf16 v[64:67], a[92:95], a[44:47], v[64:67]
    v_exp_f32 v77, v77
    v_mfma_f32_16x16x32_bf16 v[68:71], a[108:111], a[44:47], -4.0
    v_exp_f32 v78, v78
    v_mfma_f32_16x16x32_bf16 v[68:71], a[104:107], a[40:43], v[68:71]
    v_exp_f32 v79, v79
    v_mfma_f32_16x16x32_bf16 v[68:71], a[100:103], a[36:39], v[68:71]
    v_cvt_pk_bf16_f32 v54, v76, v77
    v_cvt_pk_bf16_f32 v55, v78, v79
    v_mfma_f32_16x16x32_bf16 v[68:71], a[96:99], a[32:35], v[68:71]
    s_waitcnt vmcnt(16)
    v_exp_f32 v64, v64
    v_smfmac_f32_16x16x64_bf16 v[36:39], v[24:27], v[48:55], v9
    s_barrier
    v_mfma_f32_16x16x32_bf16 v[96:99], a[176:179], v[52:55], v[32:35]
    v_exp_f32 v65, v65
    v_mfma_f32_16x16x32_bf16 v[96:99], a[144:147], v[48:51], v[96:99]
    ds_read_b128 a[128:131], v3 offset:28672
    v_cvt_pk_bf16_f32 v138, v140, v141
    v_mfma_f32_16x16x32_bf16 v[100:103], a[148:151], v[48:51], v[32:35]
    v_exp_f32 v66, v66
    v_mfma_f32_16x16x32_bf16 v[100:103], a[180:183], v[52:55], v[100:103]
    v_cvt_pk_bf16_f32 v139, v142, v143
    v_cvt_pk_bf16_f32 v56, v64, v65
    v_mfma_f32_16x16x32_bf16 v[104:107], a[184:187], v[52:55], v[32:35]
    v_exp_f32 v67, v67
    v_mfma_f32_16x16x32_bf16 v[104:107], a[152:155], v[48:51], v[104:107]
    ds_read_b64_tr_b16 a[176:177], v5 offset:24576
    v_cvt_pk_bf16_f32 v57, v66, v67
    v_mfma_f32_16x16x32_bf16 v[108:111], a[156:159], v[48:51], v[32:35]
    v_exp_f32 v68, v68
    v_mfma_f32_16x16x32_bf16 v[108:111], a[188:191], v[52:55], v[108:111]
    s_waitcnt lgkmcnt(2)
    ds_read_b64_tr_b16 a[178:179], v5 offset:28672
    v_subrev_u32 v29, s30, v29
    v_mfma_f32_16x16x32_bf16 v[72:75], a[112:115], a[32:35], -4.0
    v_exp_f32 v69, v69
    v_mfma_f32_16x16x32_bf16 v[72:75], a[116:119], a[36:39], v[72:75]
    ds_read_b64_tr_b16 a[144:145], v5 offset:16384
    v_cvt_pk_bf16_f32 v58, v68, v69
    v_mfma_f32_16x16x32_bf16 v[72:75], a[120:123], a[40:43], v[72:75]
    v_exp_f32 v70, v70
    v_mfma_f32_16x16x32_bf16 v[72:75], a[124:127], a[44:47], v[72:75]
    ds_read_b64_tr_b16 a[146:147], v5 offset:20480
    ds_read_b64_tr_b16 a[148:149], v5 offset:16392
    v_mfma_f32_16x16x32_bf16 v[76:79], a[140:143], a[44:47], -4.0
    v_exp_f32 v71, v71
    v_mfma_f32_16x16x32_bf16 v[76:79], a[136:139], a[40:43], v[76:79]
    ds_read_b64_tr_b16 a[150:151], v5 offset:20488
    v_cvt_pk_bf16_f32 v59, v70, v71
    v_mfma_f32_16x16x32_bf16 v[76:79], a[132:135], a[36:39], v[76:79]
    s_waitcnt lgkmcnt(5)
    v_exp_f32 v72, v72
    v_mfma_f32_16x16x32_bf16 v[76:79], a[128:131], a[32:35], v[76:79]
    ds_read_b64_tr_b16 a[180:181], v5 offset:24584
    ds_read_b64_tr_b16 a[182:183], v5 offset:28680
    v_mfma_f32_16x16x32_bf16 v[112:115], a[192:195], v[52:55], v[32:35]
    v_exp_f32 v73, v73
    v_mfma_f32_16x16x32_bf16 v[112:115], a[160:163], v[48:51], v[112:115]
    ds_read_b64_tr_b16 a[184:185], v5 offset:24832
    ds_read_b64_tr_b16 a[186:187], v5 offset:28928
    v_mfma_f32_16x16x32_bf16 v[116:119], a[164:167], v[48:51], v[32:35]
    v_exp_f32 v74, v74
    v_mfma_f32_16x16x32_bf16 v[116:119], a[196:199], v[52:55], v[116:119]
    ds_read_b64_tr_b16 a[152:153], v5 offset:16640
    v_cvt_pk_bf16_f32 v60, v72, v73
    v_mfma_f32_16x16x32_bf16 v[120:123], a[200:203], v[52:55], v[32:35]
    v_exp_f32 v75, v75
    v_mfma_f32_16x16x32_bf16 v[120:123], a[168:171], v[48:51], v[120:123]
    ds_read_b64_tr_b16 a[154:155], v5 offset:20736
    v_cvt_pk_bf16_f32 v61, v74, v75
    v_mfma_f32_16x16x32_bf16 v[124:127], a[172:175], v[48:51], v[32:35]
    v_exp_f32 v76, v76
    v_mfma_f32_16x16x32_bf16 v[124:127], a[204:207], v[52:55], v[124:127]
    ds_read_b64_tr_b16 a[156:157], v5 offset:16648
    ds_read_b64_tr_b16 a[158:159], v5 offset:20744
    v_mfma_f32_16x16x32_bf16 v[64:67], a[80:83], a[48:51], -4.0
    v_exp_f32 v77, v77
    v_mfma_f32_16x16x32_bf16 v[64:67], a[84:87], a[52:55], v[64:67]
    ds_read_b64_tr_b16 a[188:189], v5 offset:24840
    v_cvt_pk_bf16_f32 v62, v76, v77
    v_mfma_f32_16x16x32_bf16 v[64:67], a[88:91], a[56:59], v[64:67]
    v_exp_f32 v78, v78
    v_mfma_f32_16x16x32_bf16 v[64:67], a[92:95], a[60:63], v[64:67]
    ds_read_b64_tr_b16 a[190:191], v5 offset:28936
    ds_read_b64_tr_b16 a[192:193], v5 offset:25088
    v_mfma_f32_16x16x32_bf16 v[68:71], a[108:111], a[60:63], -4.0
    v_exp_f32 v79, v79
    v_mfma_f32_16x16x32_bf16 v[68:71], a[104:107], a[56:59], v[68:71]
    ds_read_b64_tr_b16 a[194:195], v5 offset:29184
    v_cvt_pk_bf16_f32 v63, v78, v79
    v_mfma_f32_16x16x32_bf16 v[68:71], a[100:103], a[52:55], v[68:71]
    v_exp_f32 v64, v64
    v_mfma_f32_16x16x32_bf16 v[68:71], a[96:99], a[48:51], v[68:71]
    ds_read_b64_tr_b16 a[160:161], v5 offset:16896
    ds_read_b64_tr_b16 a[162:163], v5 offset:20992
    v_smfmac_f32_16x16x64_bf16 v[40:43], v[24:27], v[56:63], v9
    s_waitcnt lgkmcnt(6)
    ds_read_b64_tr_b16 a[164:165], v5 offset:16904
    ds_read_b64_tr_b16 a[166:167], v5 offset:21000
    v_mfma_f32_16x16x32_bf16 v[160:163], a[176:179], v[60:63], v[160:163]
    v_exp_f32 v65, v65
    v_mfma_f32_16x16x32_bf16 v[160:163], a[144:147], v[56:59], v[160:163]
    ds_read_b64_tr_b16 a[196:197], v5 offset:25096
    ds_read_b64_tr_b16 a[198:199], v5 offset:29192
    v_mfma_f32_16x16x32_bf16 v[164:167], a[148:151], v[56:59], v[164:167]
    v_exp_f32 v66, v66
    v_mfma_f32_16x16x32_bf16 v[164:167], a[180:183], v[60:63], v[164:167]
    ds_read_b64_tr_b16 a[200:201], v5 offset:25344
    ds_read_b64_tr_b16 a[202:203], v5 offset:29440
    v_mfma_f32_16x16x32_bf16 v[168:171], a[184:187], v[60:63], v[168:171]
    v_exp_f32 v67, v67
    v_mfma_f32_16x16x32_bf16 v[168:171], a[152:155], v[56:59], v[168:171]
    v_fma_f32 v14, v14, s42, v31
    v_cndmask_b32_dpp v132, v136, v128, vcc row_ror:8 row_mask:0xf bank_mask:0xf
    v_mfma_f32_16x16x32_bf16 v[172:175], a[156:159], v[56:59], v[172:175]
    s_waitcnt lgkmcnt(6)
    v_exp_f32 v68, v68
    v_mfma_f32_16x16x32_bf16 v[172:175], a[188:191], v[60:63], v[172:175]
    v_cndmask_b32_dpp v133, v137, v129, vcc row_ror:8 row_mask:0xf bank_mask:0xf
    v_cndmask_b32_dpp v134, v138, v130, vcc row_ror:8 row_mask:0xf bank_mask:0xf
    v_mfma_f32_16x16x32_bf16 v[72:75], a[112:115], a[48:51], -4.0
    v_exp_f32 v69, v69
    v_mfma_f32_16x16x32_bf16 v[72:75], a[116:119], a[52:55], v[72:75]
    v_cndmask_b32_dpp v135, v139, v131, vcc row_ror:8 row_mask:0xf bank_mask:0xf
    v_fma_f32 v144, v144, v13, v31
    v_mfma_f32_16x16x32_bf16 v[72:75], a[120:123], a[56:59], v[72:75]
    v_exp_f32 v70, v70
    v_mfma_f32_16x16x32_bf16 v[72:75], a[124:127], a[60:63], v[72:75]
    ds_read_b64_tr_b16 a[168:169], v5 offset:17152
    ds_read_b64_tr_b16 a[170:171], v5 offset:21248
    v_mfma_f32_16x16x32_bf16 v[76:79], a[140:143], a[60:63], -4.0
    buffer_store_dwordx4 v[132:135], v8, s[20:23], s34 offen offset:0 sc1
    v_mfma_f32_16x16x32_bf16 v[76:79], a[136:139], a[56:59], v[76:79]
    ds_read_b64_tr_b16 a[172:173], v5 offset:17160
    v_and_or_b32 v14, v14, s43, v29
    v_mfma_f32_16x16x32_bf16 v[76:79], a[132:135], a[52:55], v[76:79]
L_st10:
    s_cbranch_execz L_st11
    ds_read_b64_tr_b16 a[174:175], v5 offset:21256
    v_cmp_lt_u32_e64 s[4:5], s31, v14
    v_mfma_f32_16x16x32_bf16 v[76:79], a[128:131], a[48:51], v[76:79]
    s_cmp_lg_u64 s[4:5], 0
    ds_read_b64_tr_b16 a[204:205], v5 offset:25352
    ds_read_b64_tr_b16 a[206:207], v5 offset:29448
    v_fma_f32 v145, v145, v13, v31
    v_mfma_f32_16x16x32_bf16 v[176:179], a[192:195], v[60:63], v[176:179]
    s_addc_u32 s32, s32, s32
    v_exp_f32 v71, v71
    v_mfma_f32_16x16x32_bf16 v[176:179], a[160:163], v[56:59], v[176:179]
    s_waitcnt lgkmcnt(6)
    v_fma_f32 v146, v146, v13, v31
    v_fma_f32 v147, v147, v13, v31
    v_mfma_f32_16x16x32_bf16 v[180:183], a[164:167], v[56:59], v[180:183]
    v_exp_f32 v72, v72
    v_mfma_f32_16x16x32_bf16 v[180:183], a[196:199], v[60:63], v[180:183]
    v_fma_f32 v148, v148, v13, v31
    v_fma_f32 v149, v149, v13, v31
    v_mfma_f32_16x16x32_bf16 v[184:187], a[200:203], v[60:63], v[184:187]
    s_waitcnt lgkmcnt(4)
    v_exp_f32 v73, v73
    v_mfma_f32_16x16x32_bf16 v[184:187], a[168:171], v[56:59], v[184:187]
    s_waitcnt lgkmcnt(2)
    v_cvt_pk_bf16_f32 v48, v64, v65
    v_cvt_pk_bf16_f32 v49, v66, v67
    v_mfma_f32_16x16x32_bf16 v[188:191], a[172:175], v[56:59], v[188:191]
    s_waitcnt lgkmcnt(0)
    v_cvt_pk_bf16_f32 v50, v68, v69
    v_cvt_pk_bf16_f32 v51, v70, v71
    v_mfma_f32_16x16x32_bf16 v[188:191], a[204:207], v[60:63], v[188:191]
    s_barrier
    v_mfma_f32_16x16x32_bf16 v[64:67], a[80:83], a[64:67], -4.0
    s_mov_b32 s35, 0xc000
    v_exp_f32 v74, v74
    v_mfma_f32_16x16x32_bf16 v[64:67], a[84:87], a[68:71], v[64:67]
    v_fma_f32 v150, v150, v13, v31
    v_fma_f32 v151, v151, v13, v31
    v_mfma_f32_16x16x32_bf16 v[64:67], a[88:91], a[72:75], v[64:67]
    s_mov_b32 m0, s50
    v_exp_f32 v75, v75
    v_mfma_f32_16x16x32_bf16 v[64:67], a[92:95], a[76:79], v[64:67]
    v_mov_b32_dpp v136, v128 row_ror:8 row_mask:0xf bank_mask:0x3
    v_mov_b32_dpp v137, v129 row_ror:8 row_mask:0xf bank_mask:0x3
    v_mfma_f32_16x16x32_bf16 v[68:71], a[108:111], a[76:79], -4.0
    v_mov_b32_dpp v138, v130 row_ror:8 row_mask:0xf bank_mask:0x3
    v_mov_b32_dpp v139, v131 row_ror:8 row_mask:0xf bank_mask:0x3
    v_mfma_f32_16x16x32_bf16 v[68:71], a[104:107], a[72:75], v[68:71]
    buffer_store_dwordx4 v[136:139], v8, s[20:23], s34 offen offset:2048 sc1
    v_cvt_pk_bf16_f32 v144, v144, v145
    v_exp_f32 v76, v76
    v_exp_f32 v77, v77
    v_exp_f32 v78, v78
    v_exp_f32 v79, v79
    v_mfma_f32_16x16x32_bf16 v[68:71], a[100:103], a[68:71], v[68:71]
    v_cvt_pk_bf16_f32 v52, v72, v73
    v_cvt_pk_bf16_f32 v53, v74, v75
    v_cvt_pk_bf16_f32 v54, v76, v77
    v_cvt_pk_bf16_f32 v55, v78, v79
    v_mfma_f32_16x16x32_bf16 v[68:71], a[96:99], a[64:67], v[68:71]
    buffer_load_dwordx4 v2, s[16:19], s35 offen offset:0 lds
    v_cvt_pk_bf16_f32 v145, v146, v147
    v_smfmac_f32_16x16x64_bf16 v[42:45], v[24:27], v[48:55], v9
    v_cvt_pk_bf16_f32 v146, v148, v149
    v_mfma_f32_16x16x32_bf16 v[192:195], a[176:179], v[52:55], v[192:195]
    v_exp_f32 v64, v64
    v_mfma_f32_16x16x32_bf16 v[192:195], a[144:147], v[48:51], v[192:195]
    buffer_load_dwordx4 v2, s[16:19], s35 offen offset:1024 lds
    v_cvt_pk_bf16_f32 v147, v150, v151
    v_mfma_f32_16x16x32_bf16 v[196:199], a[148:151], v[48:51], v[196:199]
    s_mov_b32 m0, s51
    v_exp_f32 v65, v65
    v_mfma_f32_16x16x32_bf16 v[196:199], a[180:183], v[52:55], v[196:199]
    s_mov_b32 s35, 0xe000
    v_fma_f32 v152, v152, v13, v31
    v_fma_f32 v153, v153, v13, v31
    v_mfma_f32_16x16x32_bf16 v[200:203], a[184:187], v[52:55], v[200:203]
    v_exp_f32 v66, v66
    v_mfma_f32_16x16x32_bf16 v[200:203], a[152:155], v[48:51], v[200:203]
    buffer_load_dwordx4 v2, s[16:19], s35 offen offset:0 lds
    v_fma_f32 v154, v154, v13, v31
    v_mfma_f32_16x16x32_bf16 v[204:207], a[156:159], v[48:51], v[204:207]
    v_exp_f32 v67, v67
    v_mfma_f32_16x16x32_bf16 v[204:207], a[188:191], v[52:55], v[204:207]
    v_fma_f32 v155, v155, v13, v31
    v_fma_f32 v156, v156, v13, v31
    v_mfma_f32_16x16x32_bf16 v[72:75], a[112:115], a[64:67], -4.0
    v_exp_f32 v68, v68
    v_mfma_f32_16x16x32_bf16 v[72:75], a[116:119], a[68:71], v[72:75]
    buffer_load_dwordx4 v2, s[16:19], s35 offen offset:1024 lds
    v_fma_f32 v157, v157, v13, v31
    v_mfma_f32_16x16x32_bf16 v[72:75], a[120:123], a[72:75], v[72:75]
    v_exp_f32 v69, v69
    v_mfma_f32_16x16x32_bf16 v[72:75], a[124:127], a[76:79], v[72:75]
    v_fma_f32 v158, v158, v13, v31
    v_fma_f32 v159, v159, v13, v31
    v_mfma_f32_16x16x32_bf16 v[76:79], a[140:143], a[76:79], -4.0
    v_exp_f32 v70, v70
    v_mfma_f32_16x16x32_bf16 v[76:79], a[136:139], a[72:75], v[76:79]
    v_cvt_pk_bf16_f32 v152, v152, v153
    v_cvt_pk_bf16_f32 v56, v64, v65
    v_mfma_f32_16x16x32_bf16 v[76:79], a[132:135], a[68:71], v[76:79]
    v_exp_f32 v71, v71
    v_mfma_f32_16x16x32_bf16 v[76:79], a[128:131], a[64:67], v[76:79]
    v_cvt_pk_bf16_f32 v57, v66, v67
    v_cvt_pk_bf16_f32 v58, v68, v69
    v_mfma_f32_16x16x32_bf16 v[208:211], a[192:195], v[52:55], v[208:211]
    v_exp_f32 v72, v72
    v_mfma_f32_16x16x32_bf16 v[208:211], a[160:163], v[48:51], v[208:211]
    v_cvt_pk_bf16_f32 v59, v70, v71
    v_cvt_pk_bf16_f32 v153, v154, v155
    v_mfma_f32_16x16x32_bf16 v[212:215], a[164:167], v[48:51], v[212:215]
    v_exp_f32 v73, v73
    v_mfma_f32_16x16x32_bf16 v[212:215], a[196:199], v[52:55], v[212:215]
    v_cvt_pk_bf16_f32 v154, v156, v157
    v_cvt_pk_bf16_f32 v155, v158, v159
    v_mfma_f32_16x16x32_bf16 v[216:219], a[200:203], v[52:55], v[216:219]
    v_exp_f32 v74, v74
    v_mfma_f32_16x16x32_bf16 v[216:219], a[168:171], v[48:51], v[216:219]
    v_cvt_pk_bf16_f32 v60, v72, v73
    v_cndmask_b32_dpp v148, v152, v144, vcc row_ror:8 row_mask:0xf bank_mask:0xf
    v_mfma_f32_16x16x32_bf16 v[220:223], a[172:175], v[48:51], v[220:223]
    v_exp_f32 v75, v75
    v_mfma_f32_16x16x32_bf16 v[220:223], a[204:207], v[52:55], v[220:223]
    v_cvt_pk_bf16_f32 v61, v74, v75
    v_cndmask_b32_dpp v149, v153, v145, vcc row_ror:8 row_mask:0xf bank_mask:0xf
    v_mfma_f32_16x16x32_bf16 v[64:67], a[80:83], a[0:3], -4.0
    v_exp_f32 v76, v76
    v_mfma_f32_16x16x32_bf16 v[64:67], a[84:87], a[4:7], v[64:67]
    v_cndmask_b32_dpp v150, v154, v146, vcc row_ror:8 row_mask:0xf bank_mask:0xf
    v_cndmask_b32_dpp v151, v155, v147, vcc row_ror:8 row_mask:0xf bank_mask:0xf
    v_mfma_f32_16x16x32_bf16 v[64:67], a[88:91], a[8:11], v[64:67]
    v_exp_f32 v77, v77
    v_mfma_f32_16x16x32_bf16 v[64:67], a[92:95], a[12:15], v[64:67]
    ds_read_b128 a[80:83], v3 offset:32768
    v_cvt_pk_bf16_f32 v62, v76, v77
    v_mfma_f32_16x16x32_bf16 v[68:71], a[108:111], a[12:15], -4.0
    v_exp_f32 v78, v78
    v_mfma_f32_16x16x32_bf16 v[68:71], a[104:107], a[8:11], v[68:71]
    v_exp_f32 v79, v79
    v_mfma_f32_16x16x32_bf16 v[68:71], a[100:103], a[4:7], v[68:71]
    ds_read_b128 a[84:87], v3 offset:33792
    v_cvt_pk_bf16_f32 v63, v78, v79
    v_mfma_f32_16x16x32_bf16 v[68:71], a[96:99], a[0:3], v[68:71]
    v_exp_f32 v64, v64
    v_smfmac_f32_16x16x64_bf16 v[44:47], v[24:27], v[56:63], v9
    ds_read_b128 a[88:91], v3 offset:34816
    v_mov_b32_dpp v152, v144 row_ror:8 row_mask:0xf bank_mask:0x3
    v_mfma_f32_16x16x32_bf16 v[224:227], a[176:179], v[60:63], v[224:227]
    v_exp_f32 v65, v65
    v_mfma_f32_16x16x32_bf16 v[224:227], a[144:147], v[56:59], v[224:227]
    ds_read_b128 a[92:95], v3 offset:35840
    v_mov_b32_dpp v153, v145 row_ror:8 row_mask:0xf bank_mask:0x3
    v_mfma_f32_16x16x32_bf16 v[228:231], a[148:151], v[56:59], v[228:231]
    v_exp_f32 v66, v66
    v_mfma_f32_16x16x32_bf16 v[228:231], a[180:183], v[60:63], v[228:231]
    ds_read_b128 a[108:111], v3 offset:39936
    v_mov_b32_dpp v154, v146 row_ror:8 row_mask:0xf bank_mask:0x3
    v_mfma_f32_16x16x32_bf16 v[232:235], a[184:187], v[60:63], v[232:235]
    v_exp_f32 v67, v67
    v_mfma_f32_16x16x32_bf16 v[232:235], a[152:155], v[56:59], v[232:235]
    ds_read_b128 a[104:107], v3 offset:38912
    v_mov_b32_dpp v155, v147 row_ror:8 row_mask:0xf bank_mask:0x3
    v_mfma_f32_16x16x32_bf16 v[236:239], a[156:159], v[56:59], v[236:239]
    buffer_store_dwordx4 v[148:151], v8, s[20:23], s34 offen offset:128 sc1
    v_mfma_f32_16x16x32_bf16 v[236:239], a[188:191], v[60:63], v[236:239]
    v_cvt_pk_bf16_f32 v48, v64, v65
    v_cvt_pk_bf16_f32 v49, v66, v67
    v_mfma_f32_16x16x32_bf16 v[72:75], a[112:115], a[0:3], -4.0
    v_exp_f32 v68, v68
    v_mfma_f32_16x16x32_bf16 v[72:75], a[116:119], a[4:7], v[72:75]
    v_exp_f32 v69, v69
    v_mfma_f32_16x16x32_bf16 v[72:75], a[120:123], a[8:11], v[72:75]
    ds_read_b128 a[100:103], v3 offset:37888
    v_cvt_pk_bf16_f32 v50, v68, v69
    v_mfma_f32_16x16x32_bf16 v[72:75], a[124:127], a[12:15], v[72:75]
    v_exp_f32 v70, v70
    v_mfma_f32_16x16x32_bf16 v[76:79], a[140:143], a[12:15], -4.0
    v_exp_f32 v71, v71
    v_mfma_f32_16x16x32_bf16 v[76:79], a[136:139], a[8:11], v[76:79]
    ds_read_b128 a[96:99], v3 offset:36864
    v_cvt_pk_bf16_f32 v51, v70, v71
    v_mfma_f32_16x16x32_bf16 v[76:79], a[132:135], a[4:7], v[76:79]
    v_exp_f32 v72, v72
    v_mfma_f32_16x16x32_bf16 v[76:79], a[128:131], a[0:3], v[76:79]
    v_exp_f32 v73, v73
    v_mfma_f32_16x16x32_bf16 v[240:243], a[192:195], v[60:63], v[240:243]
    ds_read_b128 a[112:115], v3 offset:40960
    v_cvt_pk_bf16_f32 v52, v72, v73
    v_mfma_f32_16x16x32_bf16 v[240:243], a[160:163], v[56:59], v[240:243]
    v_exp_f32 v74, v74
    v_mfma_f32_16x16x32_bf16 v[244:247], a[164:167], v[56:59], v[244:247]
    v_exp_f32 v75, v75
    v_mfma_f32_16x16x32_bf16 v[244:247], a[196:199], v[60:63], v[244:247]
    ds_read_b128 a[116:119], v3 offset:41984
    v_cvt_pk_bf16_f32 v53, v74, v75
    v_mfma_f32_16x16x32_bf16 v[248:251], a[200:203], v[60:63], v[248:251]
    buffer_store_dwordx4 v[152:155], v8, s[20:23], s34 offen offset:2176 sc1
    v_mfma_f32_16x16x32_bf16 v[248:251], a[168:171], v[56:59], v[248:251]
    s_add_u32 s34, s34, s38
    ds_read_b128 a[120:123], v3 offset:43008
    ds_read_b128 a[124:127], v3 offset:44032
    v_mfma_f32_16x16x32_bf16 v[252:255], a[172:175], v[56:59], v[252:255]
    v_exp_f32 v76, v76
    v_mfma_f32_16x16x32_bf16 v[252:255], a[204:207], v[60:63], v[252:255]
    s_waitcnt lgkmcnt(4)
    ds_read_b128 a[140:143], v3 offset:48128
    ds_read_b128 a[136:139], v3 offset:47104
    v_mfma_f32_16x16x32_bf16 v[64:67], a[80:83], a[32:35], -4.0
    v_exp_f32 v77, v77
    v_mfma_f32_16x16x32_bf16 v[64:67], a[84:87], a[36:39], v[64:67]
    ds_read_b128 a[132:135], v3 offset:46080
    v_cvt_pk_bf16_f32 v54, v76, v77
    v_mfma_f32_16x16x32_bf16 v[64:67], a[88:91], a[40:43], v[64:67]
    v_exp_f32 v78, v78
    v_mfma_f32_16x16x32_bf16 v[64:67], a[92:95], a[44:47], v[64:67]
    v_exp_f32 v79, v79
    v_mfma_f32_16x16x32_bf16 v[68:71], a[108:111], a[44:47], -4.0
    ds_read_b128 a[128:131], v3 offset:45056
    v_cvt_pk_bf16_f32 v55, v78, v79
    v_mfma_f32_16x16x32_bf16 v[68:71], a[104:107], a[40:43], v[68:71]
    v_mfma_f32_16x16x32_bf16 v[68:71], a[100:103], a[36:39], v[68:71]
    v_exp_f32 v64, v64
    v_mfma_f32_16x16x32_bf16 v[68:71], a[96:99], a[32:35], v[68:71]
    s_waitcnt vmcnt(12)
    v_exp_f32 v65, v65
    v_smfmac_f32_16x16x64_bf16 v[36:39], v[24:27], v[48:55], v9
    s_barrier
    v_mfma_f32_16x16x32_bf16 v[96:99], a[176:179], v[52:55], v[96:99]
    v_exp_f32 v66, v66
    v_mfma_f32_16x16x32_bf16 v[96:99], a[144:147], v[48:51], v[96:99]
    ds_read_b64_tr_b16 a[176:177], v5 offset:8192
    v_cvt_pk_bf16_f32 v56, v64, v65
    v_mfma_f32_16x16x32_bf16 v[100:103], a[148:151], v[48:51], v[100:103]
    v_exp_f32 v67, v67
    v_mfma_f32_16x16x32_bf16 v[100:103], a[180:183], v[52:55], v[100:103]
    ds_read_b64_tr_b16 a[178:179], v5 offset:12288
    v_cvt_pk_bf16_f32 v57, v66, v67
    v_mfma_f32_16x16x32_bf16 v[104:107], a[184:187], v[52:55], v[104:107]
    v_exp_f32 v68, v68
    v_mfma_f32_16x16x32_bf16 v[104:107], a[152:155], v[48:51], v[104:107]
    v_exp_f32 v69, v69
    v_mfma_f32_16x16x32_bf16 v[108:111], a[156:159], v[48:51], v[108:111]
    ds_read_b64_tr_b16 a[144:145], v5 offset:0
    v_cvt_pk_bf16_f32 v58, v68, v69
    v_mfma_f32_16x16x32_bf16 v[108:111], a[188:191], v[52:55], v[108:111]
    s_waitcnt lgkmcnt(3)
    v_exp_f32 v70, v70
    v_mfma_f32_16x16x32_bf16 v[72:75], a[112:115], a[32:35], -4.0
    v_exp_f32 v71, v71
    v_mfma_f32_16x16x32_bf16 v[72:75], a[116:119], a[36:39], v[72:75]
    ds_read_b64_tr_b16 a[146:147], v5 offset:4096
    v_cvt_pk_bf16_f32 v59, v70, v71
    v_mfma_f32_16x16x32_bf16 v[72:75], a[120:123], a[40:43], v[72:75]
    ds_read_b64_tr_b16 a[148:149], v5 offset:8
    v_mfma_f32_16x16x32_bf16 v[72:75], a[124:127], a[44:47], v[72:75]
    ds_read_b64_tr_b16 a[150:151], v5 offset:4104
    v_mfma_f32_16x16x32_bf16 v[76:79], a[140:143], a[44:47], -4.0
    ds_read_b64_tr_b16 a[180:181], v5 offset:8200
    ds_read_b64_tr_b16 a[182:183], v5 offset:12296
    v_mfma_f32_16x16x32_bf16 v[76:79], a[136:139], a[40:43], v[76:79]
    ds_read_b64_tr_b16 a[184:185], v5 offset:8448
    ds_read_b64_tr_b16 a[186:187], v5 offset:12544
    v_mfma_f32_16x16x32_bf16 v[76:79], a[132:135], a[36:39], v[76:79]
    v_exp_f32 v72, v72
    v_mfma_f32_16x16x32_bf16 v[76:79], a[128:131], a[32:35], v[76:79]
    ds_read_b64_tr_b16 a[152:153], v5 offset:256
    ds_read_b64_tr_b16 a[154:155], v5 offset:4352
    v_mfma_f32_16x16x32_bf16 v[112:115], a[192:195], v[52:55], v[112:115]
    v_exp_f32 v73, v73
    v_mfma_f32_16x16x32_bf16 v[112:115], a[160:163], v[48:51], v[112:115]
    ds_read_b64_tr_b16 a[156:157], v5 offset:264
    v_cvt_pk_bf16_f32 v60, v72, v73
    v_mfma_f32_16x16x32_bf16 v[116:119], a[164:167], v[48:51], v[116:119]
    v_exp_f32 v74, v74
    v_mfma_f32_16x16x32_bf16 v[116:119], a[196:199], v[52:55], v[116:119]
    ds_read_b64_tr_b16 a[158:159], v5 offset:4360
    ds_read_b64_tr_b16 a[188:189], v5 offset:8456
    v_mfma_f32_16x16x32_bf16 v[120:123], a[200:203], v[52:55], v[120:123]
    v_exp_f32 v75, v75
    v_mfma_f32_16x16x32_bf16 v[120:123], a[168:171], v[48:51], v[120:123]
    ds_read_b64_tr_b16 a[190:191], v5 offset:12552
    v_cvt_pk_bf16_f32 v61, v74, v75
    v_mfma_f32_16x16x32_bf16 v[124:127], a[172:175], v[48:51], v[124:127]
    v_exp_f32 v76, v76
    v_mfma_f32_16x16x32_bf16 v[124:127], a[204:207], v[52:55], v[124:127]
    v_exp_f32 v77, v77
    v_mfma_f32_16x16x32_bf16 v[64:67], a[80:83], a[48:51], -4.0
    ds_read_b64_tr_b16 a[192:193], v5 offset:8704
    v_cvt_pk_bf16_f32 v62, v76, v77
    v_mfma_f32_16x16x32_bf16 v[64:67], a[84:87], a[52:55], v[64:67]
    v_exp_f32 v78, v78
    v_mfma_f32_16x16x32_bf16 v[64:67], a[88:91], a[56:59], v[64:67]
    ds_read_b64_tr_b16 a[194:195], v5 offset:12800
    ds_read_b64_tr_b16 a[160:161], v5 offset:512
    v_mfma_f32_16x16x32_bf16 v[64:67], a[92:95], a[60:63], v[64:67]
    v_exp_f32 v79, v79
    v_mfma_f32_16x16x32_bf16 v[68:71], a[108:111], a[60:63], -4.0
    ds_read_b64_tr_b16 a[162:163], v5 offset:4608
    v_cvt_pk_bf16_f32 v63, v78, v79
    v_mfma_f32_16x16x32_bf16 v[68:71], a[104:107], a[56:59], v[68:71]
    ds_read_b64_tr_b16 a[164:165], v5 offset:520
    ds_read_b64_tr_b16 a[166:167], v5 offset:4616
    v_mfma_f32_16x16x32_bf16 v[68:71], a[100:103], a[52:55], v[68:71]
    v_exp_f32 v64, v64
    v_mfma_f32_16x16x32_bf16 v[68:71], a[96:99], a[48:51], v[68:71]
    ds_read_b64_tr_b16 a[196:197], v5 offset:8712
    ds_read_b64_tr_b16 a[198:199], v5 offset:12808
    v_smfmac_f32_16x16x64_bf16 v[40:43], v[24:27], v[56:63], v9
    s_waitcnt lgkmcnt(7)
    ds_read_b64_tr_b16 a[200:201], v5 offset:8960
    ds_read_b64_tr_b16 a[202:203], v5 offset:13056
    v_mfma_f32_16x16x32_bf16 v[160:163], a[176:179], v[60:63], v[160:163]
    v_exp_f32 v65, v65
    v_mfma_f32_16x16x32_bf16 v[160:163], a[144:147], v[56:59], v[160:163]
    ds_read_b64_tr_b16 a[168:169], v5 offset:768
    ds_read_b64_tr_b16 a[170:171], v5 offset:4864
    v_mfma_f32_16x16x32_bf16 v[164:167], a[148:151], v[56:59], v[164:167]
    v_exp_f32 v66, v66
    v_mfma_f32_16x16x32_bf16 v[164:167], a[180:183], v[60:63], v[164:167]
    ds_read_b64_tr_b16 a[172:173], v5 offset:776
    v_add_f32 v28, v40, v41
    v_mfma_f32_16x16x32_bf16 v[168:171], a[184:187], v[60:63], v[168:171]
    v_rcp_f32 v12, v28
    v_mfma_f32_16x16x32_bf16 v[168:171], a[152:155], v[56:59], v[168:171]
    ds_read_b64_tr_b16 a[174:175], v5 offset:4872
    v_mul_f32_e64 v30, -v32, v12
    v_mfma_f32_16x16x32_bf16 v[172:175], a[156:159], v[56:59], v[172:175]
    v_exp_f32 v67, v67
    v_mfma_f32_16x16x32_bf16 v[172:175], a[188:191], v[60:63], v[172:175]
    ds_read_b64_tr_b16 a[204:205], v5 offset:8968
    v_fma_f32 v160, v160, v12, v30
    v_mfma_f32_16x16x32_bf16 v[72:75], a[112:115], a[48:51], -4.0
    v_exp_f32 v68, v68
    v_mfma_f32_16x16x32_bf16 v[72:75], a[116:119], a[52:55], v[72:75]
    ds_read_b64_tr_b16 a[206:207], v5 offset:13064
    v_fma_f32 v161, v161, v12, v30
    v_mfma_f32_16x16x32_bf16 v[72:75], a[120:123], a[56:59], v[72:75]
    v_exp_f32 v69, v69
    v_mfma_f32_16x16x32_bf16 v[72:75], a[124:127], a[60:63], v[72:75]
    v_fma_f32 v162, v162, v12, v30
    v_cvt_pk_bf16_f32 v48, v64, v65
    v_mfma_f32_16x16x32_bf16 v[76:79], a[140:143], a[60:63], -4.0
    v_exp_f32 v70, v70
    v_mfma_f32_16x16x32_bf16 v[76:79], a[136:139], a[56:59], v[76:79]
    v_cvt_pk_bf16_f32 v49, v66, v67
    v_cvt_pk_bf16_f32 v50, v68, v69
    v_mfma_f32_16x16x32_bf16 v[76:79], a[132:135], a[52:55], v[76:79]
    v_exp_f32 v71, v71
    v_mfma_f32_16x16x32_bf16 v[76:79], a[128:131], a[48:51], v[76:79]
    s_waitcnt lgkmcnt(1)
    v_cvt_pk_bf16_f32 v51, v70, v71
    v_fma_f32 v163, v163, v12, v30
    v_mfma_f32_16x16x32_bf16 v[176:179], a[192:195], v[60:63], v[176:179]
    v_exp_f32 v72, v72
    v_mfma_f32_16x16x32_bf16 v[176:179], a[160:163], v[56:59], v[176:179]
    v_fma_f32 v164, v164, v12, v30
    v_fma_f32 v165, v165, v12, v30
    v_mfma_f32_16x16x32_bf16 v[180:183], a[164:167], v[56:59], v[180:183]
    v_exp_f32 v73, v73
    v_mfma_f32_16x16x32_bf16 v[180:183], a[196:199], v[60:63], v[180:183]
    v_cvt_pk_bf16_f32 v52, v72, v73
    v_fma_f32 v166, v166, v12, v30
    v_mfma_f32_16x16x32_bf16 v[184:187], a[200:203], v[60:63], v[184:187]
    v_exp_f32 v74, v74
    v_mfma_f32_16x16x32_bf16 v[184:187], a[168:171], v[56:59], v[184:187]
    v_fma_f32 v167, v167, v12, v30
    v_max3_f32 v14, abs(v160), abs(v161), abs(v162)
    v_mfma_f32_16x16x32_bf16 v[188:191], a[172:175], v[56:59], v[188:191]
    s_waitcnt lgkmcnt(0)
    v_exp_f32 v75, v75
    v_mfma_f32_16x16x32_bf16 v[188:191], a[204:207], v[60:63], v[188:191]
    s_barrier
    v_mfma_f32_16x16x32_bf16 v[64:67], a[80:83], a[64:67], -4.0
    s_mov_b32 s35, 0x10000
    v_exp_f32 v76, v76
    v_mfma_f32_16x16x32_bf16 v[64:67], a[84:87], a[68:71], v[64:67]
    v_cvt_pk_bf16_f32 v53, v74, v75
    v_cvt_pk_bf16_f32 v160, v160, v161
    v_mfma_f32_16x16x32_bf16 v[64:67], a[88:91], a[72:75], v[64:67]
    s_mov_b32 m0, s48
    v_exp_f32 v77, v77
    v_mfma_f32_16x16x32_bf16 v[64:67], a[92:95], a[76:79], v[64:67]
    v_cvt_pk_bf16_f32 v54, v76, v77
    v_cvt_pk_bf16_f32 v161, v162, v163
    v_mfma_f32_16x16x32_bf16 v[68:71], a[108:111], a[76:79], -4.0
    v_exp_f32 v78, v78
    v_mfma_f32_16x16x32_bf16 v[68:71], a[104:107], a[72:75], v[68:71]
    v_exp_f32 v79, v79
    v_mfma_f32_16x16x32_bf16 v[68:71], a[100:103], a[68:71], v[68:71]
    buffer_load_dwordx4 v2, s[16:19], s35 offen offset:0 lds
    v_cvt_pk_bf16_f32 v55, v78, v79
    v_mfma_f32_16x16x32_bf16 v[68:71], a[96:99], a[64:67], v[68:71]
    v_exp_f32 v64, v64
    v_smfmac_f32_16x16x64_bf16 v[42:45], v[24:27], v[48:55], v9
    v_cvt_pk_bf16_f32 v162, v164, v165
    v_mfma_f32_16x16x32_bf16 v[192:195], a[176:179], v[52:55], v[192:195]
    v_exp_f32 v65, v65
    v_mfma_f32_16x16x32_bf16 v[192:195], a[144:147], v[48:51], v[192:195]
    buffer_load_dwordx4 v2, s[16:19], s35 offen offset:1024 lds
    v_max3_f32 v14, v14, abs(v163), abs(v164)
    v_mfma_f32_16x16x32_bf16 v[196:199], a[148:151], v[48:51], v[196:199]
    s_mov_b32 m0, s49
    v_exp_f32 v66, v66
    v_mfma_f32_16x16x32_bf16 v[196:199], a[180:183], v[52:55], v[196:199]
    s_mov_b32 s35, 0x12000
    v_cvt_pk_bf16_f32 v163, v166, v167
    v_cvt_pk_bf16_f32 v56, v64, v65
    v_mfma_f32_16x16x32_bf16 v[200:203], a[184:187], v[52:55], v[200:203]
    v_exp_f32 v67, v67
    v_mfma_f32_16x16x32_bf16 v[200:203], a[152:155], v[48:51], v[200:203]
    buffer_load_dwordx4 v2, s[16:19], s35 offen offset:0 lds
    v_cvt_pk_bf16_f32 v57, v66, v67
    v_mfma_f32_16x16x32_bf16 v[204:207], a[156:159], v[48:51], v[204:207]
    v_exp_f32 v68, v68
    v_mfma_f32_16x16x32_bf16 v[204:207], a[188:191], v[52:55], v[204:207]
    v_subrev_u32 v28, s30, v28
    v_fma_f32 v14, v14, s42, v30
    v_mfma_f32_16x16x32_bf16 v[72:75], a[112:115], a[64:67], -4.0
    v_exp_f32 v69, v69
    v_mfma_f32_16x16x32_bf16 v[72:75], a[116:119], a[68:71], v[72:75]
    buffer_load_dwordx4 v2, s[16:19], s35 offen offset:1024 lds
    v_cvt_pk_bf16_f32 v58, v68, v69
    v_mfma_f32_16x16x32_bf16 v[72:75], a[120:123], a[72:75], v[72:75]
    v_exp_f32 v70, v70
    v_mfma_f32_16x16x32_bf16 v[72:75], a[124:127], a[76:79], v[72:75]
    v_and_or_b32 v14, v14, s43, v28
    v_fma_f32 v168, v168, v12, v30
    v_mfma_f32_16x16x32_bf16 v[76:79], a[140:143], a[76:79], -4.0
    v_exp_f32 v71, v71
    v_mfma_f32_16x16x32_bf16 v[76:79], a[136:139], a[72:75], v[76:79]
    v_cvt_pk_bf16_f32 v59, v70, v71
    v_cmp_lt_u32_e64 s[4:5], s31, v14
    v_mfma_f32_16x16x32_bf16 v[76:79], a[132:135], a[68:71], v[76:79]
    v_exp_f32 v72, v72
    v_mfma_f32_16x16x32_bf16 v[76:79], a[128:131], a[64:67], v[76:79]
    v_fma_f32 v169, v169, v12, v30
    v_fma_f32 v170, v170, v12, v30
    v_mfma_f32_16x16x32_bf16 v[208:211], a[192:195], v[52:55], v[208:211]
    v_exp_f32 v73, v73
    v_mfma_f32_16x16x32_bf16 v[208:211], a[160:163], v[48:51], v[208:211]
    v_cvt_pk_bf16_f32 v60, v72, v73
    v_fma_f32 v171, v171, v12, v30
    v_mfma_f32_16x16x32_bf16 v[212:215], a[164:167], v[48:51], v[212:215]
    v_exp_f32 v74, v74
    v_mfma_f32_16x16x32_bf16 v[212:215], a[196:199], v[52:55], v[212:215]
    v_fma_f32 v172, v172, v12, v30
    v_fma_f32 v173, v173, v12, v30
    v_mfma_f32_16x16x32_bf16 v[216:219], a[200:203], v[52:55], v[216:219]
    v_exp_f32 v75, v75
    v_mfma_f32_16x16x32_bf16 v[216:219], a[168:171], v[48:51], v[216:219]
    v_cvt_pk_bf16_f32 v61, v74, v75
    v_fma_f32 v174, v174, v12, v30
    v_mfma_f32_16x16x32_bf16 v[220:223], a[172:175], v[48:51], v[220:223]
    v_exp_f32 v76, v76
    v_mfma_f32_16x16x32_bf16 v[220:223], a[204:207], v[52:55], v[220:223]
    v_fma_f32 v175, v175, v12, v30
    v_cvt_pk_bf16_f32 v168, v168, v169
    v_mfma_f32_16x16x32_bf16 v[64:67], a[80:83], a[0:3], -4.0
    v_exp_f32 v77, v77
    v_mfma_f32_16x16x32_bf16 v[64:67], a[84:87], a[4:7], v[64:67]
    ds_read_b128 a[80:83], v3 offset:49152
    v_cvt_pk_bf16_f32 v62, v76, v77
    v_mfma_f32_16x16x32_bf16 v[64:67], a[88:91], a[8:11], v[64:67]
    buffer_store_dwordx4 v[160:163], v1, s[20:23], s34 offen offset:0 sc1
    v_mfma_f32_16x16x32_bf16 v[64:67], a[92:95], a[12:15], v[64:67]
    s_cmp_lg_u64 s[4:5], 0
    ds_read_b128 a[84:87], v3 offset:50176
    ds_read_b128 a[88:91], v3 offset:51200
    v_mfma_f32_16x16x32_bf16 v[68:71], a[108:111], a[12:15], -4.0
    s_addc_u32 s32, s32, s32
    v_exp_f32 v78, v78
    v_mfma_f32_16x16x32_bf16 v[68:71], a[104:107], a[8:11], v[68:71]
    v_exp_f32 v79, v79
    v_mfma_f32_16x16x32_bf16 v[68:71], a[100:103], a[4:7], v[68:71]
    ds_read_b128 a[92:95], v3 offset:52224
    v_cvt_pk_bf16_f32 v63, v78, v79
    v_mfma_f32_16x16x32_bf16 v[68:71], a[96:99], a[0:3], v[68:71]
    v_exp_f32 v64, v64
    v_smfmac_f32_16x16x64_bf16 v[44:47], v[24:27], v[56:63], v9
    ds_read_b128 a[108:111], v3 offset:56320
    ds_read_b128 a[104:107], v3 offset:55296
    v_mfma_f32_16x16x32_bf16 v[224:227], a[176:179], v[60:63], v[224:227]
    v_exp_f32 v65, v65
    v_mfma_f32_16x16x32_bf16 v[224:227], a[144:147], v[56:59], v[224:227]
    ds_read_b128 a[100:103], v3 offset:54272
    ds_read_b128 a[96:99], v3 offset:53248
    v_mfma_f32_16x16x32_bf16 v[228:231], a[148:151], v[56:59], v[228:231]
    v_exp_f32 v66, v66
    v_mfma_f32_16x16x32_bf16 v[228:231], a[180:183], v[60:63], v[228:231]
    v_cvt_pk_bf16_f32 v48, v64, v65
    v_cvt_pk_bf16_f32 v169, v170, v171
    v_mfma_f32_16x16x32_bf16 v[232:235], a[184:187], v[60:63], v[232:235]
    v_exp_f32 v67, v67
    v_mfma_f32_16x16x32_bf16 v[232:235], a[152:155], v[56:59], v[232:235]
    v_cvt_pk_bf16_f32 v49, v66, v67
    v_cvt_pk_bf16_f32 v170, v172, v173
    v_mfma_f32_16x16x32_bf16 v[236:239], a[156:159], v[56:59], v[236:239]
    v_exp_f32 v68, v68
    v_mfma_f32_16x16x32_bf16 v[236:239], a[188:191], v[60:63], v[236:239]
    v_cvt_pk_bf16_f32 v171, v174, v175
    v_fma_f32 v176, v176, v12, v30
    v_mfma_f32_16x16x32_bf16 v[72:75], a[112:115], a[0:3], -4.0
    v_exp_f32 v69, v69
    v_mfma_f32_16x16x32_bf16 v[72:75], a[116:119], a[4:7], v[72:75]
    ds_read_b128 a[112:115], v3 offset:57344
    v_cvt_pk_bf16_f32 v50, v68, v69
    v_mfma_f32_16x16x32_bf16 v[72:75], a[120:123], a[8:11], v[72:75]
    v_exp_f32 v70, v70
    v_mfma_f32_16x16x32_bf16 v[72:75], a[124:127], a[12:15], v[72:75]
    ds_read_b128 a[116:119], v3 offset:58368
    ds_read_b128 a[120:123], v3 offset:59392
    v_mfma_f32_16x16x32_bf16 v[76:79], a[140:143], a[12:15], -4.0
    v_exp_f32 v71, v71
    v_mfma_f32_16x16x32_bf16 v[76:79], a[136:139], a[8:11], v[76:79]
    ds_read_b128 a[124:127], v3 offset:60416
    v_cvt_pk_bf16_f32 v51, v70, v71
    v_mfma_f32_16x16x32_bf16 v[76:79], a[132:135], a[4:7], v[76:79]
    v_exp_f32 v72, v72
    v_mfma_f32_16x16x32_bf16 v[76:79], a[128:131], a[0:3], v[76:79]
    ds_read_b128 a[140:143], v3 offset:64512
    ds_read_b128 a[136:139], v3 offset:63488
    v_mfma_f32_16x16x32_bf16 v[240:243], a[192:195], v[60:63], v[240:243]
    v_exp_f32 v73, v73
    v_mfma_f32_16x16x32_bf16 v[240:243], a[160:163], v[56:59], v[240:243]
    ds_read_b128 a[132:135], v3 offset:62464
    ds_read_b128 a[128:131], v3 offset:61440
    v_mfma_f32_16x16x32_bf16 v[244:247], a[164:167], v[56:59], v[244:247]
    v_exp_f32 v74, v74
    v_mfma_f32_16x16x32_bf16 v[244:247], a[196:199], v[60:63], v[244:247]
    v_cvt_pk_bf16_f32 v52, v72, v73
    v_fma_f32 v177, v177, v12, v30
    v_mfma_f32_16x16x32_bf16 v[248:251], a[200:203], v[60:63], v[248:251]
    v_exp_f32 v75, v75
    v_mfma_f32_16x16x32_bf16 v[248:251], a[168:171], v[56:59], v[248:251]
    v_cvt_pk_bf16_f32 v53, v74, v75
    v_fma_f32 v178, v178, v12, v30
    v_mfma_f32_16x16x32_bf16 v[252:255], a[172:175], v[56:59], v[252:255]
    v_exp_f32 v76, v76
    v_mfma_f32_16x16x32_bf16 v[252:255], a[204:207], v[60:63], v[252:255]
    s_waitcnt lgkmcnt(2)
    v_fma_f32 v179, v179, v12, v30
    v_fma_f32 v180, v180, v12, v30
    v_mfma_f32_16x16x32_bf16 v[64:67], a[80:83], a[48:51], -4.0
    v_exp_f32 v77, v77
    v_mfma_f32_16x16x32_bf16 v[64:67], a[84:87], a[52:55], v[64:67]
    v_cvt_pk_bf16_f32 v54, v76, v77
    v_fma_f32 v181, v181, v12, v30
    v_mfma_f32_16x16x32_bf16 v[64:67], a[88:91], a[56:59], v[64:67]
    v_exp_f32 v78, v78
    v_mfma_f32_16x16x32_bf16 v[64:67], a[92:95], a[60:63], v[64:67]
    v_exp_f32 v79, v79
    v_mfma_f32_16x16x32_bf16 v[68:71], a[108:111], a[60:63], -4.0
    v_cvt_pk_bf16_f32 v55, v78, v79
    v_fma_f32 v182, v182, v12, v30
    v_mfma_f32_16x16x32_bf16 v[68:71], a[104:107], a[56:59], v[68:71]
    v_fma_f32 v183, v183, v12, v30
    v_cvt_pk_bf16_f32 v176, v176, v177
    v_mfma_f32_16x16x32_bf16 v[68:71], a[100:103], a[52:55], v[68:71]
    v_exp_f32 v64, v64
    v_mfma_f32_16x16x32_bf16 v[68:71], a[96:99], a[48:51], v[68:71]
    s_waitcnt vmcnt(7)
    v_exp_f32 v65, v65
    v_smfmac_f32_16x16x64_bf16 v[36:39], v[24:27], v[48:55], v9
    s_barrier
    v_mfma_f32_16x16x32_bf16 v[96:99], a[176:179], v[52:55], v[96:99]
    v_exp_f32 v66, v66
    v_mfma_f32_16x16x32_bf16 v[96:99], a[144:147], v[48:51], v[96:99]
    ds_read_b64_tr_b16 a[176:177], v5 offset:24576
    ds_read_b64_tr_b16 a[178:179], v5 offset:28672
    v_mfma_f32_16x16x32_bf16 v[100:103], a[148:151], v[48:51], v[100:103]
    v_exp_f32 v67, v67
    v_mfma_f32_16x16x32_bf16 v[100:103], a[180:183], v[52:55], v[100:103]
    ds_read_b64_tr_b16 a[144:145], v5 offset:16384
    ds_read_b64_tr_b16 a[146:147], v5 offset:20480
    v_mfma_f32_16x16x32_bf16 v[104:107], a[184:187], v[52:55], v[104:107]
    v_exp_f32 v68, v68
    v_mfma_f32_16x16x32_bf16 v[104:107], a[152:155], v[48:51], v[104:107]
    ds_read_b64_tr_b16 a[148:149], v5 offset:16392
    ds_read_b64_tr_b16 a[150:151], v5 offset:20488
    v_mfma_f32_16x16x32_bf16 v[108:111], a[156:159], v[48:51], v[108:111]
L_st11:
    s_cbranch_execz L_st12
    buffer_store_dwordx4 v[168:171], v1, s[20:23], s34 offen offset:64 sc1
    v_mfma_f32_16x16x32_bf16 v[108:111], a[188:191], v[52:55], v[108:111]
    ds_read_b64_tr_b16 a[180:181], v5 offset:24584
    ds_read_b64_tr_b16 a[182:183], v5 offset:28680
    v_mfma_f32_16x16x32_bf16 v[72:75], a[112:115], a[48:51], -4.0
    v_exp_f32 v69, v69
    v_mfma_f32_16x16x32_bf16 v[72:75], a[116:119], a[52:55], v[72:75]
    ds_read_b64_tr_b16 a[184:185], v5 offset:24832
    ds_read_b64_tr_b16 a[186:187], v5 offset:28928
    v_mfma_f32_16x16x32_bf16 v[72:75], a[120:123], a[56:59], v[72:75]
    v_exp_f32 v70, v70
    v_mfma_f32_16x16x32_bf16 v[72:75], a[124:127], a[60:63], v[72:75]
    ds_read_b64_tr_b16 a[152:153], v5 offset:16640
    v_cvt_pk_bf16_f32 v56, v64, v65
    v_mfma_f32_16x16x32_bf16 v[76:79], a[140:143], a[60:63], -4.0
    v_exp_f32 v71, v71
    v_mfma_f32_16x16x32_bf16 v[76:79], a[136:139], a[56:59], v[76:79]
    s_waitcnt lgkmcnt(5)
    ds_read_b64_tr_b16 a[154:155], v5 offset:20736
    v_cvt_pk_bf16_f32 v57, v66, v67
    v_mfma_f32_16x16x32_bf16 v[76:79], a[132:135], a[52:55], v[76:79]
    v_exp_f32 v72, v72
    v_mfma_f32_16x16x32_bf16 v[76:79], a[128:131], a[48:51], v[76:79]
    ds_read_b64_tr_b16 a[156:157], v5 offset:16648
    v_cvt_pk_bf16_f32 v58, v68, v69
    v_mfma_f32_16x16x32_bf16 v[112:115], a[192:195], v[52:55], v[112:115]
    v_exp_f32 v73, v73
    v_mfma_f32_16x16x32_bf16 v[112:115], a[160:163], v[48:51], v[112:115]
    ds_read_b64_tr_b16 a[192:193], v5 offset:25088
    ds_read_b64_tr_b16 a[194:195], v5 offset:29184
    v_mfma_f32_16x16x32_bf16 v[116:119], a[164:167], v[48:51], v[116:119]
    v_exp_f32 v74, v74
    v_mfma_f32_16x16x32_bf16 v[116:119], a[196:199], v[52:55], v[116:119]
    ds_read_b64_tr_b16 a[160:161], v5 offset:16896
    ds_read_b64_tr_b16 a[158:159], v5 offset:20744
    v_mfma_f32_16x16x32_bf16 v[120:123], a[200:203], v[52:55], v[120:123]
    v_exp_f32 v75, v75
    v_mfma_f32_16x16x32_bf16 v[120:123], a[168:171], v[48:51], v[120:123]
    ds_read_b64_tr_b16 a[188:189], v5 offset:24840
    v_cvt_pk_bf16_f32 v59, v70, v71
    v_mfma_f32_16x16x32_bf16 v[124:127], a[172:175], v[48:51], v[124:127]
    ds_read_b64_tr_b16 a[162:163], v5 offset:20992
    ds_read_b64_tr_b16 a[164:165], v5 offset:16904
    v_mfma_f32_16x16x32_bf16 v[124:127], a[204:207], v[52:55], v[124:127]
    v_exp_f32 v76, v76
    v_mfma_f32_16x16x32_bf16 v[64:67], a[80:83], a[64:67], -4.0
    ds_read_b64_tr_b16 a[190:191], v5 offset:28936
    v_cvt_pk_bf16_f32 v60, v72, v73
    v_mfma_f32_16x16x32_bf16 v[64:67], a[84:87], a[68:71], v[64:67]
    ds_read_b64_tr_b16 a[166:167], v5 offset:21000
    v_cvt_pk_bf16_f32 v61, v74, v75
    v_mfma_f32_16x16x32_bf16 v[64:67], a[88:91], a[72:75], v[64:67]
    ds_read_b64_tr_b16 a[196:197], v5 offset:25096
    ds_read_b64_tr_b16 a[198:199], v5 offset:29192
    v_mfma_f32_16x16x32_bf16 v[64:67], a[92:95], a[76:79], v[64:67]
    v_exp_f32 v77, v77
    v_mfma_f32_16x16x32_bf16 v[68:71], a[108:111], a[76:79], -4.0
    v_cvt_pk_bf16_f32 v62, v76, v77
    v_exp_f32 v78, v78
    v_mfma_f32_16x16x32_bf16 v[68:71], a[104:107], a[72:75], v[68:71]
    ds_read_b64_tr_b16 a[200:201], v5 offset:25344
    v_exp_f32 v79, v79
    v_mfma_f32_16x16x32_bf16 v[68:71], a[100:103], a[68:71], v[68:71]
    ds_read_b64_tr_b16 a[202:203], v5 offset:29440
    v_cvt_pk_bf16_f32 v63, v78, v79
    v_mfma_f32_16x16x32_bf16 v[68:71], a[96:99], a[64:67], v[68:71]
    v_exp_f32 v64, v64
    v_smfmac_f32_16x16x64_bf16 v[42:45], v[24:27], v[56:63], v9
    ds_read_b64_tr_b16 a[168:169], v5 offset:17152
    ds_read_b64_tr_b16 a[170:171], v5 offset:21248
    v_mfma_f32_16x16x32_bf16 v[192:195], a[176:179], v[60:63], v[192:195]
    v_exp_f32 v65, v65
    v_mfma_f32_16x16x32_bf16 v[192:195], a[144:147], v[56:59], v[192:195]
    ds_read_b64_tr_b16 a[172:173], v5 offset:17160
    ds_read_b64_tr_b16 a[174:175], v5 offset:21256
    v_mfma_f32_16x16x32_bf16 v[196:199], a[148:151], v[56:59], v[196:199]
    s_waitcnt lgkmcnt(6)
    v_exp_f32 v66, v66
    v_mfma_f32_16x16x32_bf16 v[196:199], a[180:183], v[60:63], v[196:199]
    ds_read_b64_tr_b16 a[204:205], v5 offset:25352
    v_cvt_pk_bf16_f32 v177, v178, v179
    v_mfma_f32_16x16x32_bf16 v[200:203], a[184:187], v[60:63], v[200:203]
    v_exp_f32 v67, v67
    v_mfma_f32_16x16x32_bf16 v[200:203], a[152:155], v[56:59], v[200:203]
    ds_read_b64_tr_b16 a[206:207], v5 offset:29448
    v_cvt_pk_bf16_f32 v178, v180, v181
    v_mfma_f32_16x16x32_bf16 v[204:207], a[156:159], v[56:59], v[204:207]
    v_exp_f32 v68, v68
    v_mfma_f32_16x16x32_bf16 v[204:207], a[188:191], v[60:63], v[204:207]
    v_cvt_pk_bf16_f32 v179, v182, v183
    v_cvt_pk_bf16_f32 v48, v64, v65
    v_mfma_f32_16x16x32_bf16 v[72:75], a[112:115], a[64:67], -4.0
    v_exp_f32 v69, v69
    v_mfma_f32_16x16x32_bf16 v[72:75], a[116:119], a[68:71], v[72:75]
    v_cvt_pk_bf16_f32 v49, v66, v67
    v_fma_f32 v184, v184, v12, v30
    v_mfma_f32_16x16x32_bf16 v[72:75], a[120:123], a[72:75], v[72:75]
    v_exp_f32 v70, v70
    v_mfma_f32_16x16x32_bf16 v[72:75], a[124:127], a[76:79], v[72:75]
    v_cvt_pk_bf16_f32 v50, v68, v69
    v_fma_f32 v185, v185, v12, v30
    v_mfma_f32_16x16x32_bf16 v[76:79], a[140:143], a[76:79], -4.0
    v_exp_f32 v71, v71
    v_mfma_f32_16x16x32_bf16 v[76:79], a[136:139], a[72:75], v[76:79]
    v_cvt_pk_bf16_f32 v51, v70, v71
    v_fma_f32 v186, v186, v12, v30
    v_mfma_f32_16x16x32_bf16 v[76:79], a[132:135], a[68:71], v[76:79]
    v_exp_f32 v72, v72
    v_mfma_f32_16x16x32_bf16 v[76:79], a[128:131], a[64:67], v[76:79]
    v_fma_f32 v187, v187, v12, v30
    v_fma_f32 v188, v188, v12, v30
    v_mfma_f32_16x16x32_bf16 v[208:211], a[192:195], v[60:63], v[208:211]
    v_exp_f32 v73, v73
    v_mfma_f32_16x16x32_bf16 v[208:211], a[160:163], v[56:59], v[208:211]
    v_cvt_pk_bf16_f32 v52, v72, v73
    v_fma_f32 v189, v189, v12, v30
    v_mfma_f32_16x16x32_bf16 v[212:215], a[164:167], v[56:59], v[212:215]
    buffer_store_dwordx4 v[176:179], v1, s[20:23], s34 offen offset:128 sc1
    v_mfma_f32_16x16x32_bf16 v[212:215], a[196:199], v[60:63], v[212:215]
    s_waitcnt lgkmcnt(0)
    v_fma_f32 v190, v190, v12, v30
    v_fma_f32 v191, v191, v12, v30
    v_mfma_f32_16x16x32_bf16 v[216:219], a[200:203], v[60:63], v[216:219]
    v_exp_f32 v74, v74
    v_mfma_f32_16x16x32_bf16 v[216:219], a[168:171], v[56:59], v[216:219]
    v_exp_f32 v75, v75
    v_mfma_f32_16x16x32_bf16 v[220:223], a[172:175], v[56:59], v[220:223]
    v_cvt_pk_bf16_f32 v53, v74, v75
    v_cvt_pk_bf16_f32 v184, v184, v185
    v_mfma_f32_16x16x32_bf16 v[220:223], a[204:207], v[60:63], v[220:223]
    s_barrier
    v_mfma_f32_16x16x32_bf16 v[64:67], a[80:83], a[0:3], -4.0
    s_mov_b32 s35, 0x14000
    v_exp_f32 v76, v76
    v_mfma_f32_16x16x32_bf16 v[64:67], a[84:87], a[4:7], v[64:67]
    ds_read_b128 a[80:83], v4 offset:0
    v_cvt_pk_bf16_f32 v185, v186, v187
    v_mfma_f32_16x16x32_bf16 v[64:67], a[88:91], a[8:11], v[64:67]
    s_mov_b32 m0, s50
    v_exp_f32 v77, v77
    v_mfma_f32_16x16x32_bf16 v[64:67], a[92:95], a[12:15], v[64:67]
    ds_read_b128 a[84:87], v4 offset:1024
    v_cvt_pk_bf16_f32 v54, v76, v77
    v_mfma_f32_16x16x32_bf16 v[68:71], a[108:111], a[12:15], -4.0
    v_exp_f32 v78, v78
    v_mfma_f32_16x16x32_bf16 v[68:71], a[104:107], a[8:11], v[68:71]
    v_exp_f32 v79, v79
    v_mfma_f32_16x16x32_bf16 v[68:71], a[100:103], a[4:7], v[68:71]
    buffer_load_dwordx4 v2, s[16:19], s35 offen offset:0 lds
    v_cvt_pk_bf16_f32 v55, v78, v79
    v_mfma_f32_16x16x32_bf16 v[68:71], a[96:99], a[0:3], v[68:71]
    v_exp_f32 v64, v64
    v_smfmac_f32_16x16x64_bf16 v[44:47], v[24:27], v[48:55], v9
    ds_read_b128 a[88:91], v4 offset:2048
    ds_read_b128 a[92:95], v4 offset:3072
    v_mfma_f32_16x16x32_bf16 v[224:227], a[176:179], v[52:55], v[224:227]
    v_exp_f32 v65, v65
    v_mfma_f32_16x16x32_bf16 v[224:227], a[144:147], v[48:51], v[224:227]
    buffer_load_dwordx4 v2, s[16:19], s35 offen offset:1024 lds
    v_cvt_pk_bf16_f32 v56, v64, v65
    v_mfma_f32_16x16x32_bf16 v[228:231], a[148:151], v[48:51], v[228:231]
    s_mov_b32 m0, s51
    v_exp_f32 v66, v66
    v_mfma_f32_16x16x32_bf16 v[228:231], a[180:183], v[52:55], v[228:231]
    s_mov_b32 s35, 0x16000
    ds_read_b128 a[108:111], v4 offset:7168
    ds_read_b128 a[104:107], v4 offset:6144
    v_mfma_f32_16x16x32_bf16 v[232:235], a[184:187], v[52:55], v[232:235]
    v_exp_f32 v67, v67
    v_mfma_f32_16x16x32_bf16 v[232:235], a[152:155], v[48:51], v[232:235]
    buffer_load_dwordx4 v2, s[16:19], s35 offen offset:0 lds
    v_cvt_pk_bf16_f32 v57, v66, v67
    v_mfma_f32_16x16x32_bf16 v[236:239], a[156:159], v[48:51], v[236:239]
    v_exp_f32 v68, v68
    v_mfma_f32_16x16x32_bf16 v[236:239], a[188:191], v[52:55], v[236:239]
    ds_read_b128 a[100:103], v4 offset:5120
    ds_read_b128 a[96:99], v4 offset:4096
    v_mfma_f32_16x16x32_bf16 v[72:75], a[112:115], a[0:3], -4.0
    v_exp_f32 v69, v69
    v_mfma_f32_16x16x32_bf16 v[72:75], a[116:119], a[4:7], v[72:75]
    buffer_load_dwordx4 v2, s[16:19], s35 offen offset:1024 lds
    v_cvt_pk_bf16_f32 v58, v68, v69
    v_mfma_f32_16x16x32_bf16 v[72:75], a[120:123], a[8:11], v[72:75]
    s_sub_u32 m0, s48, 0x14000
    v_exp_f32 v70, v70
    v_mfma_f32_16x16x32_bf16 v[72:75], a[124:127], a[12:15], v[72:75]
    s_mov_b32 s35, 0x18000
    ds_read_b128 a[112:115], v4 offset:8192
    ds_read_b128 a[116:119], v4 offset:9216
    v_mfma_f32_16x16x32_bf16 v[76:79], a[140:143], a[12:15], -4.0
    buffer_load_dwordx4 v2, s[16:19], s35 offen offset:0 lds
    v_cvt_pk_bf16_f32 v186, v188, v189
    v_mfma_f32_16x16x32_bf16 v[76:79], a[136:139], a[8:11], v[76:79]
    v_exp_f32 v71, v71
    v_mfma_f32_16x16x32_bf16 v[76:79], a[132:135], a[4:7], v[76:79]
    buffer_load_dwordx4 v2, s[16:19], s35 offen offset:1024 lds
    v_cvt_pk_bf16_f32 v59, v70, v71
    v_mfma_f32_16x16x32_bf16 v[76:79], a[128:131], a[0:3], v[76:79]
    s_sub_u32 m0, s48, 0x12000
    v_exp_f32 v72, v72
    v_mfma_f32_16x16x32_bf16 v[240:243], a[192:195], v[52:55], v[240:243]
    s_mov_b32 s35, 0x1a000
    ds_read_b128 a[120:123], v4 offset:10240
    ds_read_b128 a[124:127], v4 offset:11264
    v_mfma_f32_16x16x32_bf16 v[240:243], a[160:163], v[48:51], v[240:243]
    v_exp_f32 v73, v73
    v_mfma_f32_16x16x32_bf16 v[244:247], a[164:167], v[48:51], v[244:247]
    buffer_load_dwordx4 v2, s[16:19], s35 offen offset:0 lds
    v_cvt_pk_bf16_f32 v60, v72, v73
    v_mfma_f32_16x16x32_bf16 v[244:247], a[196:199], v[52:55], v[244:247]
    v_exp_f32 v74, v74
    v_mfma_f32_16x16x32_bf16 v[248:251], a[200:203], v[52:55], v[248:251]
    ds_read_b128 a[140:143], v4 offset:15360
    ds_read_b128 a[136:139], v4 offset:14336
    v_mfma_f32_16x16x32_bf16 v[248:251], a[168:171], v[48:51], v[248:251]
    v_exp_f32 v75, v75
    v_mfma_f32_16x16x32_bf16 v[252:255], a[172:175], v[48:51], v[252:255]
    buffer_load_dwordx4 v2, s[16:19], s35 offen offset:1024 lds
    v_cvt_pk_bf16_f32 v187, v190, v191
    v_mfma_f32_16x16x32_bf16 v[252:255], a[204:207], v[52:55], v[252:255]
    s_waitcnt lgkmcnt(4)
    v_exp_f32 v76, v76
    v_mfma_f32_16x16x32_bf16 v[64:67], a[80:83], a[48:51], -4.0
    ds_read_b128 a[132:135], v4 offset:13312
    v_cvt_pk_bf16_f32 v61, v74, v75
    v_mfma_f32_16x16x32_bf16 v[64:67], a[84:87], a[52:55], v[64:67]
    v_exp_f32 v77, v77
    v_mfma_f32_16x16x32_bf16 v[64:67], a[88:91], a[56:59], v[64:67]
    ds_read_b128 a[128:131], v4 offset:12288
    v_cvt_pk_bf16_f32 v62, v76, v77
    v_mfma_f32_16x16x32_bf16 v[64:67], a[92:95], a[60:63], v[64:67]
    v_exp_f32 v78, v78
    v_mfma_f32_16x16x32_bf16 v[68:71], a[108:111], a[60:63], -4.0
    v_exp_f32 v79, v79
    v_mfma_f32_16x16x32_bf16 v[68:71], a[104:107], a[56:59], v[68:71]
    v_cvt_pk_bf16_f32 v63, v78, v79
    v_mfma_f32_16x16x32_bf16 v[68:71], a[100:103], a[52:55], v[68:71]
    s_waitcnt vmcnt(11)
    buffer_store_dwordx4 v[184:187], v1, s[20:23], s34 offen offset:192 sc1
    v_mfma_f32_16x16x32_bf16 v[68:71], a[96:99], a[48:51], v[68:71]
    s_add_u32 s34, s34, s38
    v_exp_f32 v64, v64
    v_smfmac_f32_16x16x64_bf16 v[36:39], v[24:27], v[56:63], v9
    s_barrier
    v_mfma_f32_16x16x32_bf16 v[96:99], a[176:179], v[60:63], v[96:99]
    v_exp_f32 v65, v65
    v_mfma_f32_16x16x32_bf16 v[96:99], a[144:147], v[56:59], v[96:99]
    ds_read_b64_tr_b16 a[176:177], v5 offset:8192
    ds_read_b64_tr_b16 a[178:179], v5 offset:12288
    v_mfma_f32_16x16x32_bf16 v[100:103], a[148:151], v[56:59], v[100:103]
    v_exp_f32 v66, v66
    v_mfma_f32_16x16x32_bf16 v[100:103], a[180:183], v[60:63], v[100:103]
    ds_read_b64_tr_b16 a[144:145], v5 offset:0
    ds_read_b64_tr_b16 a[146:147], v5 offset:4096
    v_mfma_f32_16x16x32_bf16 v[104:107], a[184:187], v[60:63], v[104:107]
    v_exp_f32 v67, v67
    v_mfma_f32_16x16x32_bf16 v[104:107], a[152:155], v[56:59], v[104:107]
    ds_read_b64_tr_b16 a[148:149], v5 offset:8
    ds_read_b64_tr_b16 a[150:151], v5 offset:4104
    v_mfma_f32_16x16x32_bf16 v[108:111], a[156:159], v[56:59], v[108:111]
    v_exp_f32 v68, v68
    v_mfma_f32_16x16x32_bf16 v[108:111], a[188:191], v[60:63], v[108:111]
    ds_read_b64_tr_b16 a[180:181], v5 offset:8200
    ds_read_b64_tr_b16 a[182:183], v5 offset:12296
    v_mfma_f32_16x16x32_bf16 v[72:75], a[112:115], a[48:51], -4.0
    v_exp_f32 v69, v69
    v_mfma_f32_16x16x32_bf16 v[72:75], a[116:119], a[52:55], v[72:75]
    s_waitcnt lgkmcnt(6)
    ds_read_b64_tr_b16 a[184:185], v5 offset:8448
    ds_read_b64_tr_b16 a[186:187], v5 offset:12544
    v_mfma_f32_16x16x32_bf16 v[72:75], a[120:123], a[56:59], v[72:75]
    v_exp_f32 v70, v70
    v_mfma_f32_16x16x32_bf16 v[72:75], a[124:127], a[60:63], v[72:75]
    ds_read_b64_tr_b16 a[152:153], v5 offset:256
    v_cvt_pk_bf16_f32 v48, v64, v65
    v_mfma_f32_16x16x32_bf16 v[76:79], a[140:143], a[60:63], -4.0
    v_exp_f32 v71, v71
    v_mfma_f32_16x16x32_bf16 v[76:79], a[136:139], a[56:59], v[76:79]
    ds_read_b64_tr_b16 a[154:155], v5 offset:4352
    v_cvt_pk_bf16_f32 v49, v66, v67
    v_mfma_f32_16x16x32_bf16 v[76:79], a[132:135], a[52:55], v[76:79]
    v_exp_f32 v72, v72
    v_mfma_f32_16x16x32_bf16 v[76:79], a[128:131], a[48:51], v[76:79]
    ds_read_b64_tr_b16 a[156:157], v5 offset:264
    v_cvt_pk_bf16_f32 v50, v68, v69
    v_mfma_f32_16x16x32_bf16 v[112:115], a[192:195], v[60:63], v[112:115]
    v_exp_f32 v73, v73
    v_mfma_f32_16x16x32_bf16 v[112:115], a[160:163], v[56:59], v[112:115]
    ds_read_b64_tr_b16 a[192:193], v5 offset:8704
    ds_read_b64_tr_b16 a[194:195], v5 offset:12800
    v_mfma_f32_16x16x32_bf16 v[116:119], a[164:167], v[56:59], v[116:119]
    v_exp_f32 v74, v74
    v_mfma_f32_16x16x32_bf16 v[116:119], a[196:199], v[60:63], v[116:119]
    ds_read_b64_tr_b16 a[160:161], v5 offset:512
    ds_read_b64_tr_b16 a[158:159], v5 offset:4360
    v_mfma_f32_16x16x32_bf16 v[120:123], a[200:203], v[60:63], v[120:123]
    v_exp_f32 v75, v75
    v_mfma_f32_16x16x32_bf16 v[120:123], a[168:171], v[56:59], v[120:123]
    ds_read_b64_tr_b16 a[188:189], v5 offset:8456
    v_cvt_pk_bf16_f32 v51, v70, v71
    v_mfma_f32_16x16x32_bf16 v[124:127], a[172:175], v[56:59], v[124:127]
    ds_read_b64_tr_b16 a[162:163], v5 offset:4608
    ds_read_b64_tr_b16 a[164:165], v5 offset:520
    v_mfma_f32_16x16x32_bf16 v[124:127], a[204:207], v[60:63], v[124:127]
    v_exp_f32 v76, v76
    v_mfma_f32_16x16x32_bf16 v[64:67], a[80:83], a[64:67], -4.0
    ds_read_b64_tr_b16 a[190:191], v5 offset:12552
    v_cvt_pk_bf16_f32 v52, v72, v73
    v_mfma_f32_16x16x32_bf16 v[64:67], a[84:87], a[68:71], v[64:67]
    ds_read_b64_tr_b16 a[166:167], v5 offset:4616
    v_cvt_pk_bf16_f32 v53, v74, v75
    v_mfma_f32_16x16x32_bf16 v[64:67], a[88:91], a[72:75], v[64:67]
    ds_read_b64_tr_b16 a[196:197], v5 offset:8712
    ds_read_b64_tr_b16 a[198:199], v5 offset:12808
    v_mfma_f32_16x16x32_bf16 v[64:67], a[92:95], a[76:79], v[64:67]
    v_exp_f32 v77, v77
    v_mfma_f32_16x16x32_bf16 v[68:71], a[108:111], a[76:79], -4.0
    v_cvt_pk_bf16_f32 v54, v76, v77
    v_exp_f32 v78, v78
    v_mfma_f32_16x16x32_bf16 v[68:71], a[104:107], a[72:75], v[68:71]
    ds_read_b64_tr_b16 a[200:201], v5 offset:8960
    v_exp_f32 v79, v79
    v_mfma_f32_16x16x32_bf16 v[68:71], a[100:103], a[68:71], v[68:71]
    ds_read_b64_tr_b16 a[202:203], v5 offset:13056
    v_cvt_pk_bf16_f32 v55, v78, v79
    v_mfma_f32_16x16x32_bf16 v[68:71], a[96:99], a[64:67], v[68:71]
    v_exp_f32 v64, v64
    v_smfmac_f32_16x16x64_bf16 v[42:45], v[24:27], v[48:55], v9
    ds_read_b64_tr_b16 a[168:169], v5 offset:768
    ds_read_b64_tr_b16 a[170:171], v5 offset:4864
    v_mfma_f32_16x16x32_bf16 v[192:195], a[176:179], v[52:55], v[192:195]
    s_waitcnt lgkmcnt(6)
    v_exp_f32 v65, v65
    v_mfma_f32_16x16x32_bf16 v[192:195], a[144:147], v[48:51], v[192:195]
    ds_read_b64_tr_b16 a[172:173], v5 offset:776
    ds_read_b64_tr_b16 a[174:175], v5 offset:4872
    v_mfma_f32_16x16x32_bf16 v[196:199], a[148:151], v[48:51], v[196:199]
    v_exp_f32 v66, v66
    v_mfma_f32_16x16x32_bf16 v[196:199], a[180:183], v[52:55], v[196:199]
    ds_read_b64_tr_b16 a[204:205], v5 offset:8968
    ds_read_b64_tr_b16 a[206:207], v5 offset:13064
    v_mfma_f32_16x16x32_bf16 v[200:203], a[184:187], v[52:55], v[200:203]
    v_exp_f32 v67, v67
    v_mfma_f32_16x16x32_bf16 v[200:203], a[152:155], v[48:51], v[200:203]
    v_cvt_pk_bf16_f32 v56, v64, v65
    v_cvt_pk_bf16_f32 v57, v66, v67
    v_mfma_f32_16x16x32_bf16 v[204:207], a[156:159], v[48:51], v[204:207]
    v_exp_f32 v68, v68
    v_mfma_f32_16x16x32_bf16 v[204:207], a[188:191], v[52:55], v[204:207]
    v_exp_f32 v69, v69
    v_mfma_f32_16x16x32_bf16 v[72:75], a[112:115], a[64:67], -4.0
    v_cvt_pk_bf16_f32 v58, v68, v69
    v_add_f32 v29, v42, v43
    v_mfma_f32_16x16x32_bf16 v[72:75], a[116:119], a[68:71], v[72:75]
    v_exp_f32 v70, v70
    v_mfma_f32_16x16x32_bf16 v[72:75], a[120:123], a[72:75], v[72:75]
    v_exp_f32 v71, v71
    v_mfma_f32_16x16x32_bf16 v[72:75], a[124:127], a[76:79], v[72:75]
    v_rcp_f32 v13, v29
    v_mfma_f32_16x16x32_bf16 v[76:79], a[140:143], a[76:79], -4.0
    v_cvt_pk_bf16_f32 v59, v70, v71
    v_mul_f32_e64 v31, -v32, v13
    v_mfma_f32_16x16x32_bf16 v[76:79], a[136:139], a[72:75], v[76:79]
    v_subrev_u32 v29, s30, v29
    v_mfma_f32_16x16x32_bf16 v[76:79], a[132:135], a[68:71], v[76:79]
    v_exp_f32 v72, v72
    v_mfma_f32_16x16x32_bf16 v[76:79], a[128:131], a[64:67], v[76:79]
    v_exp_f32 v73, v73
    v_mfma_f32_16x16x32_bf16 v[208:211], a[192:195], v[52:55], v[208:211]
    v_exp_f32 v74, v74
    v_mfma_f32_16x16x32_bf16 v[208:211], a[160:163], v[48:51], v[208:211]
    v_exp_f32 v75, v75
    v_mfma_f32_16x16x32_bf16 v[212:215], a[164:167], v[48:51], v[212:215]
    s_waitcnt lgkmcnt(0)
    v_cvt_pk_bf16_f32 v60, v72, v73
    v_cvt_pk_bf16_f32 v61, v74, v75
    v_mfma_f32_16x16x32_bf16 v[212:215], a[196:199], v[52:55], v[212:215]
    v_exp_f32 v76, v76
    v_mfma_f32_16x16x32_bf16 v[216:219], a[200:203], v[52:55], v[216:219]
    v_exp_f32 v77, v77
    v_mfma_f32_16x16x32_bf16 v[216:219], a[168:171], v[48:51], v[216:219]
    v_exp_f32 v78, v78
    v_mfma_f32_16x16x32_bf16 v[220:223], a[172:175], v[48:51], v[220:223]
    s_mov_b32 s35, 0x1c000
    v_exp_f32 v79, v79
    v_mfma_f32_16x16x32_bf16 v[220:223], a[204:207], v[52:55], v[220:223]
    s_barrier
    v_mfma_f32_16x16x32_bf16 v[64:67], a[80:83], a[0:3], -4.0
    s_sub_u32 m0, s48, 0x10000
    v_cvt_pk_bf16_f32 v62, v76, v77
    v_cvt_pk_bf16_f32 v63, v78, v79
    v_mfma_f32_16x16x32_bf16 v[64:67], a[84:87], a[4:7], v[64:67]
    ds_read_b128 a[80:83], v4 offset:16384
    v_mfma_f32_16x16x32_bf16 v[64:67], a[88:91], a[8:11], v[64:67]
    ds_read_b128 a[84:87], v4 offset:17408
    v_mfma_f32_16x16x32_bf16 v[64:67], a[92:95], a[12:15], v[64:67]
    buffer_load_dwordx4 v2, s[16:19], s35 offen offset:0 lds
    v_pk_fma_f32 v[192:193], v[192:193], v[12:13], v[30:31] op_sel:[0,1,1] op_sel_hi:[1,1,1]
    v_pk_fma_f32 v[194:195], v[194:195], v[12:13], v[30:31] op_sel:[0,1,1] op_sel_hi:[1,1,1]
    v_pk_fma_f32 v[196:197], v[196:197], v[12:13], v[30:31] op_sel:[0,1,1] op_sel_hi:[1,1,1]
    v_pk_fma_f32 v[198:199], v[198:199], v[12:13], v[30:31] op_sel:[0,1,1] op_sel_hi:[1,1,1]
    v_pk_fma_f32 v[200:201], v[200:201], v[12:13], v[30:31] op_sel:[0,1,1] op_sel_hi:[1,1,1]
    v_pk_fma_f32 v[202:203], v[202:203], v[12:13], v[30:31] op_sel:[0,1,1] op_sel_hi:[1,1,1]
    v_pk_fma_f32 v[204:205], v[204:205], v[12:13], v[30:31] op_sel:[0,1,1] op_sel_hi:[1,1,1]
    v_pk_fma_f32 v[206:207], v[206:207], v[12:13], v[30:31] op_sel:[0,1,1] op_sel_hi:[1,1,1]
    v_pk_fma_f32 v[208:209], v[208:209], v[12:13], v[30:31] op_sel:[0,1,1] op_sel_hi:[1,1,1]
    v_pk_fma_f32 v[210:211], v[210:211], v[12:13], v[30:31] op_sel:[0,1,1] op_sel_hi:[1,1,1]
    v_pk_fma_f32 v[212:213], v[212:213], v[12:13], v[30:31] op_sel:[0,1,1] op_sel_hi:[1,1,1]
    v_pk_fma_f32 v[214:215], v[214:215], v[12:13], v[30:31] op_sel:[0,1,1] op_sel_hi:[1,1,1]
    v_pk_fma_f32 v[216:217], v[216:217], v[12:13], v[30:31] op_sel:[0,1,1] op_sel_hi:[1,1,1]
    v_pk_fma_f32 v[218:219], v[218:219], v[12:13], v[30:31] op_sel:[0,1,1] op_sel_hi:[1,1,1]
    v_pk_fma_f32 v[220:221], v[220:221], v[12:13], v[30:31] op_sel:[0,1,1] op_sel_hi:[1,1,1]
    v_pk_fma_f32 v[222:223], v[222:223], v[12:13], v[30:31] op_sel:[0,1,1] op_sel_hi:[1,1,1]
    v_mfma_f32_16x16x32_bf16 v[68:71], a[108:111], a[12:15], -4.0
    ds_read_b128 a[88:91], v4 offset:18432
    v_max3_f32 v14, abs(v192), abs(v193), abs(v194)
    v_mfma_f32_16x16x32_bf16 v[68:71], a[104:107], a[8:11], v[68:71]
    ds_read_b128 a[92:95], v4 offset:19456
    v_cvt_pk_bf16_f32 v192, v192, v193
    v_mfma_f32_16x16x32_bf16 v[68:71], a[100:103], a[4:7], v[68:71]
    v_exp_f32 v64, v64
    v_mfma_f32_16x16x32_bf16 v[68:71], a[96:99], a[0:3], v[68:71]
    buffer_load_dwordx4 v2, s[16:19], s35 offen offset:1024 lds
    v_cvt_pk_bf16_f32 v193, v194, v195
    v_smfmac_f32_16x16x64_bf16 v[44:47], v[24:27], v[56:63], v9
    s_sub_u32 m0, s48, 0xe000
    ds_read_b128 a[108:111], v4 offset:23552
    v_cvt_pk_bf16_f32 v194, v196, v197
    v_mfma_f32_16x16x32_bf16 v[224:227], a[176:179], v[60:63], v[224:227]
    s_mov_b32 s35, 0x1e000
    v_exp_f32 v65, v65
    v_mfma_f32_16x16x32_bf16 v[224:227], a[144:147], v[56:59], v[224:227]
    ds_read_b128 a[104:107], v4 offset:22528
    v_max3_f32 v14, v14, abs(v195), abs(v196)
    v_mfma_f32_16x16x32_bf16 v[228:231], a[148:151], v[56:59], v[228:231]
    v_exp_f32 v66, v66
    v_mfma_f32_16x16x32_bf16 v[228:231], a[180:183], v[60:63], v[228:231]
    buffer_load_dwordx4 v2, s[16:19], s35 offen offset:0 lds
    v_cvt_pk_bf16_f32 v195, v198, v199
    v_mfma_f32_16x16x32_bf16 v[232:235], a[184:187], v[60:63], v[232:235]
    v_exp_f32 v67, v67
    v_mfma_f32_16x16x32_bf16 v[232:235], a[152:155], v[56:59], v[232:235]
    ds_read_b128 a[100:103], v4 offset:21504
    ds_read_b128 a[96:99], v4 offset:20480
    v_mfma_f32_16x16x32_bf16 v[236:239], a[156:159], v[56:59], v[236:239]
    v_exp_f32 v68, v68
    v_mfma_f32_16x16x32_bf16 v[236:239], a[188:191], v[60:63], v[236:239]
    buffer_load_dwordx4 v2, s[16:19], s35 offen offset:1024 lds
    v_fma_f32 v14, v14, s42, v31
    v_mfma_f32_16x16x32_bf16 v[72:75], a[112:115], a[0:3], -4.0
    v_exp_f32 v69, v69
    v_mfma_f32_16x16x32_bf16 v[72:75], a[116:119], a[4:7], v[72:75]
    ds_read_b128 a[112:115], v4 offset:24576
    v_and_or_b32 v14, v14, s43, v29
    v_mfma_f32_16x16x32_bf16 v[72:75], a[120:123], a[8:11], v[72:75]
    v_exp_f32 v70, v70
    v_mfma_f32_16x16x32_bf16 v[72:75], a[124:127], a[12:15], v[72:75]
    ds_read_b128 a[116:119], v4 offset:25600
    v_cmp_lt_u32_e64 s[4:5], s31, v14
    v_mfma_f32_16x16x32_bf16 v[76:79], a[140:143], a[12:15], -4.0
    buffer_store_dwordx4 v[192:195], v1, s[20:23], s34 offen offset:0 sc1
    v_mfma_f32_16x16x32_bf16 v[76:79], a[136:139], a[8:11], v[76:79]
    s_cmp_lg_u64 s[4:5], 0
    ds_read_b128 a[120:123], v4 offset:26624
    v_cvt_pk_bf16_f32 v48, v64, v65
    v_mfma_f32_16x16x32_bf16 v[76:79], a[132:135], a[4:7], v[76:79]
    s_addc_u32 s32, s32, s32
    v_exp_f32 v71, v71
    v_mfma_f32_16x16x32_bf16 v[76:79], a[128:131], a[0:3], v[76:79]
    ds_read_b128 a[124:127], v4 offset:27648
    v_cvt_pk_bf16_f32 v49, v66, v67
    v_mfma_f32_16x16x32_bf16 v[240:243], a[192:195], v[60:63], v[240:243]
    v_exp_f32 v72, v72
    v_mfma_f32_16x16x32_bf16 v[240:243], a[160:163], v[56:59], v[240:243]
    ds_read_b128 a[140:143], v4 offset:31744
    v_cvt_pk_bf16_f32 v50, v68, v69
    v_mfma_f32_16x16x32_bf16 v[244:247], a[164:167], v[56:59], v[244:247]
    v_exp_f32 v73, v73
    v_mfma_f32_16x16x32_bf16 v[244:247], a[196:199], v[60:63], v[244:247]
    v_cvt_pk_bf16_f32 v51, v70, v71
    v_cvt_pk_bf16_f32 v52, v72, v73
    v_mfma_f32_16x16x32_bf16 v[248:251], a[200:203], v[60:63], v[248:251]
    v_exp_f32 v74, v74
    v_mfma_f32_16x16x32_bf16 v[248:251], a[168:171], v[56:59], v[248:251]
    ds_read_b128 a[136:139], v4 offset:30720
    ds_read_b128 a[132:135], v4 offset:29696
    v_mfma_f32_16x16x32_bf16 v[252:255], a[172:175], v[56:59], v[252:255]
    v_exp_f32 v75, v75
    v_mfma_f32_16x16x32_bf16 v[252:255], a[204:207], v[60:63], v[252:255]
    s_waitcnt lgkmcnt(3)
    ds_read_b128 a[128:131], v4 offset:28672
    v_cvt_pk_bf16_f32 v53, v74, v75
    v_mfma_f32_16x16x32_bf16 v[64:67], a[80:83], a[64:67], -4.0
    v_exp_f32 v76, v76
    v_mfma_f32_16x16x32_bf16 v[64:67], a[84:87], a[68:71], v[64:67]
    v_exp_f32 v77, v77
    v_mfma_f32_16x16x32_bf16 v[64:67], a[88:91], a[72:75], v[64:67]
    v_cvt_pk_bf16_f32 v54, v76, v77
    v_cvt_pk_bf16_f32 v200, v200, v201
    v_mfma_f32_16x16x32_bf16 v[64:67], a[92:95], a[76:79], v[64:67]
    v_exp_f32 v78, v78
    v_mfma_f32_16x16x32_bf16 v[68:71], a[108:111], a[76:79], -4.0
    v_exp_f32 v79, v79
    v_mfma_f32_16x16x32_bf16 v[68:71], a[104:107], a[72:75], v[68:71]
    v_cvt_pk_bf16_f32 v55, v78, v79
    v_cvt_pk_bf16_f32 v201, v202, v203
    v_mfma_f32_16x16x32_bf16 v[68:71], a[100:103], a[68:71], v[68:71]
    v_exp_f32 v64, v64
    v_mfma_f32_16x16x32_bf16 v[68:71], a[96:99], a[64:67], v[68:71]
    s_waitcnt vmcnt(10)
    v_cvt_pk_bf16_f32 v202, v204, v205
    v_cvt_pk_bf16_f32 v203, v206, v207
    v_smfmac_f32_16x16x64_bf16 v[36:39], v[24:27], v[48:55], v9
    s_barrier
    v_mfma_f32_16x16x32_bf16 v[96:99], a[176:179], v[52:55], v[96:99]
    v_exp_f32 v65, v65
    v_mfma_f32_16x16x32_bf16 v[96:99], a[144:147], v[48:51], v[96:99]
    ds_read_b64_tr_b16 a[176:177], v5 offset:24576
    ds_read_b64_tr_b16 a[178:179], v5 offset:28672
    v_mfma_f32_16x16x32_bf16 v[100:103], a[148:151], v[48:51], v[100:103]
    v_exp_f32 v66, v66
    v_mfma_f32_16x16x32_bf16 v[100:103], a[180:183], v[52:55], v[100:103]
    ds_read_b64_tr_b16 a[144:145], v5 offset:16384
    ds_read_b64_tr_b16 a[146:147], v5 offset:20480
    v_mfma_f32_16x16x32_bf16 v[104:107], a[184:187], v[52:55], v[104:107]
    v_exp_f32 v67, v67
    v_mfma_f32_16x16x32_bf16 v[104:107], a[152:155], v[48:51], v[104:107]
    ds_read_b64_tr_b16 a[148:149], v5 offset:16392
    ds_read_b64_tr_b16 a[150:151], v5 offset:20488
    v_mfma_f32_16x16x32_bf16 v[108:111], a[156:159], v[48:51], v[108:111]
    v_exp_f32 v68, v68
    v_mfma_f32_16x16x32_bf16 v[108:111], a[188:191], v[52:55], v[108:111]
    ds_read_b64_tr_b16 a[180:181], v5 offset:24584
    ds_read_b64_tr_b16 a[182:183], v5 offset:28680
    v_mfma_f32_16x16x32_bf16 v[72:75], a[112:115], a[64:67], -4.0
    v_exp_f32 v69, v69
    v_mfma_f32_16x16x32_bf16 v[72:75], a[116:119], a[68:71], v[72:75]
    ds_read_b64_tr_b16 a[184:185], v5 offset:24832
    ds_read_b64_tr_b16 a[186:187], v5 offset:28928
    v_mfma_f32_16x16x32_bf16 v[72:75], a[120:123], a[72:75], v[72:75]
    buffer_store_dwordx4 v[200:203], v1, s[20:23], s34 offen offset:64 sc1
    v_mfma_f32_16x16x32_bf16 v[72:75], a[124:127], a[76:79], v[72:75]
    s_waitcnt lgkmcnt(6)
    ds_read_b64_tr_b16 a[152:153], v5 offset:16640
    v_cvt_pk_bf16_f32 v56, v64, v65
    v_mfma_f32_16x16x32_bf16 v[76:79], a[140:143], a[76:79], -4.0
    v_exp_f32 v70, v70
    v_mfma_f32_16x16x32_bf16 v[76:79], a[136:139], a[72:75], v[76:79]
    ds_read_b64_tr_b16 a[154:155], v5 offset:20736
    v_cvt_pk_bf16_f32 v57, v66, v67
    v_mfma_f32_16x16x32_bf16 v[76:79], a[132:135], a[68:71], v[76:79]
    v_exp_f32 v71, v71
    v_mfma_f32_16x16x32_bf16 v[76:79], a[128:131], a[64:67], v[76:79]
    ds_read_b64_tr_b16 a[156:157], v5 offset:16648
    v_cvt_pk_bf16_f32 v58, v68, v69
    v_mfma_f32_16x16x32_bf16 v[112:115], a[192:195], v[52:55], v[112:115]
    v_exp_f32 v72, v72
    v_mfma_f32_16x16x32_bf16 v[112:115], a[160:163], v[48:51], v[112:115]
    ds_read_b64_tr_b16 a[192:193], v5 offset:25088
    ds_read_b64_tr_b16 a[194:195], v5 offset:29184
    v_mfma_f32_16x16x32_bf16 v[116:119], a[164:167], v[48:51], v[116:119]
    v_exp_f32 v73, v73
    v_mfma_f32_16x16x32_bf16 v[116:119], a[196:199], v[52:55], v[116:119]
    ds_read_b64_tr_b16 a[160:161], v5 offset:16896
    ds_read_b64_tr_b16 a[158:159], v5 offset:20744
    v_mfma_f32_16x16x32_bf16 v[120:123], a[200:203], v[52:55], v[120:123]
    v_exp_f32 v74, v74
    v_mfma_f32_16x16x32_bf16 v[120:123], a[168:171], v[48:51], v[120:123]
    ds_read_b64_tr_b16 a[188:189], v5 offset:24840
    v_cvt_pk_bf16_f32 v59, v70, v71
    v_mfma_f32_16x16x32_bf16 v[124:127], a[172:175], v[48:51], v[124:127]
    ds_read_b64_tr_b16 a[162:163], v5 offset:20992
    ds_read_b64_tr_b16 a[164:165], v5 offset:16904
    v_mfma_f32_16x16x32_bf16 v[124:127], a[204:207], v[52:55], v[124:127]
L_st12:
    s_cbranch_execz L_wret
    v_exp_f32 v75, v75
    v_mfma_f32_16x16x32_bf16 v[64:67], a[80:83], a[0:3], -4.0
    ds_read_b64_tr_b16 a[190:191], v5 offset:28936
    v_cvt_pk_bf16_f32 v60, v72, v73
    v_mfma_f32_16x16x32_bf16 v[64:67], a[84:87], a[4:7], v[64:67]
    ds_read_b64_tr_b16 a[166:167], v5 offset:21000
    v_cvt_pk_bf16_f32 v61, v74, v75
    v_mfma_f32_16x16x32_bf16 v[64:67], a[88:91], a[8:11], v[64:67]
    ds_read_b64_tr_b16 a[196:197], v5 offset:25096
    v_exp_f32 v76, v76
    v_mfma_f32_16x16x32_bf16 v[64:67], a[92:95], a[12:15], v[64:67]
    ds_read_b128 a[80:83], v4 offset:32768
    v_exp_f32 v77, v77
    v_mfma_f32_16x16x32_bf16 v[68:71], a[108:111], a[12:15], -4.0
    ds_read_b64_tr_b16 a[198:199], v5 offset:29192
    v_cvt_pk_bf16_f32 v62, v76, v77
    v_exp_f32 v78, v78
    v_mfma_f32_16x16x32_bf16 v[68:71], a[104:107], a[8:11], v[68:71]
    ds_read_b64_tr_b16 a[200:201], v5 offset:25344
    v_exp_f32 v79, v79
    v_mfma_f32_16x16x32_bf16 v[68:71], a[100:103], a[4:7], v[68:71]
    ds_read_b128 a[84:87], v4 offset:33792
    v_cvt_pk_bf16_f32 v63, v78, v79
    v_mfma_f32_16x16x32_bf16 v[68:71], a[96:99], a[0:3], v[68:71]
    ds_read_b64_tr_b16 a[202:203], v5 offset:29440
    v_cvt_pk_bf16_f32 v208, v208, v209
    v_smfmac_f32_16x16x64_bf16 v[44:47], v[24:27], v[56:63], v9
    ds_read_b64_tr_b16 a[168:169], v5 offset:17152
    ds_read_b128 a[88:91], v4 offset:34816
    v_mfma_f32_16x16x32_bf16 v[224:227], a[176:179], v[60:63], v[224:227]
    ds_read_b64_tr_b16 a[170:171], v5 offset:21248
    v_cvt_pk_bf16_f32 v209, v210, v211
    v_mfma_f32_16x16x32_bf16 v[224:227], a[144:147], v[56:59], v[224:227]
    s_waitcnt lgkmcnt(8)
    v_exp_f32 v64, v64
    v_mfma_f32_16x16x32_bf16 v[228:231], a[148:151], v[56:59], v[228:231]
    ds_read_b64_tr_b16 a[172:173], v5 offset:17160
    ds_read_b128 a[92:95], v4 offset:35840
    v_mfma_f32_16x16x32_bf16 v[228:231], a[180:183], v[60:63], v[228:231]
    ds_read_b64_tr_b16 a[174:175], v5 offset:21256
    v_cvt_pk_bf16_f32 v210, v212, v213
    v_mfma_f32_16x16x32_bf16 v[232:235], a[184:187], v[60:63], v[232:235]
    ds_read_b128 a[108:111], v4 offset:39936
    v_cvt_pk_bf16_f32 v211, v214, v215
    v_mfma_f32_16x16x32_bf16 v[232:235], a[152:155], v[56:59], v[232:235]
    ds_read_b64_tr_b16 a[204:205], v5 offset:25352
    ds_read_b64_tr_b16 a[206:207], v5 offset:29448
    v_mfma_f32_16x16x32_bf16 v[236:239], a[156:159], v[56:59], v[236:239]
    v_exp_f32 v65, v65
    v_mfma_f32_16x16x32_bf16 v[236:239], a[188:191], v[60:63], v[236:239]
    ds_read_b128 a[104:107], v4 offset:38912
    ds_read_b128 a[100:103], v4 offset:37888
    v_mfma_f32_16x16x32_bf16 v[72:75], a[112:115], a[0:3], -4.0
    buffer_store_dwordx4 v[208:211], v1, s[20:23], s34 offen offset:128 sc1
    v_mfma_f32_16x16x32_bf16 v[72:75], a[116:119], a[4:7], v[72:75]
    ds_read_b128 a[112:115], v4 offset:40960
    ds_read_b128 a[96:99], v4 offset:36864
    v_mfma_f32_16x16x32_bf16 v[72:75], a[120:123], a[8:11], v[72:75]
    v_exp_f32 v66, v66
    v_mfma_f32_16x16x32_bf16 v[72:75], a[124:127], a[12:15], v[72:75]
    ds_read_b128 a[116:119], v4 offset:41984
    v_cvt_pk_bf16_f32 v48, v64, v65
    v_mfma_f32_16x16x32_bf16 v[76:79], a[140:143], a[12:15], -4.0
    v_exp_f32 v67, v67
    v_mfma_f32_16x16x32_bf16 v[76:79], a[136:139], a[8:11], v[76:79]
    ds_read_b128 a[120:123], v4 offset:43008
    v_cvt_pk_bf16_f32 v49, v66, v67
    v_mfma_f32_16x16x32_bf16 v[76:79], a[132:135], a[4:7], v[76:79]
    v_exp_f32 v68, v68
    v_mfma_f32_16x16x32_bf16 v[76:79], a[128:131], a[0:3], v[76:79]
    ds_read_b128 a[124:127], v4 offset:44032
    ds_read_b128 a[140:143], v4 offset:48128
    v_mfma_f32_16x16x32_bf16 v[240:243], a[192:195], v[60:63], v[240:243]
    v_exp_f32 v69, v69
    v_mfma_f32_16x16x32_bf16 v[240:243], a[160:163], v[56:59], v[240:243]
    ds_read_b128 a[136:139], v4 offset:47104
    v_cvt_pk_bf16_f32 v50, v68, v69
    v_mfma_f32_16x16x32_bf16 v[244:247], a[164:167], v[56:59], v[244:247]
    s_waitcnt lgkmcnt(5)
    v_exp_f32 v70, v70
    v_mfma_f32_16x16x32_bf16 v[244:247], a[196:199], v[60:63], v[244:247]
    ds_read_b128 a[132:135], v4 offset:46080
    ds_read_b128 a[128:131], v4 offset:45056
    v_mfma_f32_16x16x32_bf16 v[248:251], a[200:203], v[60:63], v[248:251]
    v_exp_f32 v71, v71
    v_mfma_f32_16x16x32_bf16 v[248:251], a[168:171], v[56:59], v[248:251]
    v_cvt_pk_bf16_f32 v51, v70, v71
    v_cvt_pk_bf16_f32 v216, v216, v217
    v_mfma_f32_16x16x32_bf16 v[252:255], a[172:175], v[56:59], v[252:255]
    v_exp_f32 v72, v72
    v_mfma_f32_16x16x32_bf16 v[252:255], a[204:207], v[60:63], v[252:255]
    v_exp_f32 v73, v73
    v_mfma_f32_16x16x32_bf16 v[64:67], a[80:83], a[64:67], -4.0
    v_cvt_pk_bf16_f32 v52, v72, v73
    v_exp_f32 v74, v74
    v_mfma_f32_16x16x32_bf16 v[64:67], a[84:87], a[68:71], v[64:67]
    v_exp_f32 v75, v75
    v_mfma_f32_16x16x32_bf16 v[64:67], a[88:91], a[72:75], v[64:67]
    v_cvt_pk_bf16_f32 v53, v74, v75
    v_exp_f32 v76, v76
    v_mfma_f32_16x16x32_bf16 v[64:67], a[92:95], a[76:79], v[64:67]
    v_exp_f32 v77, v77
    v_mfma_f32_16x16x32_bf16 v[68:71], a[108:111], a[76:79], -4.0
    v_cvt_pk_bf16_f32 v54, v76, v77
    v_exp_f32 v78, v78
    v_mfma_f32_16x16x32_bf16 v[68:71], a[104:107], a[72:75], v[68:71]
    v_exp_f32 v79, v79
    v_mfma_f32_16x16x32_bf16 v[68:71], a[100:103], a[68:71], v[68:71]
    v_cvt_pk_bf16_f32 v55, v78, v79
    v_cvt_pk_bf16_f32 v217, v218, v219
    v_mfma_f32_16x16x32_bf16 v[68:71], a[96:99], a[64:67], v[68:71]
    s_waitcnt vmcnt(3)
    v_exp_f32 v64, v64
    v_smfmac_f32_16x16x64_bf16 v[36:39], v[24:27], v[48:55], v9
    s_barrier
    v_mfma_f32_16x16x32_bf16 v[96:99], a[176:179], v[52:55], v[96:99]
    v_exp_f32 v65, v65
    v_mfma_f32_16x16x32_bf16 v[96:99], a[144:147], v[48:51], v[96:99]
    ds_read_b64_tr_b16 a[176:177], v10 offset:8192
    v_cvt_pk_bf16_f32 v218, v220, v221
    v_mfma_f32_16x16x32_bf16 v[100:103], a[148:151], v[48:51], v[100:103]
    v_exp_f32 v66, v66
    v_mfma_f32_16x16x32_bf16 v[100:103], a[180:183], v[52:55], v[100:103]
    ds_read_b64_tr_b16 a[178:179], v10 offset:12288
    v_cvt_pk_bf16_f32 v219, v222, v223
    v_mfma_f32_16x16x32_bf16 v[104:107], a[184:187], v[52:55], v[104:107]
    ds_read_b64_tr_b16 a[144:145], v10 offset:0
    ds_read_b64_tr_b16 a[146:147], v10 offset:4096
    v_mfma_f32_16x16x32_bf16 v[104:107], a[152:155], v[48:51], v[104:107]
    v_exp_f32 v67, v67
    v_mfma_f32_16x16x32_bf16 v[108:111], a[156:159], v[48:51], v[108:111]
    ds_read_b64_tr_b16 a[148:149], v10 offset:8
    ds_read_b64_tr_b16 a[150:151], v10 offset:4104
    v_mfma_f32_16x16x32_bf16 v[108:111], a[188:191], v[52:55], v[108:111]
    s_waitcnt lgkmcnt(6)
    buffer_store_dwordx4 v[216:219], v1, s[20:23], s34 offen offset:192 sc1
    v_mfma_f32_16x16x32_bf16 v[72:75], a[112:115], a[64:67], -4.0
    s_add_u32 s34, s34, s38
    ds_read_b64_tr_b16 a[180:181], v10 offset:8200
    ds_read_b64_tr_b16 a[182:183], v10 offset:12296
    v_mfma_f32_16x16x32_bf16 v[72:75], a[116:119], a[68:71], v[72:75]
    v_exp_f32 v68, v68
    v_mfma_f32_16x16x32_bf16 v[72:75], a[120:123], a[72:75], v[72:75]
    ds_read_b64_tr_b16 a[184:185], v10 offset:8448
    ds_read_b64_tr_b16 a[186:187], v10 offset:12544
    v_mfma_f32_16x16x32_bf16 v[72:75], a[124:127], a[76:79], v[72:75]
    v_exp_f32 v69, v69
    v_mfma_f32_16x16x32_bf16 v[76:79], a[140:143], a[76:79], -4.0
    ds_read_b64_tr_b16 a[152:153], v10 offset:256
    v_cvt_pk_bf16_f32 v56, v64, v65
    v_mfma_f32_16x16x32_bf16 v[76:79], a[136:139], a[72:75], v[76:79]
    v_exp_f32 v70, v70
    v_mfma_f32_16x16x32_bf16 v[76:79], a[132:135], a[68:71], v[76:79]
    ds_read_b64_tr_b16 a[154:155], v10 offset:4352
    v_cvt_pk_bf16_f32 v57, v66, v67
    v_mfma_f32_16x16x32_bf16 v[76:79], a[128:131], a[64:67], v[76:79]
    v_exp_f32 v71, v71
    v_mfma_f32_16x16x32_bf16 v[112:115], a[192:195], v[52:55], v[112:115]
    ds_read_b64_tr_b16 a[192:193], v10 offset:8704
    ds_read_b64_tr_b16 a[156:157], v10 offset:264
    v_mfma_f32_16x16x32_bf16 v[112:115], a[160:163], v[48:51], v[112:115]
    v_exp_f32 v72, v72
    v_mfma_f32_16x16x32_bf16 v[116:119], a[164:167], v[48:51], v[116:119]
    ds_read_b64_tr_b16 a[194:195], v10 offset:12800
    v_cvt_pk_bf16_f32 v58, v68, v69
    v_mfma_f32_16x16x32_bf16 v[116:119], a[196:199], v[52:55], v[116:119]
    v_exp_f32 v73, v73
    v_mfma_f32_16x16x32_bf16 v[120:123], a[200:203], v[52:55], v[120:123]
    ds_read_b64_tr_b16 a[160:161], v10 offset:512
    ds_read_b64_tr_b16 a[158:159], v10 offset:4360
    v_mfma_f32_16x16x32_bf16 v[120:123], a[168:171], v[48:51], v[120:123]
    v_exp_f32 v74, v74
    v_mfma_f32_16x16x32_bf16 v[124:127], a[172:175], v[48:51], v[124:127]
    ds_read_b64_tr_b16 a[188:189], v10 offset:8456
    ds_read_b64_tr_b16 a[162:163], v10 offset:4608
    v_cvt_pk_bf16_f32 v59, v70, v71
    v_mfma_f32_16x16x32_bf16 v[124:127], a[204:207], v[52:55], v[124:127]
    ds_read_b64_tr_b16 a[164:165], v10 offset:520
    v_cvt_pk_bf16_f32 v60, v72, v73
    v_mfma_f32_16x16x32_bf16 v[64:67], a[80:83], a[0:3], -4.0
    ds_read_b64_tr_b16 a[190:191], v10 offset:12552
    ds_read_b64_tr_b16 a[166:167], v10 offset:4616
    v_mfma_f32_16x16x32_bf16 v[64:67], a[84:87], a[4:7], v[64:67]
    v_exp_f32 v75, v75
    v_mfma_f32_16x16x32_bf16 v[64:67], a[88:91], a[8:11], v[64:67]
    ds_read_b64_tr_b16 a[196:197], v10 offset:8712
    v_cvt_pk_bf16_f32 v61, v74, v75
    v_exp_f32 v76, v76
    v_mfma_f32_16x16x32_bf16 v[64:67], a[92:95], a[12:15], v[64:67]
    ds_read_b128 a[80:83], v4 offset:49152
    v_exp_f32 v77, v77
    v_mfma_f32_16x16x32_bf16 v[68:71], a[108:111], a[12:15], -4.0
    ds_read_b64_tr_b16 a[198:199], v10 offset:12808
    v_cvt_pk_bf16_f32 v62, v76, v77
    v_exp_f32 v78, v78
    v_mfma_f32_16x16x32_bf16 v[68:71], a[104:107], a[8:11], v[68:71]
    ds_read_b64_tr_b16 a[200:201], v10 offset:8960
    v_exp_f32 v79, v79
    v_mfma_f32_16x16x32_bf16 v[68:71], a[100:103], a[4:7], v[68:71]
    ds_read_b128 a[84:87], v4 offset:50176
    v_cvt_pk_bf16_f32 v63, v78, v79
    v_mfma_f32_16x16x32_bf16 v[68:71], a[96:99], a[0:3], v[68:71]
    ds_read_b64_tr_b16 a[202:203], v10 offset:13056
    ds_read_b64_tr_b16 a[168:169], v10 offset:768
    v_smfmac_f32_16x16x64_bf16 v[44:47], v[24:27], v[56:63], v9
    s_waitcnt lgkmcnt(7)
    ds_read_b128 a[88:91], v4 offset:51200
    ds_read_b64_tr_b16 a[170:171], v10 offset:4864
    v_mfma_f32_16x16x32_bf16 v[224:227], a[176:179], v[60:63], v[224:227]
    v_exp_f32 v64, v64
    v_mfma_f32_16x16x32_bf16 v[224:227], a[144:147], v[56:59], v[224:227]
    ds_read_b64_tr_b16 a[172:173], v10 offset:776
    ds_read_b128 a[92:95], v4 offset:52224
    v_mfma_f32_16x16x32_bf16 v[228:231], a[148:151], v[56:59], v[228:231]
    v_exp_f32 v65, v65
    v_mfma_f32_16x16x32_bf16 v[228:231], a[180:183], v[60:63], v[228:231]
    ds_read_b64_tr_b16 a[174:175], v10 offset:4872
    ds_read_b128 a[108:111], v4 offset:56320
    v_mfma_f32_16x16x32_bf16 v[232:235], a[184:187], v[60:63], v[232:235]
    v_exp_f32 v66, v66
    v_mfma_f32_16x16x32_bf16 v[232:235], a[152:155], v[56:59], v[232:235]
    ds_read_b64_tr_b16 a[204:205], v10 offset:8968
    ds_read_b64_tr_b16 a[206:207], v10 offset:13064
    v_mfma_f32_16x16x32_bf16 v[236:239], a[156:159], v[56:59], v[236:239]
    v_exp_f32 v67, v67
    v_mfma_f32_16x16x32_bf16 v[236:239], a[188:191], v[60:63], v[236:239]
    ds_read_b128 a[104:107], v4 offset:55296
    ds_read_b128 a[100:103], v4 offset:54272
    v_mfma_f32_16x16x32_bf16 v[72:75], a[112:115], a[0:3], -4.0
    v_exp_f32 v68, v68
    v_mfma_f32_16x16x32_bf16 v[72:75], a[116:119], a[4:7], v[72:75]
    ds_read_b128 a[112:115], v4 offset:57344
    ds_read_b128 a[96:99], v4 offset:53248
    v_mfma_f32_16x16x32_bf16 v[72:75], a[120:123], a[8:11], v[72:75]
    v_exp_f32 v69, v69
    v_mfma_f32_16x16x32_bf16 v[72:75], a[124:127], a[12:15], v[72:75]
    ds_read_b128 a[116:119], v4 offset:58368
    v_cvt_pk_bf16_f32 v48, v64, v65
    v_mfma_f32_16x16x32_bf16 v[76:79], a[140:143], a[12:15], -4.0
    v_exp_f32 v70, v70
    v_mfma_f32_16x16x32_bf16 v[76:79], a[136:139], a[8:11], v[76:79]
    ds_read_b128 a[120:123], v4 offset:59392
    v_cvt_pk_bf16_f32 v49, v66, v67
    v_mfma_f32_16x16x32_bf16 v[76:79], a[132:135], a[4:7], v[76:79]
    v_exp_f32 v71, v71
    v_mfma_f32_16x16x32_bf16 v[76:79], a[128:131], a[0:3], v[76:79]
    ds_read_b128 a[124:127], v4 offset:60416
    v_cvt_pk_bf16_f32 v50, v68, v69
    v_mfma_f32_16x16x32_bf16 v[240:243], a[192:195], v[60:63], v[240:243]
    v_exp_f32 v72, v72
    v_mfma_f32_16x16x32_bf16 v[240:243], a[160:163], v[56:59], v[240:243]
    ds_read_b128 a[140:143], v4 offset:64512
    v_cvt_pk_bf16_f32 v51, v70, v71
    v_mfma_f32_16x16x32_bf16 v[244:247], a[164:167], v[56:59], v[244:247]
    s_waitcnt lgkmcnt(4)
    v_exp_f32 v73, v73
    v_mfma_f32_16x16x32_bf16 v[244:247], a[196:199], v[60:63], v[244:247]
    v_add_f32 v28, v44, v45
    v_cvt_pk_bf16_f32 v52, v72, v73
    v_mfma_f32_16x16x32_bf16 v[248:251], a[200:203], v[60:63], v[248:251]
    v_exp_f32 v74, v74
    v_mfma_f32_16x16x32_bf16 v[248:251], a[168:171], v[56:59], v[248:251]
    ds_read_b128 a[136:139], v4 offset:63488
    ds_read_b128 a[132:135], v4 offset:62464
    v_mfma_f32_16x16x32_bf16 v[252:255], a[172:175], v[56:59], v[252:255]
    v_rcp_f32 v12, v28
    v_mfma_f32_16x16x32_bf16 v[252:255], a[204:207], v[60:63], v[252:255]
    ds_read_b128 a[128:131], v4 offset:61440
    v_mul_f32_e64 v30, -v32, v12
    v_mfma_f32_16x16x32_bf16 v[64:67], a[80:83], a[0:3], -4.0
    v_exp_f32 v75, v75
    v_mfma_f32_16x16x32_bf16 v[64:67], a[84:87], a[4:7], v[64:67]
    v_cvt_pk_bf16_f32 v53, v74, v75
    v_subrev_u32 v28, s30, v28
    v_mfma_f32_16x16x32_bf16 v[64:67], a[88:91], a[8:11], v[64:67]
    v_exp_f32 v76, v76
    v_mfma_f32_16x16x32_bf16 v[64:67], a[92:95], a[12:15], v[64:67]
    v_exp_f32 v77, v77
    v_exp_f32 v78, v78
    v_pk_fma_f32 v[224:225], v[224:225], v[12:13], v[30:31] op_sel:[0,0,0] op_sel_hi:[1,0,0]
    v_pk_fma_f32 v[226:227], v[226:227], v[12:13], v[30:31] op_sel:[0,0,0] op_sel_hi:[1,0,0]
    v_pk_fma_f32 v[228:229], v[228:229], v[12:13], v[30:31] op_sel:[0,0,0] op_sel_hi:[1,0,0]
    v_pk_fma_f32 v[230:231], v[230:231], v[12:13], v[30:31] op_sel:[0,0,0] op_sel_hi:[1,0,0]
    v_pk_fma_f32 v[232:233], v[232:233], v[12:13], v[30:31] op_sel:[0,0,0] op_sel_hi:[1,0,0]
    v_pk_fma_f32 v[234:235], v[234:235], v[12:13], v[30:31] op_sel:[0,0,0] op_sel_hi:[1,0,0]
    v_pk_fma_f32 v[236:237], v[236:237], v[12:13], v[30:31] op_sel:[0,0,0] op_sel_hi:[1,0,0]
    v_pk_fma_f32 v[238:239], v[238:239], v[12:13], v[30:31] op_sel:[0,0,0] op_sel_hi:[1,0,0]
    v_pk_fma_f32 v[240:241], v[240:241], v[12:13], v[30:31] op_sel:[0,0,0] op_sel_hi:[1,0,0]
    v_pk_fma_f32 v[242:243], v[242:243], v[12:13], v[30:31] op_sel:[0,0,0] op_sel_hi:[1,0,0]
    v_pk_fma_f32 v[244:245], v[244:245], v[12:13], v[30:31] op_sel:[0,0,0] op_sel_hi:[1,0,0]
    v_pk_fma_f32 v[246:247], v[246:247], v[12:13], v[30:31] op_sel:[0,0,0] op_sel_hi:[1,0,0]
    v_pk_fma_f32 v[248:249], v[248:249], v[12:13], v[30:31] op_sel:[0,0,0] op_sel_hi:[1,0,0]
    v_pk_fma_f32 v[250:251], v[250:251], v[12:13], v[30:31] op_sel:[0,0,0] op_sel_hi:[1,0,0]
    v_pk_fma_f32 v[252:253], v[252:253], v[12:13], v[30:31] op_sel:[0,0,0] op_sel_hi:[1,0,0]
    v_pk_fma_f32 v[254:255], v[254:255], v[12:13], v[30:31] op_sel:[0,0,0] op_sel_hi:[1,0,0]
    v_mfma_f32_16x16x32_bf16 v[68:71], a[108:111], a[12:15], -4.0
    v_max3_f32 v14, abs(v224), abs(v225), abs(v226)
    v_cvt_pk_bf16_f32 v224, v224, v225
    v_cvt_pk_bf16_f32 v225, v226, v227
    v_cvt_pk_bf16_f32 v226, v228, v229
    v_cvt_pk_bf16_f32 v54, v76, v77
    v_mfma_f32_16x16x32_bf16 v[68:71], a[104:107], a[8:11], v[68:71]
    v_max3_f32 v14, v14, abs(v227), abs(v228)
    v_cvt_pk_bf16_f32 v227, v230, v231
    v_exp_f32 v79, v79
    v_mfma_f32_16x16x32_bf16 v[68:71], a[100:103], a[4:7], v[68:71]
    v_cvt_pk_bf16_f32 v55, v78, v79
    v_fma_f32 v14, v14, s42, v30
    v_mfma_f32_16x16x32_bf16 v[68:71], a[96:99], a[0:3], v[68:71]
    buffer_store_dwordx4 v[224:227], v1, s[20:23], s34 offen offset:0 sc1
    v_smfmac_f32_16x16x64_bf16 v[36:39], v[24:27], v[48:55], v9
    v_cvt_pk_bf16_f32 v232, v232, v233
    v_mfma_f32_16x16x32_bf16 v[96:99], a[176:179], v[52:55], v[96:99]
    ds_read_b64_tr_b16 a[176:177], v10 offset:24576
    ds_read_b64_tr_b16 a[178:179], v10 offset:28672
    v_cvt_pk_bf16_f32 v233, v234, v235
    v_cvt_pk_bf16_f32 v234, v236, v237
    v_cvt_pk_bf16_f32 v235, v238, v239
    v_mfma_f32_16x16x32_bf16 v[96:99], a[144:147], v[48:51], v[96:99]
    ds_read_b64_tr_b16 a[144:145], v10 offset:16384
    ds_read_b64_tr_b16 a[146:147], v10 offset:20480
    v_and_or_b32 v14, v14, s43, v28
    v_mfma_f32_16x16x32_bf16 v[100:103], a[148:151], v[48:51], v[100:103]
    ds_read_b64_tr_b16 a[148:149], v10 offset:16392
    ds_read_b64_tr_b16 a[150:151], v10 offset:20488
    v_cmp_lt_u32_e64 s[4:5], s31, v14
    v_mfma_f32_16x16x32_bf16 v[100:103], a[180:183], v[52:55], v[100:103]
    s_cmp_lg_u64 s[4:5], 0
    ds_read_b64_tr_b16 a[180:181], v10 offset:24584
    v_cvt_pk_bf16_f32 v240, v240, v241
    v_mfma_f32_16x16x32_bf16 v[104:107], a[184:187], v[52:55], v[104:107]
    s_addc_u32 s32, s32, s32
    buffer_store_dwordx4 v[232:235], v1, s[20:23], s34 offen offset:64 sc1
    ds_read_b64_tr_b16 a[182:183], v10 offset:28680
    v_cvt_pk_bf16_f32 v241, v242, v243
    v_mfma_f32_16x16x32_bf16 v[104:107], a[152:155], v[48:51], v[104:107]
    ds_read_b64_tr_b16 a[184:185], v10 offset:24832
    v_cvt_pk_bf16_f32 v242, v244, v245
    v_cvt_pk_bf16_f32 v243, v246, v247
    v_mfma_f32_16x16x32_bf16 v[108:111], a[156:159], v[48:51], v[108:111]
    buffer_store_dwordx4 v[240:243], v1, s[20:23], s34 offen offset:128 sc1
    v_mfma_f32_16x16x32_bf16 v[108:111], a[188:191], v[52:55], v[108:111]
    ds_read_b64_tr_b16 a[186:187], v10 offset:28928
    ds_read_b64_tr_b16 a[152:153], v10 offset:16640
    v_mfma_f32_16x16x32_bf16 v[72:75], a[112:115], a[0:3], -4.0
    s_waitcnt lgkmcnt(9)
    v_exp_f32 v64, v64
    v_mfma_f32_16x16x32_bf16 v[72:75], a[116:119], a[4:7], v[72:75]
    ds_read_b64_tr_b16 a[154:155], v10 offset:20736
    ds_read_b64_tr_b16 a[156:157], v10 offset:16648
    v_mfma_f32_16x16x32_bf16 v[72:75], a[120:123], a[8:11], v[72:75]
    v_exp_f32 v65, v65
    v_mfma_f32_16x16x32_bf16 v[72:75], a[124:127], a[12:15], v[72:75]
    ds_read_b64_tr_b16 a[158:159], v10 offset:20744
    v_cvt_pk_bf16_f32 v248, v248, v249
    v_mfma_f32_16x16x32_bf16 v[76:79], a[140:143], a[12:15], -4.0
    v_cvt_pk_bf16_f32 v249, v250, v251
    v_cvt_pk_bf16_f32 v250, v252, v253
    v_mfma_f32_16x16x32_bf16 v[76:79], a[136:139], a[8:11], v[76:79]
    v_exp_f32 v66, v66
    v_mfma_f32_16x16x32_bf16 v[76:79], a[132:135], a[4:7], v[76:79]
    ds_read_b64_tr_b16 a[188:189], v10 offset:24840
    v_cvt_pk_bf16_f32 v251, v254, v255
    v_exp_f32 v72, v72
    v_mfma_f32_16x16x32_bf16 v[76:79], a[128:131], a[0:3], v[76:79]
    v_exp_f32 v73, v73
    v_mfma_f32_16x16x32_bf16 v[112:115], a[192:195], v[52:55], v[112:115]
    ds_read_b64_tr_b16 a[192:193], v10 offset:25088
    ds_read_b64_tr_b16 a[194:195], v10 offset:29184
    ds_read_b64_tr_b16 a[190:191], v10 offset:28936
    v_cvt_pk_bf16_f32 v56, v64, v65
    v_cvt_pk_bf16_f32 v60, v72, v73
    v_exp_f32 v74, v74
    v_mfma_f32_16x16x32_bf16 v[112:115], a[160:163], v[48:51], v[112:115]
    ds_read_b64_tr_b16 a[160:161], v10 offset:16896
    ds_read_b64_tr_b16 a[162:163], v10 offset:20992
    v_exp_f32 v67, v67
    v_exp_f32 v75, v75
    v_mfma_f32_16x16x32_bf16 v[116:119], a[164:167], v[48:51], v[116:119]
    ds_read_b64_tr_b16 a[164:165], v10 offset:16904
    ds_read_b64_tr_b16 a[166:167], v10 offset:21000
    buffer_store_dwordx4 v[248:251], v1, s[20:23], s34 offen offset:192 sc1
    v_cvt_pk_bf16_f32 v57, v66, v67
    v_exp_f32 v68, v68
    v_cvt_pk_bf16_f32 v61, v74, v75
    v_exp_f32 v76, v76
    v_mfma_f32_16x16x32_bf16 v[116:119], a[196:199], v[52:55], v[116:119]
    s_add_u32 s34, s34, s38
    ds_read_b64_tr_b16 a[196:197], v10 offset:25096
    ds_read_b64_tr_b16 a[198:199], v10 offset:29192
    v_exp_f32 v69, v69
    v_exp_f32 v77, v77
    v_mfma_f32_16x16x32_bf16 v[120:123], a[200:203], v[52:55], v[120:123]
    ds_read_b64_tr_b16 a[200:201], v10 offset:25344
    ds_read_b64_tr_b16 a[202:203], v10 offset:29440
    v_cvt_pk_bf16_f32 v58, v68, v69
    v_exp_f32 v70, v70
    v_cvt_pk_bf16_f32 v62, v76, v77
    v_exp_f32 v78, v78
    v_mfma_f32_16x16x32_bf16 v[120:123], a[168:171], v[48:51], v[120:123]
    ds_read_b64_tr_b16 a[168:169], v10 offset:17152
    ds_read_b64_tr_b16 a[170:171], v10 offset:21248
    v_exp_f32 v71, v71
    v_exp_f32 v79, v79
    v_mfma_f32_16x16x32_bf16 v[124:127], a[172:175], v[48:51], v[124:127]
    ds_read_b64_tr_b16 a[172:173], v10 offset:17160
    ds_read_b64_tr_b16 a[174:175], v10 offset:21256
    v_cvt_pk_bf16_f32 v59, v70, v71
    v_cvt_pk_bf16_f32 v63, v78, v79
    v_mfma_f32_16x16x32_bf16 v[124:127], a[204:207], v[52:55], v[124:127]
    ds_read_b64_tr_b16 a[204:205], v10 offset:25352
    ds_read_b64_tr_b16 a[206:207], v10 offset:29448
    v_smfmac_f32_16x16x64_bf16 v[36:39], v[24:27], v[56:63], v9
    v_mfma_f32_16x16x32_bf16 v[96:99], a[176:179], v[60:63], v[96:99]
    s_waitcnt lgkmcnt(12)
    v_mfma_f32_16x16x32_bf16 v[96:99], a[144:147], v[56:59], v[96:99]
    v_mfma_f32_16x16x32_bf16 v[100:103], a[148:151], v[56:59], v[100:103]
    v_add_f32 v29, v36, v37
    v_mfma_f32_16x16x32_bf16 v[100:103], a[180:183], v[60:63], v[100:103]
    v_rcp_f32 v13, v29
    v_mfma_f32_16x16x32_bf16 v[104:107], a[184:187], v[60:63], v[104:107]
    v_mul_f32_e64 v31, -v32, v13
    v_subrev_u32 v29, s30, v29
    v_mfma_f32_16x16x32_bf16 v[104:107], a[152:155], v[56:59], v[104:107]
    v_fma_f32 v96, v96, v13, v31
    v_fma_f32 v97, v97, v13, v31
    v_fma_f32 v98, v98, v13, v31
    v_mfma_f32_16x16x32_bf16 v[108:111], a[156:159], v[56:59], v[108:111]
    v_fma_f32 v99, v99, v13, v31
    v_fma_f32 v100, v100, v13, v31
    v_fma_f32 v101, v101, v13, v31
    v_fma_f32 v102, v102, v13, v31
    v_fma_f32 v103, v103, v13, v31
    v_max3_f32 v14, abs(v96), abs(v97), abs(v98)
    v_mfma_f32_16x16x32_bf16 v[108:111], a[188:191], v[60:63], v[108:111]
    v_max3_f32 v14, v14, abs(v99), abs(v100)
    v_cvt_pk_bf16_f32 v96, v96, v97
    v_cvt_pk_bf16_f32 v97, v98, v99
    v_cvt_pk_bf16_f32 v98, v100, v101
    v_cvt_pk_bf16_f32 v99, v102, v103
    v_mfma_f32_16x16x32_bf16 v[112:115], a[192:195], v[60:63], v[112:115]
    ds_write_b128 v18, v[96:99] offset:0
    v_mfma_f32_16x16x32_bf16 v[112:115], a[160:163], v[56:59], v[112:115]
    s_waitcnt lgkmcnt(1)
    ds_read_b128 v[100:103], v16 offset:0
    v_fma_f32 v14, v14, s42, v31
    v_mfma_f32_16x16x32_bf16 v[116:119], a[164:167], v[56:59], v[116:119]
    v_and_or_b32 v14, v14, s43, v29
    v_mfma_f32_16x16x32_bf16 v[116:119], a[196:199], v[60:63], v[116:119]
    v_cmp_lt_u32_e64 s[4:5], s31, v14
    v_mfma_f32_16x16x32_bf16 v[120:123], a[200:203], v[60:63], v[120:123]
    v_mfma_f32_16x16x32_bf16 v[120:123], a[168:171], v[56:59], v[120:123]
    s_cmp_lg_u64 s[4:5], 0
    v_mfma_f32_16x16x32_bf16 v[124:127], a[172:175], v[56:59], v[124:127]
    s_addc_u32 s32, s32, s32
    v_mfma_f32_16x16x32_bf16 v[124:127], a[204:207], v[60:63], v[124:127]
    s_waitcnt lgkmcnt(0)
    buffer_store_dwordx4 v[100:103], v17, s[20:23], s34 offen offset:0 sc1
    v_pk_fma_f32 v[104:105], v[104:105], v[12:13], v[30:31] op_sel:[0,1,1] op_sel_hi:[1,1,1]
    v_pk_fma_f32 v[106:107], v[106:107], v[12:13], v[30:31] op_sel:[0,1,1] op_sel_hi:[1,1,1]
    v_cvt_pk_bf16_f32 v104, v104, v105
    v_cvt_pk_bf16_f32 v105, v106, v107
    v_pk_fma_f32 v[108:109], v[108:109], v[12:13], v[30:31] op_sel:[0,1,1] op_sel_hi:[1,1,1]
    v_pk_fma_f32 v[110:111], v[110:111], v[12:13], v[30:31] op_sel:[0,1,1] op_sel_hi:[1,1,1]
    v_cvt_pk_bf16_f32 v106, v108, v109
    v_cvt_pk_bf16_f32 v107, v110, v111
    ds_write_b128 v18, v[104:107] offset:1024
    ds_read_b128 v[108:111], v16 offset:1024
    v_pk_fma_f32 v[112:113], v[112:113], v[12:13], v[30:31] op_sel:[0,1,1] op_sel_hi:[1,1,1]
    v_pk_fma_f32 v[114:115], v[114:115], v[12:13], v[30:31] op_sel:[0,1,1] op_sel_hi:[1,1,1]
    v_cvt_pk_bf16_f32 v112, v112, v113
    v_cvt_pk_bf16_f32 v113, v114, v115
    v_pk_fma_f32 v[116:117], v[116:117], v[12:13], v[30:31] op_sel:[0,1,1] op_sel_hi:[1,1,1]
    v_pk_fma_f32 v[118:119], v[118:119], v[12:13], v[30:31] op_sel:[0,1,1] op_sel_hi:[1,1,1]
    v_cvt_pk_bf16_f32 v114, v116, v117
    v_cvt_pk_bf16_f32 v115, v118, v119
    ds_write_b128 v18, v[112:115] offset:2048
    ds_read_b128 v[116:119], v16 offset:2048
    s_waitcnt lgkmcnt(2)
    buffer_store_dwordx4 v[108:111], v17, s[20:23], s34 offen offset:64 sc1
    v_pk_fma_f32 v[120:121], v[120:121], v[12:13], v[30:31] op_sel:[0,1,1] op_sel_hi:[1,1,1]
    v_pk_fma_f32 v[122:123], v[122:123], v[12:13], v[30:31] op_sel:[0,1,1] op_sel_hi:[1,1,1]
    v_cvt_pk_bf16_f32 v120, v120, v121
    v_cvt_pk_bf16_f32 v121, v122, v123
    v_pk_fma_f32 v[124:125], v[124:125], v[12:13], v[30:31] op_sel:[0,1,1] op_sel_hi:[1,1,1]
    v_pk_fma_f32 v[126:127], v[126:127], v[12:13], v[30:31] op_sel:[0,1,1] op_sel_hi:[1,1,1]
    v_cvt_pk_bf16_f32 v122, v124, v125
    v_cvt_pk_bf16_f32 v123, v126, v127
    ds_write_b128 v18, v[120:123] offset:3072
    s_waitcnt lgkmcnt(1)
    buffer_store_dwordx4 v[116:119], v17, s[20:23], s34 offen offset:128 sc1
    ds_read_b128 v[124:127], v16 offset:3072
    s_waitcnt lgkmcnt(0)
    buffer_store_dwordx4 v[124:127], v17, s[20:23], s34 offen offset:192 sc1
L_fin:
    s_cmp_lg_u32 s32, 0
    s_cbranch_scc1 L_fb
    s_endpgm

.section .rodata,"a"
.p2align 6
.amdhsa_kernel standalone__gqa_softmax__near_ridge_kernel
  .amdhsa_next_free_vgpr 512
  .amdhsa_next_free_sgpr 102
  .amdhsa_accum_offset 256
  .amdhsa_group_segment_fixed_size 0
  .amdhsa_kernarg_size 48
  .amdhsa_user_sgpr_count 2
  .amdhsa_user_sgpr_kernarg_segment_ptr 1
  .amdhsa_system_sgpr_workgroup_id_x 1
.end_amdhsa_kernel
```
